```python
import torch

def _softmax(x, axis=-1):
    return torch.softmax(x, dim=axis)
def _gelu(x):
    return torch.nn.functional.gelu(x, approximate="tanh")
def _silu(x):
    return torch.nn.functional.silu(x)
def _sigmoid(x):
    return torch.sigmoid(x)
def _layernorm(x, axis=-1, eps=1e-5):
    m = x.mean(dim=axis, keepdim=True)
    v = x.var(dim=axis, keepdim=True, unbiased=False)
    return (x - m) / torch.sqrt(v + eps)
def _scatter_add(tgt, idx, src, axis=0):
    return tgt.clone().index_add_(axis, idx, src)
def _segment_sum(src, seg, n):
    out = torch.zeros((n,) + src.shape[1:], dtype=src.dtype)
    return out.index_add_(0, seg, src)
def _pad(x, pw):
    flat = tuple(v for pair in reversed(pw) for v in pair)
    return torch.nn.functional.pad(x, flat)

kernel_name = 'concat_heads__linear_kernel_hedgehog__ssm_conv_s4d__prompt'

def setup_inputs():

    _w = (lambda a: (lambda t: t.to(torch.bfloat16) if t.is_floating_point() else t)(torch.as_tensor(a)))
    def _A_setup():
        B, S, D, H = 1, 2048, 576, 32
        Dh = D // H
        return {
            "x": _w((lambda *s: torch.randn(*s, dtype=torch.bfloat16) * 0.4)(B, S, D)),
            "wqkv": _w((lambda *s: torch.randn(*s, dtype=torch.bfloat16) * 0.4)(D, 3 * D)),
            "w_phi": _w((lambda *s: torch.randn(*s, dtype=torch.bfloat16) * 0.4)(H, Dh, Dh) * (Dh ** -0.5)),
            "wo": _w((lambda *s: torch.randn(*s, dtype=torch.bfloat16) * 0.05)(D, D)),
        }
    _A_in = _A_setup()

    def _B_setup():
        Bsz, L, D, N = 1, 2048, 576, 128
        return {
            "u": _w((lambda *s: torch.randn(*s, dtype=torch.bfloat16) * 0.05)(Bsz, L, D)),
            "log_A_real": _w((lambda *s: torch.randn(*s, dtype=torch.bfloat16) * 3.2)(D, N) * 0.5),
            "A_imag": _w((lambda *s: torch.randn(*s, dtype=torch.bfloat16) * 0.2)(D, N) * 3.14),
            "C_real": _w((lambda *s: torch.randn(*s, dtype=torch.bfloat16) * 3.2)(D, N) / N ** 0.5),
            "C_imag": _w((lambda *s: torch.randn(*s, dtype=torch.bfloat16) * 3.2)(D, N) / N ** 0.5),
            "log_dt": _w((lambda *s: torch.randn(*s, dtype=torch.bfloat16) * 0.2)(D) * 0.5 - 4.0),
            "D_skip": _w((lambda *s: torch.randn(*s, dtype=torch.bfloat16) * 0.4)(D)),
        }
    _B_in = _B_setup()

    return {
        "A_x": _A_in["x"],
        "A_wqkv": _A_in["wqkv"],
        "A_w_phi": _A_in["w_phi"],
        "A_wo": _A_in["wo"],
        "B_u": _B_in["u"],
        "B_log_A_real": _B_in["log_A_real"],
        "B_A_imag": _B_in["A_imag"],
        "B_C_real": _B_in["C_real"],
        "B_C_imag": _B_in["C_imag"],
        "B_log_dt": _B_in["log_dt"],
        "B_D_skip": _B_in["D_skip"],
    }

def reference(A_x, A_wqkv, A_w_phi, A_wo, B_u, B_log_A_real, B_A_imag, B_C_real, B_C_imag, B_log_dt, B_D_skip):
    def _A_ref(x, wqkv, w_phi, wo):
        B, S, D = x.shape
        H = 32; Dh = D // H
        qkv = (lambda x, *d: x.permute(*d))((x @ wqkv).reshape(B, S, 3, H, Dh), 2, 0, 3, 1, 4)
        q, k, v = qkv[0], qkv[1], qkv[2]
        pq = torch.einsum("bhsd,hdf->bhsf", q, w_phi)
        pk = torch.einsum("bhsd,hdf->bhsf", k, w_phi)
        phi_q = torch.concatenate([_softmax(pq, axis=-1), _softmax(-pq, axis=-1)], axis=-1)
        phi_k = torch.concatenate([_softmax(pk, axis=-1), _softmax(-pk, axis=-1)], axis=-1)
        kv = torch.einsum("bhsf,bhsd->bhfd", phi_k, v)
        z  = torch.einsum("bhsf->bhf", phi_k)
        num = torch.einsum("bhqf,bhfd->bhqd", phi_q, kv)
        den = torch.einsum("bhqf,bhf->bhq", phi_q, z)[..., None] + 1e-6
        o = num / den
        return (lambda x, *d: x.permute(*d))(o, 0, 2, 1, 3).reshape(B, S, D) @ wo

    def _B_ref(u, log_A_real, A_imag, C_real, C_imag, log_dt, D_skip):
        L = u.shape[1]
        dt = torch.exp(log_dt)
        A = -torch.exp(log_A_real) + 1j * A_imag
        C = (C_real + 1j * C_imag) * dt[:, None]
        pos = (lambda x, dt: x.to(dt))(torch.arange(L), log_dt.dtype)
        P = torch.exp((A * dt[:, None])[:, :, None] * pos[None, None, :])
        K = 2.0 * torch.einsum("dn,dnl->dl", C, P).real
        L2 = 2 * L
        u_t = (lambda x, *d: x.permute(*d))(u, 0, 2, 1)
        Kf = (lambda x, *a, **k: torch.fft.rfft(x.float(), *a, **k))(K, L2)
        Uf = (lambda x, *a, **k: torch.fft.rfft(x.float(), *a, **k))(u_t, L2)
        y = (lambda x, *a, **k: torch.fft.irfft(x, *a, **k).to(torch.bfloat16))(Uf * Kf[None, :, :], L2)[:, :, :L]
        y = (lambda x, *d: x.permute(*d))(y, 0, 2, 1)
        return y + u * D_skip[None, None, :]

    a = _A_ref(A_x, A_wqkv, A_w_phi, A_wo)
    b = _B_ref(B_u, B_log_A_real, B_A_imag, B_C_real, B_C_imag, B_log_dt, B_D_skip)
    return torch.concatenate([a, b], axis=-1)
```

```asm
; @launch grid=(256,1,1) block=(768,1,1) lds=163840
.amdgcn_target "amdgcn-amd-amdhsa--gfx950"
.text
.globl concat_heads__linear_kernel_hedgehog__ssm_conv_s4d__prompt_kernel
.p2align 8
.type concat_heads__linear_kernel_hedgehog__ssm_conv_s4d__prompt_kernel,@function
concat_heads__linear_kernel_hedgehog__ssm_conv_s4d__prompt_kernel:
L_code0:
s_cmp_ge_u32 s2, 256
s_cbranch_scc1 L_end
v_subrev_u32 v2, 0, v0
v_cmp_gt_u32 vcc, 12, v2
s_and_saveexec_b64 s[4:5], vcc
s_cbranch_execz cw_1
s_getpc_b64 s[6:7]
pc_2:
s_sub_u32 s6, s6, pc_2-L_code0
s_subb_u32 s7, s7, 0
s_lshr_b32 s3, s2, 3
s_and_b32 s3, s3, 31
s_mul_i32 s3, s3, 12
v_add_u32 v2, s3, v2
v_min_u32 v2, (L_end-L_code0)/128, v2
v_lshlrev_b32 v2, 7, v2
v_mov_b32 v3, s7
v_add_co_u32 v2, vcc, s6, v2
s_nop 1
v_addc_co_u32 v3, vcc, 0, v3, vcc
global_load_dword v167, v[2:3], off
cw_1:
s_mov_b64 exec, s[4:5]
s_load_dwordx4 s[36:39], s[0:1], 0
s_load_dwordx2 s[40:41], s[0:1], 16
s_load_dwordx2 s[42:43], s[0:1], 104
s_load_dwordx2 s[48:49], s[0:1], 88
s_load_dwordx2 s[52:53], s[0:1], 96
v_and_b32 v1, 63, v0
v_lshrrev_b32 v4, 6, v0
s_and_b32 s31, s2, 7
s_lshl_b32 s31, s31, 2
v_readfirstlane_b32 s24, v4
s_lshr_b32 s32, s2, 3
s_and_b32 s33, s32, 3
s_add_u32 s25, s31, s33
s_lshr_b32 s26, s32, 2
s_and_b32 s29, s24, 1
s_lshr_b32 s30, s24, 1
s_and_b32 s30, s30, 1
s_mov_b32 s34, -1
s_mov_b32 s35, 0x7fffffff
s_and_b32 s56, s2, 7
s_lshr_b32 s57, s2, 3
s_mov_b32 s61, 4096
s_mov_b32 s62, -1
s_mov_b32 s63, 0
s_waitcnt lgkmcnt(0)
s_mov_b32 s8, s36
s_and_b32 s9, s37, 0xffff
s_mov_b32 s10, 2359296
s_mov_b32 s11, 0x20000
s_mov_b32 s12, s38
s_and_b32 s13, s39, 0xffff
s_mov_b32 s14, 1990656
s_mov_b32 s15, 0x20000
s_mov_b32 s16, s40
s_and_b32 s17, s41, 0xffff
s_mov_b32 s18, 20736
s_mov_b32 s19, 0x20000
s_mov_b32 s20, s42
s_and_b32 s21, s43, 0xffff
s_mov_b32 s22, 0x10000000
s_mov_b32 s23, 0x20000
s_and_b32 s49, s49, 0xffff
s_mov_b32 s50, 4718592
s_mov_b32 s51, 0x20000
s_and_b32 s53, s53, 0xffff
s_mov_b32 s54, 256
s_mov_b32 s55, 0x20000
s_cmp_ge_u32 s24, 10
s_cbranch_scc1 L_help
s_cmp_ge_u32 s24, 8
s_cbranch_scc1 L_loader
s_cmp_ge_u32 s24, 4
s_cbranch_scc1 L_g1
s_lshl_b32 s31, s26, 2
s_lshl_b32 s32, s29, 1
s_add_u32 s31, s31, s32
s_mul_i32 s28, s31, 648
s_lshl_b32 s31, s24, 11
s_add_u32 m0, s31, 122112
v_lshlrev_b32 v16, 4, v1
buffer_load_dwordx4 v16, s[16:19], s28 offen lds
s_add_u32 m0, m0, 1024
s_add_u32 s28, s28, 1024
buffer_load_dwordx4 v16, s[16:19], s28 offen lds
v_and_b32 v16, 31, v1
s_lshl_b32 s31, s30, 5
v_add_u32 v16, s31, v16
v_lshrrev_b32 v17, 1, v16
v_and_b32 v17, 7, v17
v_lshrrev_b32 v18, 5, v1
v_xor_b32 v17, v17, v18
v_lshlrev_b32 v17, 4, v17
v_lshlrev_b32 v16, 7, v16
v_add_u32 v16, v16, v17
v_xor_b32 v5, 0, v16
v_add_u32 v9, 0x10000, v5
v_xor_b32 v6, 32, v16
v_add_u32 v10, 0x10000, v6
v_xor_b32 v7, 64, v16
v_add_u32 v11, 0x10000, v7
v_xor_b32 v8, 96, v16
v_add_u32 v12, 0x10000, v8
v_lshrrev_b32 v16, 5, v1
v_bfe_u32 v17, v1, 2, 2
v_lshl_add_u32 v16, v16, 3, v17
v_mul_u32_u24 v16, 144, v16
v_add_u32 v16, 73728, v16
v_and_b32 v17, 1, v17
v_and_b32 v18, 1, v1
v_lshl_add_u32 v16, v18, 3, v16
v_lshl_add_u32 v14, v17, 7, v16
v_bfe_u32 v18, v1, 4, 1
v_bfe_u32 v19, v1, 1, 1
v_lshl_add_u32 v18, v18, 1, v19
s_mul_i32 s31, s29, 5
v_add_u32 v18, s31, v18
v_lshlrev_b32 v18, 2, v18
v_sub_u32 v18, v18, v17
v_add_u32 v18, 2, v18
v_mul_u32_u24 v19, 57, v18
v_lshrrev_b32 v19, 9, v19
v_mul_u32_u24 v19, 9, v19
v_sub_u32 v18, v18, v19
v_lshl_add_u32 v13, v18, 4, v16
s_waitcnt vmcnt(0)
v_and_b32 v18, 31, v1
v_lshrrev_b32 v17, 5, v1
v_cmp_eq_u32 vcc, 20, v18
v_mov_b32 v20, 17
s_nop 0
v_cndmask_b32 v16, v18, v20, vcc
v_cmp_gt_u32 s[44:45], 17, v18
s_or_b64 s[44:45], s[44:45], vcc
v_min_u32 v16, 17, v16
v_lshlrev_b32 v16, 1, v16
v_cndmask_b32 v19, 0, -1, s[44:45]
v_mul_u32_u24 v20, 144, v17
s_and_b32 s31, s24, 3
s_lshl_b32 s31, s31, 11
s_add_u32 s31, s31, 122112
v_add3_u32 v16, v16, v20, s31
v_cmp_eq_u32 s[46:47], 1, v17
s_cmp_eq_u32 s29, 1
s_cbranch_scc1 wg_j1_3
ds_read_u16 v88, v16 offset:0
ds_read_u16_d16_hi v72, v16 offset:36
ds_read_u16 v89, v16 offset:72
ds_read_u16_d16_hi v73, v16 offset:108
ds_read_u16 v90, v16 offset:288
ds_read_u16_d16_hi v74, v16 offset:324
ds_read_u16 v91, v16 offset:360
ds_read_u16_d16_hi v75, v16 offset:396
ds_read_u16 v92, v16 offset:576
ds_read_u16_d16_hi v76, v16 offset:612
v_mov_b32 v93, 0
v_mov_b32 v77, 0
v_mov_b32 v94, 0
v_mov_b32 v78, 0
v_mov_b32 v95, 0
v_mov_b32 v79, 0
ds_read_u16 v96, v16 offset:576
ds_read_u16_d16_hi v80, v16 offset:612
ds_read_u16 v97, v16 offset:648
ds_read_u16_d16_hi v81, v16 offset:684
ds_read_u16 v98, v16 offset:864
ds_read_u16_d16_hi v82, v16 offset:900
ds_read_u16 v99, v16 offset:936
ds_read_u16_d16_hi v83, v16 offset:972
ds_read_u16 v100, v16 offset:1152
ds_read_u16_d16_hi v84, v16 offset:1188
ds_read_u16 v101, v16 offset:1224
ds_read_u16_d16_hi v85, v16 offset:1260
v_mov_b32 v102, 0
v_mov_b32 v86, 0
v_mov_b32 v103, 0
v_mov_b32 v87, 0
s_waitcnt lgkmcnt(0)
v_or_b32 v72, v72, v88
v_and_b32 v72, v72, v19
v_or_b32 v73, v73, v89
v_and_b32 v73, v73, v19
v_or_b32 v74, v74, v90
v_and_b32 v74, v74, v19
v_or_b32 v75, v75, v91
v_and_b32 v75, v75, v19
v_or_b32 v76, v76, v92
v_mov_b32 v20, 4294967295
v_mov_b32 v21, 0
v_cndmask_b32 v20, v20, v21, s[46:47]
v_and_b32 v20, v20, v19
v_and_b32 v76, v76, v20
v_mov_b32 v77, 0
v_mov_b32 v78, 0
v_mov_b32 v79, 0
v_or_b32 v80, v80, v96
v_mov_b32 v20, 0
v_mov_b32 v21, 4294967295
v_cndmask_b32 v20, v20, v21, s[46:47]
v_and_b32 v20, v20, v19
v_and_b32 v80, v80, v20
v_or_b32 v81, v81, v97
v_and_b32 v81, v81, v19
v_or_b32 v82, v82, v98
v_and_b32 v82, v82, v19
v_or_b32 v83, v83, v99
v_and_b32 v83, v83, v19
v_or_b32 v84, v84, v100
v_mov_b32 v20, 4294967295
v_mov_b32 v21, 0
v_cndmask_b32 v20, v20, v21, s[46:47]
v_and_b32 v20, v20, v19
v_and_b32 v84, v84, v20
v_or_b32 v85, v85, v101
v_mov_b32 v20, 4294967295
v_mov_b32 v21, 0
v_cndmask_b32 v20, v20, v21, s[46:47]
v_and_b32 v20, v20, v19
v_and_b32 v85, v85, v20
v_mov_b32 v86, 0
v_mov_b32 v87, 0
s_branch wg_end_4
wg_j1_3:
v_subrev_u32 v20, 144, v16
v_max_i32 v20, 0, v20
ds_read_u16 v88, v20
v_subrev_u32 v20, 108, v16
v_max_i32 v20, 0, v20
ds_read_u16_d16_hi v72, v20
v_subrev_u32 v20, 72, v16
v_max_i32 v20, 0, v20
ds_read_u16 v89, v20
v_subrev_u32 v20, 36, v16
v_max_i32 v20, 0, v20
ds_read_u16_d16_hi v73, v20
v_mov_b32 v90, 0
v_mov_b32 v74, 0
v_mov_b32 v91, 0
v_mov_b32 v75, 0
ds_read_u16 v92, v16 offset:144
ds_read_u16_d16_hi v76, v16 offset:180
ds_read_u16 v93, v16 offset:216
ds_read_u16_d16_hi v77, v16 offset:252
ds_read_u16 v94, v16 offset:432
ds_read_u16_d16_hi v78, v16 offset:468
ds_read_u16 v95, v16 offset:504
ds_read_u16_d16_hi v79, v16 offset:540
v_mov_b32 v96, 0
v_mov_b32 v80, 0
v_mov_b32 v97, 0
v_mov_b32 v81, 0
v_mov_b32 v98, 0
v_mov_b32 v82, 0
ds_read_u16 v99, v16 offset:504
ds_read_u16_d16_hi v83, v16 offset:540
ds_read_u16 v100, v16 offset:720
ds_read_u16_d16_hi v84, v16 offset:756
ds_read_u16 v101, v16 offset:792
ds_read_u16_d16_hi v85, v16 offset:828
ds_read_u16 v102, v16 offset:1008
ds_read_u16_d16_hi v86, v16 offset:1044
ds_read_u16 v103, v16 offset:1080
ds_read_u16_d16_hi v87, v16 offset:1116
s_waitcnt lgkmcnt(0)
v_or_b32 v72, v72, v88
v_mov_b32 v20, 0
v_mov_b32 v21, 4294967295
v_cndmask_b32 v20, v20, v21, s[46:47]
v_and_b32 v20, v20, v19
v_and_b32 v72, v72, v20
v_or_b32 v73, v73, v89
v_mov_b32 v20, 0
v_mov_b32 v21, 4294967295
v_cndmask_b32 v20, v20, v21, s[46:47]
v_and_b32 v20, v20, v19
v_and_b32 v73, v73, v20
v_mov_b32 v74, 0
v_mov_b32 v75, 0
v_or_b32 v76, v76, v92
v_and_b32 v76, v76, v19
v_or_b32 v77, v77, v93
v_and_b32 v77, v77, v19
v_or_b32 v78, v78, v94
v_and_b32 v78, v78, v19
v_or_b32 v79, v79, v95
v_mov_b32 v20, 4294967295
v_mov_b32 v21, 0
v_cndmask_b32 v20, v20, v21, s[46:47]
v_and_b32 v20, v20, v19
v_and_b32 v79, v79, v20
v_mov_b32 v80, 0
v_mov_b32 v81, 0
v_mov_b32 v82, 0
v_or_b32 v83, v83, v99
v_mov_b32 v20, 0
v_mov_b32 v21, 4294967295
v_cndmask_b32 v20, v20, v21, s[46:47]
v_and_b32 v20, v20, v19
v_and_b32 v83, v83, v20
v_or_b32 v84, v84, v100
v_and_b32 v84, v84, v19
v_or_b32 v85, v85, v101
v_and_b32 v85, v85, v19
v_or_b32 v86, v86, v102
v_and_b32 v86, v86, v19
v_or_b32 v87, v87, v103
v_and_b32 v87, v87, v19
wg_end_4:
v_mov_b32 v160, 0x3fb8aa3b
v_mov_b32 v147, 0
v_and_b32 v16, 31, v1
s_lshl_b32 s31, s30, 5
v_add_u32 v16, s31, v16
v_mul_u32_u24 v16, 328, v16
v_lshrrev_b32 v17, 5, v1
v_lshl_add_u32 v16, v17, 3, v16
s_mul_i32 s31, s29, 160
s_add_u32 s31, s31, 122112
v_add_u32 v15, s31, v16
s_barrier
ds_read_b128 v[16:19], v5 offset:0
ds_read_b64_tr_b16 v[20:21], v13 offset:0
ds_read_b64_tr_b16 v[22:23], v13 offset:576
ds_read_b64_tr_b16 v[24:25], v14 offset:0
ds_read_b64_tr_b16 v[26:27], v14 offset:576
ds_read_b128 v[28:31], v6 offset:0
ds_read_b64_tr_b16 v[32:33], v13 offset:2304
ds_read_b64_tr_b16 v[34:35], v13 offset:2880
ds_read_b64_tr_b16 v[36:37], v14 offset:2304
ds_read_b64_tr_b16 v[38:39], v14 offset:2880
s_waitcnt lgkmcnt(5)
v_mfma_f32_32x32x16_bf16 v[40:55], v[20:23], v[16:19], 0
ds_read_b128 v[104:107], v7 offset:0
ds_read_b64_tr_b16 v[108:109], v13 offset:4608
ds_read_b64_tr_b16 v[110:111], v13 offset:5184
v_mfma_f32_32x32x16_bf16 v[56:71], v[24:27], v[16:19], 0
ds_read_b64_tr_b16 v[112:113], v14 offset:4608
ds_read_b64_tr_b16 v[114:115], v14 offset:5184
s_waitcnt lgkmcnt(5)
v_mfma_f32_32x32x16_bf16 v[40:55], v[32:35], v[28:31], v[40:55]
ds_read_b128 v[16:19], v8 offset:0
ds_read_b64_tr_b16 v[20:21], v13 offset:6912
ds_read_b64_tr_b16 v[22:23], v13 offset:7488
v_mfma_f32_32x32x16_bf16 v[56:71], v[36:39], v[28:31], v[56:71]
ds_read_b64_tr_b16 v[24:25], v14 offset:6912
ds_read_b64_tr_b16 v[26:27], v14 offset:7488
s_waitcnt lgkmcnt(5)
s_barrier
v_mfma_f32_32x32x16_bf16 v[40:55], v[108:111], v[104:107], v[40:55]
ds_read_b128 v[28:31], v5 offset:8192
ds_read_b64_tr_b16 v[32:33], v13 offset:9216
ds_read_b64_tr_b16 v[34:35], v13 offset:9792
v_mfma_f32_32x32x16_bf16 v[56:71], v[112:115], v[104:107], v[56:71]
ds_read_b64_tr_b16 v[36:37], v14 offset:9216
ds_read_b64_tr_b16 v[38:39], v14 offset:9792
s_waitcnt lgkmcnt(5)
v_mfma_f32_32x32x16_bf16 v[40:55], v[20:23], v[16:19], v[40:55]
ds_read_b128 v[104:107], v6 offset:8192
ds_read_b64_tr_b16 v[108:109], v13 offset:11520
ds_read_b64_tr_b16 v[110:111], v13 offset:12096
v_mfma_f32_32x32x16_bf16 v[56:71], v[24:27], v[16:19], v[56:71]
ds_read_b64_tr_b16 v[112:113], v14 offset:11520
ds_read_b64_tr_b16 v[114:115], v14 offset:12096
s_waitcnt lgkmcnt(5)
v_mfma_f32_32x32x16_bf16 v[40:55], v[32:35], v[28:31], v[40:55]
ds_read_b128 v[16:19], v7 offset:8192
ds_read_b64_tr_b16 v[20:21], v13 offset:13824
ds_read_b64_tr_b16 v[22:23], v13 offset:14400
v_mfma_f32_32x32x16_bf16 v[56:71], v[36:39], v[28:31], v[56:71]
ds_read_b64_tr_b16 v[24:25], v14 offset:13824
ds_read_b64_tr_b16 v[26:27], v14 offset:14400
s_waitcnt lgkmcnt(5)
v_mfma_f32_32x32x16_bf16 v[40:55], v[108:111], v[104:107], v[40:55]
ds_read_b128 v[28:31], v8 offset:8192
ds_read_b64_tr_b16 v[32:33], v13 offset:16128
ds_read_b64_tr_b16 v[34:35], v13 offset:16704
v_mfma_f32_32x32x16_bf16 v[56:71], v[112:115], v[104:107], v[56:71]
ds_read_b64_tr_b16 v[36:37], v14 offset:16128
ds_read_b64_tr_b16 v[38:39], v14 offset:16704
s_waitcnt lgkmcnt(5)
s_barrier
v_mfma_f32_32x32x16_bf16 v[40:55], v[20:23], v[16:19], v[40:55]
ds_read_b128 v[104:107], v5 offset:16384
ds_read_b64_tr_b16 v[108:109], v13 offset:18432
ds_read_b64_tr_b16 v[110:111], v13 offset:19008
v_mfma_f32_32x32x16_bf16 v[56:71], v[24:27], v[16:19], v[56:71]
ds_read_b64_tr_b16 v[112:113], v14 offset:18432
ds_read_b64_tr_b16 v[114:115], v14 offset:19008
s_waitcnt lgkmcnt(5)
v_mfma_f32_32x32x16_bf16 v[40:55], v[32:35], v[28:31], v[40:55]
ds_read_b128 v[16:19], v6 offset:16384
ds_read_b64_tr_b16 v[20:21], v13 offset:20736
ds_read_b64_tr_b16 v[22:23], v13 offset:21312
v_mfma_f32_32x32x16_bf16 v[56:71], v[36:39], v[28:31], v[56:71]
ds_read_b64_tr_b16 v[24:25], v14 offset:20736
ds_read_b64_tr_b16 v[26:27], v14 offset:21312
s_waitcnt lgkmcnt(5)
v_mfma_f32_32x32x16_bf16 v[40:55], v[108:111], v[104:107], v[40:55]
ds_read_b128 v[28:31], v7 offset:16384
ds_read_b64_tr_b16 v[32:33], v13 offset:23040
ds_read_b64_tr_b16 v[34:35], v13 offset:23616
v_mfma_f32_32x32x16_bf16 v[56:71], v[112:115], v[104:107], v[56:71]
ds_read_b64_tr_b16 v[36:37], v14 offset:23040
ds_read_b64_tr_b16 v[38:39], v14 offset:23616
s_waitcnt lgkmcnt(5)
v_mfma_f32_32x32x16_bf16 v[40:55], v[20:23], v[16:19], v[40:55]
ds_read_b128 v[104:107], v8 offset:16384
ds_read_b64_tr_b16 v[108:109], v13 offset:25344
ds_read_b64_tr_b16 v[110:111], v13 offset:25920
v_mfma_f32_32x32x16_bf16 v[56:71], v[24:27], v[16:19], v[56:71]
ds_read_b64_tr_b16 v[112:113], v14 offset:25344
ds_read_b64_tr_b16 v[114:115], v14 offset:25920
s_waitcnt lgkmcnt(5)
s_barrier
v_mfma_f32_32x32x16_bf16 v[40:55], v[32:35], v[28:31], v[40:55]
ds_read_b128 v[16:19], v5 offset:24576
ds_read_b64_tr_b16 v[20:21], v13 offset:27648
ds_read_b64_tr_b16 v[22:23], v13 offset:28224
v_mfma_f32_32x32x16_bf16 v[56:71], v[36:39], v[28:31], v[56:71]
ds_read_b64_tr_b16 v[24:25], v14 offset:27648
ds_read_b64_tr_b16 v[26:27], v14 offset:28224
s_waitcnt lgkmcnt(5)
v_mfma_f32_32x32x16_bf16 v[40:55], v[108:111], v[104:107], v[40:55]
ds_read_b128 v[28:31], v6 offset:24576
ds_read_b64_tr_b16 v[32:33], v13 offset:29952
ds_read_b64_tr_b16 v[34:35], v13 offset:30528
v_mfma_f32_32x32x16_bf16 v[56:71], v[112:115], v[104:107], v[56:71]
ds_read_b64_tr_b16 v[36:37], v14 offset:29952
ds_read_b64_tr_b16 v[38:39], v14 offset:30528
s_waitcnt lgkmcnt(5)
v_mfma_f32_32x32x16_bf16 v[40:55], v[20:23], v[16:19], v[40:55]
ds_read_b128 v[104:107], v7 offset:24576
ds_read_b64_tr_b16 v[108:109], v13 offset:32256
ds_read_b64_tr_b16 v[110:111], v13 offset:32832
v_mfma_f32_32x32x16_bf16 v[56:71], v[24:27], v[16:19], v[56:71]
ds_read_b64_tr_b16 v[112:113], v14 offset:32256
ds_read_b64_tr_b16 v[114:115], v14 offset:32832
s_waitcnt lgkmcnt(5)
v_mfma_f32_32x32x16_bf16 v[40:55], v[32:35], v[28:31], v[40:55]
ds_read_b128 v[16:19], v8 offset:24576
ds_read_b64_tr_b16 v[20:21], v13 offset:34560
ds_read_b64_tr_b16 v[22:23], v13 offset:35136
v_mfma_f32_32x32x16_bf16 v[56:71], v[36:39], v[28:31], v[56:71]
ds_read_b64_tr_b16 v[24:25], v14 offset:34560
ds_read_b64_tr_b16 v[26:27], v14 offset:35136
s_waitcnt lgkmcnt(5)
s_barrier
v_mfma_f32_32x32x16_bf16 v[40:55], v[108:111], v[104:107], v[40:55]
ds_read_b128 v[28:31], v5 offset:32768
ds_read_b64_tr_b16 v[32:33], v13 offset:36864
ds_read_b64_tr_b16 v[34:35], v13 offset:37440
v_mfma_f32_32x32x16_bf16 v[56:71], v[112:115], v[104:107], v[56:71]
ds_read_b64_tr_b16 v[36:37], v14 offset:36864
ds_read_b64_tr_b16 v[38:39], v14 offset:37440
s_waitcnt lgkmcnt(5)
v_mfma_f32_32x32x16_bf16 v[40:55], v[20:23], v[16:19], v[40:55]
ds_read_b128 v[104:107], v6 offset:32768
ds_read_b64_tr_b16 v[108:109], v13 offset:39168
ds_read_b64_tr_b16 v[110:111], v13 offset:39744
v_mfma_f32_32x32x16_bf16 v[56:71], v[24:27], v[16:19], v[56:71]
ds_read_b64_tr_b16 v[112:113], v14 offset:39168
ds_read_b64_tr_b16 v[114:115], v14 offset:39744
s_waitcnt lgkmcnt(5)
v_mfma_f32_32x32x16_bf16 v[40:55], v[32:35], v[28:31], v[40:55]
ds_read_b128 v[16:19], v7 offset:32768
ds_read_b64_tr_b16 v[20:21], v13 offset:41472
ds_read_b64_tr_b16 v[22:23], v13 offset:42048
v_mfma_f32_32x32x16_bf16 v[56:71], v[36:39], v[28:31], v[56:71]
ds_read_b64_tr_b16 v[24:25], v14 offset:41472
ds_read_b64_tr_b16 v[26:27], v14 offset:42048
s_waitcnt lgkmcnt(5)
v_mfma_f32_32x32x16_bf16 v[40:55], v[108:111], v[104:107], v[40:55]
ds_read_b128 v[28:31], v8 offset:32768
ds_read_b64_tr_b16 v[32:33], v13 offset:43776
ds_read_b64_tr_b16 v[34:35], v13 offset:44352
v_mfma_f32_32x32x16_bf16 v[56:71], v[112:115], v[104:107], v[56:71]
ds_read_b64_tr_b16 v[36:37], v14 offset:43776
ds_read_b64_tr_b16 v[38:39], v14 offset:44352
s_waitcnt lgkmcnt(5)
s_barrier
v_mfma_f32_32x32x16_bf16 v[40:55], v[20:23], v[16:19], v[40:55]
ds_read_b128 v[104:107], v5 offset:40960
ds_read_b64_tr_b16 v[108:109], v13 offset:46080
ds_read_b64_tr_b16 v[110:111], v13 offset:46656
v_mfma_f32_32x32x16_bf16 v[56:71], v[24:27], v[16:19], v[56:71]
ds_read_b64_tr_b16 v[112:113], v14 offset:46080
ds_read_b64_tr_b16 v[114:115], v14 offset:46656
s_waitcnt lgkmcnt(5)
v_mfma_f32_32x32x16_bf16 v[40:55], v[32:35], v[28:31], v[40:55]
ds_read_b128 v[16:19], v6 offset:40960
ds_read_b64_tr_b16 v[20:21], v13 offset:0
ds_read_b64_tr_b16 v[22:23], v13 offset:576
v_mfma_f32_32x32x16_bf16 v[56:71], v[36:39], v[28:31], v[56:71]
ds_read_b64_tr_b16 v[24:25], v14 offset:0
ds_read_b64_tr_b16 v[26:27], v14 offset:576
s_waitcnt lgkmcnt(5)
v_mfma_f32_32x32x16_bf16 v[40:55], v[108:111], v[104:107], v[40:55]
ds_read_b128 v[28:31], v7 offset:40960
ds_read_b64_tr_b16 v[32:33], v13 offset:2304
ds_read_b64_tr_b16 v[34:35], v13 offset:2880
v_mfma_f32_32x32x16_bf16 v[56:71], v[112:115], v[104:107], v[56:71]
ds_read_b64_tr_b16 v[36:37], v14 offset:2304
ds_read_b64_tr_b16 v[38:39], v14 offset:2880
s_waitcnt lgkmcnt(5)
v_mfma_f32_32x32x16_bf16 v[40:55], v[20:23], v[16:19], v[40:55]
ds_read_b128 v[104:107], v8 offset:40960
ds_read_b64_tr_b16 v[108:109], v13 offset:4608
ds_read_b64_tr_b16 v[110:111], v13 offset:5184
v_mfma_f32_32x32x16_bf16 v[56:71], v[24:27], v[16:19], v[56:71]
ds_read_b64_tr_b16 v[112:113], v14 offset:4608
ds_read_b64_tr_b16 v[114:115], v14 offset:5184
s_waitcnt lgkmcnt(5)
s_barrier
v_mfma_f32_32x32x16_bf16 v[40:55], v[32:35], v[28:31], v[40:55]
ds_read_b128 v[16:19], v5 offset:49152
ds_read_b64_tr_b16 v[20:21], v13 offset:6912
ds_read_b64_tr_b16 v[22:23], v13 offset:7488
v_mfma_f32_32x32x16_bf16 v[56:71], v[36:39], v[28:31], v[56:71]
ds_read_b64_tr_b16 v[24:25], v14 offset:6912
ds_read_b64_tr_b16 v[26:27], v14 offset:7488
s_waitcnt lgkmcnt(5)
v_mfma_f32_32x32x16_bf16 v[40:55], v[108:111], v[104:107], v[40:55]
ds_read_b128 v[28:31], v6 offset:49152
ds_read_b64_tr_b16 v[32:33], v13 offset:9216
ds_read_b64_tr_b16 v[34:35], v13 offset:9792
v_mfma_f32_32x32x16_bf16 v[56:71], v[112:115], v[104:107], v[56:71]
ds_read_b64_tr_b16 v[36:37], v14 offset:9216
ds_read_b64_tr_b16 v[38:39], v14 offset:9792
s_waitcnt lgkmcnt(5)
v_mfma_f32_32x32x16_bf16 v[40:55], v[20:23], v[16:19], v[40:55]
ds_read_b128 v[104:107], v7 offset:49152
ds_read_b64_tr_b16 v[108:109], v13 offset:11520
ds_read_b64_tr_b16 v[110:111], v13 offset:12096
v_mfma_f32_32x32x16_bf16 v[56:71], v[24:27], v[16:19], v[56:71]
ds_read_b64_tr_b16 v[112:113], v14 offset:11520
ds_read_b64_tr_b16 v[114:115], v14 offset:12096
s_waitcnt lgkmcnt(5)
v_mfma_f32_32x32x16_bf16 v[40:55], v[32:35], v[28:31], v[40:55]
ds_read_b128 v[16:19], v8 offset:49152
ds_read_b64_tr_b16 v[20:21], v13 offset:13824
ds_read_b64_tr_b16 v[22:23], v13 offset:14400
v_mfma_f32_32x32x16_bf16 v[56:71], v[36:39], v[28:31], v[56:71]
ds_read_b64_tr_b16 v[24:25], v14 offset:13824
ds_read_b64_tr_b16 v[26:27], v14 offset:14400
s_waitcnt lgkmcnt(5)
s_barrier
v_mfma_f32_32x32x16_bf16 v[40:55], v[108:111], v[104:107], v[40:55]
ds_read_b128 v[28:31], v5 offset:57344
ds_read_b64_tr_b16 v[32:33], v13 offset:16128
ds_read_b64_tr_b16 v[34:35], v13 offset:16704
v_mfma_f32_32x32x16_bf16 v[56:71], v[112:115], v[104:107], v[56:71]
ds_read_b64_tr_b16 v[36:37], v14 offset:16128
ds_read_b64_tr_b16 v[38:39], v14 offset:16704
s_waitcnt lgkmcnt(5)
v_mfma_f32_32x32x16_bf16 v[40:55], v[20:23], v[16:19], v[40:55]
ds_read_b128 v[104:107], v6 offset:57344
ds_read_b64_tr_b16 v[108:109], v13 offset:18432
ds_read_b64_tr_b16 v[110:111], v13 offset:19008
v_mfma_f32_32x32x16_bf16 v[56:71], v[24:27], v[16:19], v[56:71]
ds_read_b64_tr_b16 v[112:113], v14 offset:18432
ds_read_b64_tr_b16 v[114:115], v14 offset:19008
s_waitcnt lgkmcnt(5)
v_mfma_f32_32x32x16_bf16 v[40:55], v[32:35], v[28:31], v[40:55]
ds_read_b128 v[16:19], v7 offset:57344
ds_read_b64_tr_b16 v[20:21], v13 offset:20736
ds_read_b64_tr_b16 v[22:23], v13 offset:21312
v_mfma_f32_32x32x16_bf16 v[56:71], v[36:39], v[28:31], v[56:71]
ds_read_b64_tr_b16 v[24:25], v14 offset:20736
ds_read_b64_tr_b16 v[26:27], v14 offset:21312
s_waitcnt lgkmcnt(5)
v_mfma_f32_32x32x16_bf16 v[40:55], v[108:111], v[104:107], v[40:55]
ds_read_b128 v[28:31], v8 offset:57344
ds_read_b64_tr_b16 v[32:33], v13 offset:23040
ds_read_b64_tr_b16 v[34:35], v13 offset:23616
v_mfma_f32_32x32x16_bf16 v[56:71], v[112:115], v[104:107], v[56:71]
ds_read_b64_tr_b16 v[36:37], v14 offset:23040
ds_read_b64_tr_b16 v[38:39], v14 offset:23616
s_waitcnt lgkmcnt(5)
s_barrier
v_mfma_f32_32x32x16_bf16 v[40:55], v[20:23], v[16:19], v[40:55]
ds_read_b128 v[104:107], v9 offset:0
ds_read_b64_tr_b16 v[108:109], v13 offset:25344
ds_read_b64_tr_b16 v[110:111], v13 offset:25920
v_mfma_f32_32x32x16_bf16 v[56:71], v[24:27], v[16:19], v[56:71]
ds_read_b64_tr_b16 v[112:113], v14 offset:25344
ds_read_b64_tr_b16 v[114:115], v14 offset:25920
s_waitcnt lgkmcnt(5)
v_mfma_f32_32x32x16_bf16 v[40:55], v[32:35], v[28:31], v[40:55]
ds_read_b128 v[16:19], v10 offset:0
ds_read_b64_tr_b16 v[20:21], v13 offset:27648
ds_read_b64_tr_b16 v[22:23], v13 offset:28224
v_mfma_f32_32x32x16_bf16 v[56:71], v[36:39], v[28:31], v[56:71]
ds_read_b64_tr_b16 v[24:25], v14 offset:27648
ds_read_b64_tr_b16 v[26:27], v14 offset:28224
s_waitcnt lgkmcnt(5)
v_mfma_f32_32x32x16_bf16 v[40:55], v[108:111], v[104:107], v[40:55]
ds_read_b128 v[28:31], v11 offset:0
ds_read_b64_tr_b16 v[32:33], v13 offset:29952
ds_read_b64_tr_b16 v[34:35], v13 offset:30528
v_mfma_f32_32x32x16_bf16 v[56:71], v[112:115], v[104:107], v[56:71]
ds_read_b64_tr_b16 v[36:37], v14 offset:29952
ds_read_b64_tr_b16 v[38:39], v14 offset:30528
s_waitcnt lgkmcnt(5)
v_mfma_f32_32x32x16_bf16 v[40:55], v[20:23], v[16:19], v[40:55]
ds_read_b128 v[104:107], v12 offset:0
ds_read_b64_tr_b16 v[108:109], v13 offset:32256
ds_read_b64_tr_b16 v[110:111], v13 offset:32832
v_mfma_f32_32x32x16_bf16 v[56:71], v[24:27], v[16:19], v[56:71]
ds_read_b64_tr_b16 v[112:113], v14 offset:32256
ds_read_b64_tr_b16 v[114:115], v14 offset:32832
s_waitcnt lgkmcnt(5)
s_barrier
v_mfma_f32_32x32x16_bf16 v[40:55], v[32:35], v[28:31], v[40:55]
v_mfma_f32_32x32x16_bf16 v[56:71], v[36:39], v[28:31], v[56:71]
s_waitcnt lgkmcnt(0)
v_mfma_f32_32x32x16_bf16 v[40:55], v[108:111], v[104:107], v[40:55]
v_mfma_f32_32x32x16_bf16 v[56:71], v[112:115], v[104:107], v[56:71]
s_nop 7
s_nop 3
s_cmp_eq_u32 s29, 1
s_cbranch_scc1 ss_j1_5
v_cvt_pk_bf16_f32 v104, v40, v41
v_cvt_pk_bf16_f32 v105, v42, v43
v_cvt_pk_bf16_f32 v106, v44, v45
v_cvt_pk_bf16_f32 v107, v46, v47
v_cvt_pk_bf16_f32 v108, v48, v49
v_cvt_pk_bf16_f32 v109, v50, v51
v_cvt_pk_bf16_f32 v110, v52, v53
v_cvt_pk_bf16_f32 v111, v54, v55
v_cvt_pk_bf16_f32 v112, v56, v57
v_cvt_pk_bf16_f32 v113, v58, v59
v_cvt_pk_bf16_f32 v114, v60, v61
v_cvt_pk_bf16_f32 v115, v62, v63
s_branch ss_end_6
ss_j1_5:
v_cvt_pk_bf16_f32 v108, v40, v41
v_cvt_pk_bf16_f32 v109, v42, v43
v_cvt_pk_bf16_f32 v110, v44, v45
v_cvt_pk_bf16_f32 v111, v46, v47
v_cvt_pk_bf16_f32 v112, v48, v49
v_cvt_pk_bf16_f32 v113, v50, v51
v_cvt_pk_bf16_f32 v114, v52, v53
v_cvt_pk_bf16_f32 v115, v54, v55
v_cvt_pk_bf16_f32 v104, v56, v57
v_cvt_pk_bf16_f32 v105, v58, v59
v_cvt_pk_bf16_f32 v106, v60, v61
v_cvt_pk_bf16_f32 v107, v62, v63
ss_end_6:
s_nop 1
v_mfma_f32_32x32x16_bf16 v[88:103], v[72:75], v[104:107], 0
v_mfma_f32_32x32x16_bf16 v[40:55], v[80:83], v[108:111], 0
s_barrier
v_mfma_f32_32x32x16_bf16 v[88:103], v[76:79], v[108:111], v[88:103]
v_mfma_f32_32x32x16_bf16 v[40:55], v[84:87], v[112:115], v[40:55]
s_nop 7
s_nop 3
v_max3_f32 v148, v88, v89, v90
v_min3_f32 v149, v88, v89, v90
v_max3_f32 v148, v148, v91, v92
v_min3_f32 v149, v149, v91, v92
v_max3_f32 v148, v148, v93, v94
v_min3_f32 v149, v149, v93, v94
v_max3_f32 v148, v148, v95, v96
v_min3_f32 v149, v149, v95, v96
v_mov_b32 v150, v148
v_mov_b32 v151, v149
s_nop 1
v_permlane32_swap_b32 v148, v150
v_permlane32_swap_b32 v149, v151
s_nop 0
v_max_f32 v148, v148, v150
v_min_f32 v149, v149, v151
v_mul_f32 v152, v160, v148
v_mul_f32 v153, v160, v149
v_fma_f32 v118, v88, v160, -v152
v_fma_f32 v128, -v88, v160, v153
v_fma_f32 v119, v89, v160, -v152
v_fma_f32 v129, -v89, v160, v153
v_fma_f32 v120, v90, v160, -v152
v_fma_f32 v130, -v90, v160, v153
s_barrier
v_exp_f32 v118, v118
v_exp_f32 v128, v128
v_exp_f32 v119, v119
v_exp_f32 v129, v129
v_exp_f32 v120, v120
v_exp_f32 v130, v130
v_fma_f32 v121, v91, v160, -v152
v_fma_f32 v131, -v91, v160, v153
v_fma_f32 v122, v92, v160, -v152
v_fma_f32 v132, -v92, v160, v153
v_fma_f32 v123, v93, v160, -v152
v_fma_f32 v133, -v93, v160, v153
v_exp_f32 v121, v121
v_exp_f32 v131, v131
v_exp_f32 v122, v122
v_exp_f32 v132, v132
v_exp_f32 v123, v123
v_exp_f32 v133, v133
v_fma_f32 v124, v94, v160, -v152
v_fma_f32 v134, -v94, v160, v153
v_fma_f32 v125, v95, v160, -v152
v_fma_f32 v135, -v95, v160, v153
v_fma_f32 v126, v96, v160, -v152
v_fma_f32 v136, -v96, v160, v153
v_exp_f32 v124, v124
v_exp_f32 v134, v134
s_barrier
v_exp_f32 v125, v125
v_exp_f32 v135, v135
v_exp_f32 v126, v126
v_exp_f32 v136, v136
s_nop 0
v_add_f32 v154, v118, v119
v_add_f32 v155, v128, v129
v_add_f32 v156, v120, v121
v_add_f32 v157, v130, v131
v_add_f32 v154, v154, v122
v_add_f32 v155, v155, v132
v_add_f32 v156, v156, v123
v_add_f32 v157, v157, v133
v_add_f32 v154, v154, v124
v_add_f32 v155, v155, v134
v_add_f32 v156, v156, v125
v_add_f32 v157, v157, v135
v_add_f32 v154, v154, v126
v_add_f32 v155, v155, v136
v_add_f32 v154, v154, v156
v_add_f32 v155, v155, v157
v_mov_b32 v150, v154
v_mov_b32 v151, v155
s_nop 1
v_permlane32_swap_b32 v154, v150
v_permlane32_swap_b32 v155, v151
s_nop 0
v_add_f32 v154, v154, v150
v_add_f32 v155, v155, v151
v_rcp_f32 v154, v154
v_rcp_f32 v155, v155
s_nop 0
v_mul_f32 v118, v118, v154
v_mul_f32 v119, v119, v154
v_mul_f32 v128, v128, v155
s_barrier
v_mul_f32 v129, v129, v155
v_cvt_pk_bf16_f32 v138, v118, v119
v_cvt_pk_bf16_f32 v142, v128, v129
v_mul_f32 v120, v120, v154
v_mul_f32 v121, v121, v154
v_mul_f32 v130, v130, v155
v_mul_f32 v131, v131, v155
v_cvt_pk_bf16_f32 v139, v120, v121
v_cvt_pk_bf16_f32 v143, v130, v131
v_mul_f32 v122, v122, v154
v_mul_f32 v123, v123, v154
v_mul_f32 v132, v132, v155
v_mul_f32 v133, v133, v155
v_cvt_pk_bf16_f32 v140, v122, v123
v_cvt_pk_bf16_f32 v144, v132, v133
v_mul_f32 v124, v124, v154
v_mul_f32 v125, v125, v154
v_mul_f32 v134, v134, v155
v_mul_f32 v135, v135, v155
v_cvt_pk_bf16_f32 v141, v124, v125
v_cvt_pk_bf16_f32 v145, v134, v135
v_mul_f32 v126, v126, v154
v_mul_f32 v136, v136, v155
v_cvt_pk_bf16_f32 v146, v126, v136
ds_write_b64 v15, v[138:139] offset:0
ds_write_b64 v15, v[140:141] offset:16
ds_write_b64 v15, v[142:143] offset:32
ds_write_b64 v15, v[144:145] offset:48
ds_write_b64 v15, v[146:147] offset:64
v_max3_f32 v148, v40, v41, v42
v_min3_f32 v149, v40, v41, v42
v_max3_f32 v148, v148, v43, v44
v_min3_f32 v149, v149, v43, v44
v_max3_f32 v148, v148, v45, v46
v_min3_f32 v149, v149, v45, v46
v_max3_f32 v148, v148, v47, v48
v_min3_f32 v149, v149, v47, v48
v_mov_b32 v150, v148
v_mov_b32 v151, v149
s_nop 1
v_permlane32_swap_b32 v148, v150
s_barrier
v_permlane32_swap_b32 v149, v151
s_nop 0
v_max_f32 v148, v148, v150
v_min_f32 v149, v149, v151
v_mul_f32 v152, v160, v148
v_mul_f32 v153, v160, v149
v_fma_f32 v118, v40, v160, -v152
v_fma_f32 v128, -v40, v160, v153
v_fma_f32 v119, v41, v160, -v152
v_fma_f32 v129, -v41, v160, v153
v_fma_f32 v120, v42, v160, -v152
v_fma_f32 v130, -v42, v160, v153
v_exp_f32 v118, v118
v_exp_f32 v128, v128
v_exp_f32 v119, v119
v_exp_f32 v129, v129
v_exp_f32 v120, v120
v_exp_f32 v130, v130
v_fma_f32 v121, v43, v160, -v152
v_fma_f32 v131, -v43, v160, v153
v_fma_f32 v122, v44, v160, -v152
v_fma_f32 v132, -v44, v160, v153
v_fma_f32 v123, v45, v160, -v152
v_fma_f32 v133, -v45, v160, v153
v_exp_f32 v121, v121
v_exp_f32 v131, v131
v_exp_f32 v122, v122
v_exp_f32 v132, v132
v_exp_f32 v123, v123
s_barrier
v_exp_f32 v133, v133
v_fma_f32 v124, v46, v160, -v152
v_fma_f32 v134, -v46, v160, v153
v_fma_f32 v125, v47, v160, -v152
v_fma_f32 v135, -v47, v160, v153
v_fma_f32 v126, v48, v160, -v152
v_fma_f32 v136, -v48, v160, v153
v_exp_f32 v124, v124
v_exp_f32 v134, v134
v_exp_f32 v125, v125
v_exp_f32 v135, v135
v_exp_f32 v126, v126
v_exp_f32 v136, v136
s_nop 0
v_add_f32 v154, v118, v119
v_add_f32 v155, v128, v129
v_add_f32 v156, v120, v121
v_add_f32 v157, v130, v131
v_add_f32 v154, v154, v122
v_add_f32 v155, v155, v132
v_add_f32 v156, v156, v123
v_add_f32 v157, v157, v133
v_add_f32 v154, v154, v124
v_add_f32 v155, v155, v134
v_add_f32 v156, v156, v125
v_add_f32 v157, v157, v135
v_add_f32 v154, v154, v126
v_add_f32 v155, v155, v136
v_add_f32 v154, v154, v156
v_add_f32 v155, v155, v157
v_mov_b32 v150, v154
v_mov_b32 v151, v155
s_nop 1
v_permlane32_swap_b32 v154, v150
s_barrier
v_permlane32_swap_b32 v155, v151
s_nop 0
v_add_f32 v154, v154, v150
v_add_f32 v155, v155, v151
v_rcp_f32 v154, v154
v_rcp_f32 v155, v155
s_nop 0
v_mul_f32 v118, v118, v154
v_mul_f32 v119, v119, v154
v_mul_f32 v128, v128, v155
v_mul_f32 v129, v129, v155
v_cvt_pk_bf16_f32 v138, v118, v119
v_cvt_pk_bf16_f32 v142, v128, v129
v_mul_f32 v120, v120, v154
v_mul_f32 v121, v121, v154
v_mul_f32 v130, v130, v155
v_mul_f32 v131, v131, v155
v_cvt_pk_bf16_f32 v139, v120, v121
v_cvt_pk_bf16_f32 v143, v130, v131
v_mul_f32 v122, v122, v154
v_mul_f32 v123, v123, v154
v_mul_f32 v132, v132, v155
v_mul_f32 v133, v133, v155
v_cvt_pk_bf16_f32 v140, v122, v123
v_cvt_pk_bf16_f32 v144, v132, v133
v_mul_f32 v124, v124, v154
v_mul_f32 v125, v125, v154
v_mul_f32 v134, v134, v155
v_mul_f32 v135, v135, v155
v_cvt_pk_bf16_f32 v141, v124, v125
v_cvt_pk_bf16_f32 v145, v134, v135
v_mul_f32 v126, v126, v154
v_mul_f32 v136, v136, v155
v_cvt_pk_bf16_f32 v146, v126, v136
ds_write_b64 v15, v[138:139] offset:80
ds_write_b64 v15, v[140:141] offset:96
ds_write_b64 v15, v[142:143] offset:112
ds_write_b64 v15, v[144:145] offset:128
ds_write_b64 v15, v[146:147] offset:144
s_barrier
s_and_b32 s31, s24, 3
s_mul_i32 s32, s31, 48
v_mul_u32_u24 v16, 200, v1
s_add_u32 s32, s32, 143104
v_add_u32 v16, s32, v16
v_mov_b32 v18, 0x3f80
v_mov_b32 v19, 0
ds_write_b32 v16, v18 offset:36
ds_write_b64 v16, v[18:19] offset:40
s_waitcnt lgkmcnt(0)
v_and_b32 v116, 31, v1
v_lshlrev_b32 v3, 4, v116
v_lshrrev_b32 v117, 5, v1
v_min_u32 v116, 19, v116
v_mul_u32_u24 v117, 20, v117
v_add_u32 v116, v116, v117
v_lshlrev_b32 v116, 4, v116
v_lshlrev_b32 v2, 4, v1
s_lshl_b32 s31, s26, 2
s_lshl_b32 s32, s29, 1
s_add_u32 s31, s31, s32
s_mul_i32 s40, s31, 1920
s_add_u32 s40, s40, 7340032
s_mul_i32 s41, s25, 73728
s_add_u32 s41, s41, 0
s_lshl_b32 s31, s30, 10
s_add_u32 s41, s41, s31
s_lshr_b32 s31, s26, 1
s_lshl_b32 s32, s31, 11
s_add_u32 s42, s41, s32
s_and_b32 s32, s26, 1
s_lshl_b32 s33, s32, 9
s_add_u32 s42, s42, s33
s_lshl_b32 s33, s29, 3
s_add_u32 s42, s42, s33
s_add_u32 s42, s42, 65536
s_lshl_b32 s32, s32, 15
s_add_u32 s41, s41, s32
s_lshl_b32 s31, s31, 13
s_add_u32 s41, s41, s31
s_lshl_b32 s31, s29, 12
s_add_u32 s41, s41, s31
s_barrier
s_lshl_b32 s31, s24, 2
s_add_u32 s31, s31, 163808
v_mov_b32 v161, s31
v_mov_b32 v162, 163800
ds_read_b128 v[16:19], v5 offset:0
ds_read_b64_tr_b16 v[20:21], v13 offset:20736
ds_read_b64_tr_b16 v[22:23], v13 offset:21312
ds_read_b64_tr_b16 v[24:25], v14 offset:20736
ds_read_b64_tr_b16 v[26:27], v14 offset:21312
ds_read_b128 v[28:31], v6 offset:0
ds_read_b64_tr_b16 v[32:33], v13 offset:23040
ds_read_b64_tr_b16 v[34:35], v13 offset:23616
ds_read_b64_tr_b16 v[36:37], v14 offset:23040
ds_read_b64_tr_b16 v[38:39], v14 offset:23616
s_waitcnt lgkmcnt(5)
v_mfma_f32_32x32x16_bf16 v[40:55], v[20:23], v[16:19], 0
ds_read_b128 v[104:107], v7 offset:0
ds_read_b64_tr_b16 v[108:109], v13 offset:25344
ds_read_b64_tr_b16 v[110:111], v13 offset:25920
v_mfma_f32_32x32x16_bf16 v[56:71], v[24:27], v[16:19], 0
ds_read_b64_tr_b16 v[112:113], v14 offset:25344
ds_read_b64_tr_b16 v[114:115], v14 offset:25920
s_waitcnt lgkmcnt(5)
v_mfma_f32_32x32x16_bf16 v[40:55], v[32:35], v[28:31], v[40:55]
ds_read_b64 v[164:165], v162
ds_read_b128 v[16:19], v8 offset:0
ds_read_b64_tr_b16 v[20:21], v13 offset:27648
ds_read_b64_tr_b16 v[22:23], v13 offset:28224
v_mfma_f32_32x32x16_bf16 v[56:71], v[36:39], v[28:31], v[56:71]
ds_read_b64_tr_b16 v[24:25], v14 offset:27648
ds_read_b64_tr_b16 v[26:27], v14 offset:28224
s_waitcnt lgkmcnt(5)
v_mov_b32 v163, 18
s_mov_b64 exec, 1
ds_write_b32 v161, v163
s_mov_b64 exec, -1
s_setprio 2
v_min_u32 v164, v164, v165
v_cmp_le_u32 vcc, 19, v164
s_cbranch_vccnz qk_8
s_mov_b64 s[6:7], exec
s_mov_b64 exec, 1
v_mov_b32 v162, 163800
s_mov_b32 s31, 65536
lw_9:
ds_read_b64 v[164:165], v162
s_sub_u32 s31, s31, 1
s_cbranch_scc1 lx_10
s_waitcnt lgkmcnt(0)
v_min_u32 v164, v164, v165
v_cmp_le_u32 vcc, 19, v164
s_cbranch_vccz lw_9
lx_10:
s_waitcnt lgkmcnt(0)
s_mov_b64 exec, s[6:7]
qk_8:
v_mfma_f32_32x32x16_bf16 v[40:55], v[108:111], v[104:107], v[40:55]
ds_read_b128 v[28:31], v5 offset:8192
ds_read_b64_tr_b16 v[32:33], v13 offset:29952
ds_read_b64_tr_b16 v[34:35], v13 offset:30528
v_mfma_f32_32x32x16_bf16 v[56:71], v[112:115], v[104:107], v[56:71]
ds_read_b64_tr_b16 v[36:37], v14 offset:29952
ds_read_b64_tr_b16 v[38:39], v14 offset:30528
s_waitcnt lgkmcnt(5)
v_mfma_f32_32x32x16_bf16 v[40:55], v[20:23], v[16:19], v[40:55]
ds_read_b128 v[104:107], v6 offset:8192
ds_read_b64_tr_b16 v[108:109], v13 offset:32256
ds_read_b64_tr_b16 v[110:111], v13 offset:32832
v_mfma_f32_32x32x16_bf16 v[56:71], v[24:27], v[16:19], v[56:71]
ds_read_b64_tr_b16 v[112:113], v14 offset:32256
ds_read_b64_tr_b16 v[114:115], v14 offset:32832
s_waitcnt lgkmcnt(5)
v_mfma_f32_32x32x16_bf16 v[40:55], v[32:35], v[28:31], v[40:55]
ds_read_b128 v[16:19], v7 offset:8192
ds_read_b64_tr_b16 v[20:21], v13 offset:34560
ds_read_b64_tr_b16 v[22:23], v13 offset:35136
v_mfma_f32_32x32x16_bf16 v[56:71], v[36:39], v[28:31], v[56:71]
ds_read_b64_tr_b16 v[24:25], v14 offset:34560
ds_read_b64_tr_b16 v[26:27], v14 offset:35136
s_waitcnt lgkmcnt(5)
v_mfma_f32_32x32x16_bf16 v[40:55], v[108:111], v[104:107], v[40:55]
ds_read_b64 v[164:165], v162
ds_read_b128 v[28:31], v8 offset:8192
ds_read_b64_tr_b16 v[32:33], v13 offset:36864
ds_read_b64_tr_b16 v[34:35], v13 offset:37440
v_mfma_f32_32x32x16_bf16 v[56:71], v[112:115], v[104:107], v[56:71]
ds_read_b64_tr_b16 v[36:37], v14 offset:36864
ds_read_b64_tr_b16 v[38:39], v14 offset:37440
s_waitcnt lgkmcnt(5)
v_mov_b32 v163, 19
s_mov_b64 exec, 1
ds_write_b32 v161, v163
s_mov_b64 exec, -1
v_min_u32 v164, v164, v165
v_cmp_le_u32 vcc, 20, v164
s_cbranch_vccnz qk_12
s_mov_b64 s[6:7], exec
s_mov_b64 exec, 1
v_mov_b32 v162, 163800
s_mov_b32 s31, 65536
lw_13:
ds_read_b64 v[164:165], v162
s_sub_u32 s31, s31, 1
s_cbranch_scc1 lx_14
s_waitcnt lgkmcnt(0)
v_min_u32 v164, v164, v165
v_cmp_le_u32 vcc, 20, v164
s_cbranch_vccz lw_13
lx_14:
s_waitcnt lgkmcnt(0)
s_mov_b64 exec, s[6:7]
qk_12:
v_mfma_f32_32x32x16_bf16 v[40:55], v[20:23], v[16:19], v[40:55]
ds_read_b128 v[104:107], v5 offset:16384
ds_read_b64_tr_b16 v[108:109], v13 offset:39168
ds_read_b64_tr_b16 v[110:111], v13 offset:39744
v_mfma_f32_32x32x16_bf16 v[56:71], v[24:27], v[16:19], v[56:71]
ds_read_b64_tr_b16 v[112:113], v14 offset:39168
ds_read_b64_tr_b16 v[114:115], v14 offset:39744
s_waitcnt lgkmcnt(5)
v_mfma_f32_32x32x16_bf16 v[40:55], v[32:35], v[28:31], v[40:55]
ds_read_b128 v[16:19], v6 offset:16384
ds_read_b64_tr_b16 v[20:21], v13 offset:41472
ds_read_b64_tr_b16 v[22:23], v13 offset:42048
v_mfma_f32_32x32x16_bf16 v[56:71], v[36:39], v[28:31], v[56:71]
ds_read_b64_tr_b16 v[24:25], v14 offset:41472
ds_read_b64_tr_b16 v[26:27], v14 offset:42048
s_waitcnt lgkmcnt(5)
v_mfma_f32_32x32x16_bf16 v[40:55], v[108:111], v[104:107], v[40:55]
ds_read_b128 v[28:31], v7 offset:16384
ds_read_b64_tr_b16 v[32:33], v13 offset:43776
ds_read_b64_tr_b16 v[34:35], v13 offset:44352
v_mfma_f32_32x32x16_bf16 v[56:71], v[112:115], v[104:107], v[56:71]
ds_read_b64_tr_b16 v[36:37], v14 offset:43776
ds_read_b64_tr_b16 v[38:39], v14 offset:44352
s_waitcnt lgkmcnt(5)
v_mfma_f32_32x32x16_bf16 v[40:55], v[20:23], v[16:19], v[40:55]
ds_read_b64 v[164:165], v162
ds_read_b128 v[104:107], v8 offset:16384
ds_read_b64_tr_b16 v[108:109], v13 offset:46080
ds_read_b64_tr_b16 v[110:111], v13 offset:46656
v_mfma_f32_32x32x16_bf16 v[56:71], v[24:27], v[16:19], v[56:71]
ds_read_b64_tr_b16 v[112:113], v14 offset:46080
ds_read_b64_tr_b16 v[114:115], v14 offset:46656
s_waitcnt lgkmcnt(5)
v_mov_b32 v163, 20
s_mov_b64 exec, 1
ds_write_b32 v161, v163
s_mov_b64 exec, -1
v_min_u32 v164, v164, v165
v_cmp_le_u32 vcc, 21, v164
s_cbranch_vccnz qk_16
s_mov_b64 s[6:7], exec
s_mov_b64 exec, 1
v_mov_b32 v162, 163800
s_mov_b32 s31, 65536
lw_17:
ds_read_b64 v[164:165], v162
s_sub_u32 s31, s31, 1
s_cbranch_scc1 lx_18
s_waitcnt lgkmcnt(0)
v_min_u32 v164, v164, v165
v_cmp_le_u32 vcc, 21, v164
s_cbranch_vccz lw_17
lx_18:
s_waitcnt lgkmcnt(0)
s_mov_b64 exec, s[6:7]
qk_16:
v_mfma_f32_32x32x16_bf16 v[40:55], v[32:35], v[28:31], v[40:55]
ds_read_b128 v[16:19], v5 offset:24576
ds_read_b64_tr_b16 v[20:21], v13 offset:0
ds_read_b64_tr_b16 v[22:23], v13 offset:576
v_mfma_f32_32x32x16_bf16 v[56:71], v[36:39], v[28:31], v[56:71]
ds_read_b64_tr_b16 v[24:25], v14 offset:0
ds_read_b64_tr_b16 v[26:27], v14 offset:576
s_waitcnt lgkmcnt(5)
v_mfma_f32_32x32x16_bf16 v[40:55], v[108:111], v[104:107], v[40:55]
ds_read_b128 v[28:31], v6 offset:24576
ds_read_b64_tr_b16 v[32:33], v13 offset:2304
ds_read_b64_tr_b16 v[34:35], v13 offset:2880
v_mfma_f32_32x32x16_bf16 v[56:71], v[112:115], v[104:107], v[56:71]
ds_read_b64_tr_b16 v[36:37], v14 offset:2304
ds_read_b64_tr_b16 v[38:39], v14 offset:2880
s_waitcnt lgkmcnt(5)
v_mfma_f32_32x32x16_bf16 v[40:55], v[20:23], v[16:19], v[40:55]
ds_read_b128 v[104:107], v7 offset:24576
ds_read_b64_tr_b16 v[108:109], v13 offset:4608
ds_read_b64_tr_b16 v[110:111], v13 offset:5184
v_mfma_f32_32x32x16_bf16 v[56:71], v[24:27], v[16:19], v[56:71]
ds_read_b64_tr_b16 v[112:113], v14 offset:4608
ds_read_b64_tr_b16 v[114:115], v14 offset:5184
s_waitcnt lgkmcnt(5)
v_mfma_f32_32x32x16_bf16 v[40:55], v[32:35], v[28:31], v[40:55]
ds_read_b64 v[164:165], v162
ds_read_b128 v[16:19], v8 offset:24576
ds_read_b64_tr_b16 v[20:21], v13 offset:6912
ds_read_b64_tr_b16 v[22:23], v13 offset:7488
v_mfma_f32_32x32x16_bf16 v[56:71], v[36:39], v[28:31], v[56:71]
ds_read_b64_tr_b16 v[24:25], v14 offset:6912
ds_read_b64_tr_b16 v[26:27], v14 offset:7488
s_waitcnt lgkmcnt(5)
v_mov_b32 v163, 21
s_mov_b64 exec, 1
ds_write_b32 v161, v163
s_mov_b64 exec, -1
v_min_u32 v164, v164, v165
v_cmp_le_u32 vcc, 22, v164
s_cbranch_vccnz qk_20
s_mov_b64 s[6:7], exec
s_mov_b64 exec, 1
v_mov_b32 v162, 163800
s_mov_b32 s31, 65536
lw_21:
ds_read_b64 v[164:165], v162
s_sub_u32 s31, s31, 1
s_cbranch_scc1 lx_22
s_waitcnt lgkmcnt(0)
v_min_u32 v164, v164, v165
v_cmp_le_u32 vcc, 22, v164
s_cbranch_vccz lw_21
lx_22:
s_waitcnt lgkmcnt(0)
s_mov_b64 exec, s[6:7]
qk_20:
v_mfma_f32_32x32x16_bf16 v[40:55], v[108:111], v[104:107], v[40:55]
ds_read_b128 v[28:31], v5 offset:32768
ds_read_b64_tr_b16 v[32:33], v13 offset:9216
ds_read_b64_tr_b16 v[34:35], v13 offset:9792
v_mfma_f32_32x32x16_bf16 v[56:71], v[112:115], v[104:107], v[56:71]
ds_read_b64_tr_b16 v[36:37], v14 offset:9216
ds_read_b64_tr_b16 v[38:39], v14 offset:9792
s_waitcnt lgkmcnt(5)
v_mfma_f32_32x32x16_bf16 v[40:55], v[20:23], v[16:19], v[40:55]
ds_read_b128 v[104:107], v6 offset:32768
ds_read_b64_tr_b16 v[108:109], v13 offset:11520
ds_read_b64_tr_b16 v[110:111], v13 offset:12096
v_mfma_f32_32x32x16_bf16 v[56:71], v[24:27], v[16:19], v[56:71]
ds_read_b64_tr_b16 v[112:113], v14 offset:11520
ds_read_b64_tr_b16 v[114:115], v14 offset:12096
s_waitcnt lgkmcnt(5)
v_mfma_f32_32x32x16_bf16 v[40:55], v[32:35], v[28:31], v[40:55]
ds_read_b128 v[16:19], v7 offset:32768
ds_read_b64_tr_b16 v[20:21], v13 offset:13824
ds_read_b64_tr_b16 v[22:23], v13 offset:14400
v_mfma_f32_32x32x16_bf16 v[56:71], v[36:39], v[28:31], v[56:71]
ds_read_b64_tr_b16 v[24:25], v14 offset:13824
ds_read_b64_tr_b16 v[26:27], v14 offset:14400
s_waitcnt lgkmcnt(5)
v_mfma_f32_32x32x16_bf16 v[40:55], v[108:111], v[104:107], v[40:55]
ds_read_b64 v[164:165], v162
ds_read_b128 v[28:31], v8 offset:32768
ds_read_b64_tr_b16 v[32:33], v13 offset:16128
ds_read_b64_tr_b16 v[34:35], v13 offset:16704
v_mfma_f32_32x32x16_bf16 v[56:71], v[112:115], v[104:107], v[56:71]
ds_read_b64_tr_b16 v[36:37], v14 offset:16128
ds_read_b64_tr_b16 v[38:39], v14 offset:16704
s_waitcnt lgkmcnt(5)
v_mov_b32 v163, 22
s_mov_b64 exec, 1
ds_write_b32 v161, v163
s_mov_b64 exec, -1
v_min_u32 v164, v164, v165
v_cmp_le_u32 vcc, 23, v164
s_cbranch_vccnz qk_24
s_mov_b64 s[6:7], exec
s_mov_b64 exec, 1
v_mov_b32 v162, 163800
s_mov_b32 s31, 65536
lw_25:
ds_read_b64 v[164:165], v162
s_sub_u32 s31, s31, 1
s_cbranch_scc1 lx_26
s_waitcnt lgkmcnt(0)
v_min_u32 v164, v164, v165
v_cmp_le_u32 vcc, 23, v164
s_cbranch_vccz lw_25
lx_26:
s_waitcnt lgkmcnt(0)
s_mov_b64 exec, s[6:7]
qk_24:
v_mfma_f32_32x32x16_bf16 v[40:55], v[20:23], v[16:19], v[40:55]
ds_read_b128 v[104:107], v5 offset:40960
ds_read_b64_tr_b16 v[108:109], v13 offset:18432
ds_read_b64_tr_b16 v[110:111], v13 offset:19008
v_mfma_f32_32x32x16_bf16 v[56:71], v[24:27], v[16:19], v[56:71]
ds_read_b64_tr_b16 v[112:113], v14 offset:18432
ds_read_b64_tr_b16 v[114:115], v14 offset:19008
s_waitcnt lgkmcnt(5)
v_mfma_f32_32x32x16_bf16 v[40:55], v[32:35], v[28:31], v[40:55]
ds_read_b128 v[16:19], v6 offset:40960
ds_read_b64_tr_b16 v[20:21], v13 offset:20736
ds_read_b64_tr_b16 v[22:23], v13 offset:21312
v_mfma_f32_32x32x16_bf16 v[56:71], v[36:39], v[28:31], v[56:71]
ds_read_b64_tr_b16 v[24:25], v14 offset:20736
ds_read_b64_tr_b16 v[26:27], v14 offset:21312
s_waitcnt lgkmcnt(5)
v_mfma_f32_32x32x16_bf16 v[40:55], v[108:111], v[104:107], v[40:55]
ds_read_b128 v[28:31], v7 offset:40960
ds_read_b64_tr_b16 v[32:33], v13 offset:23040
ds_read_b64_tr_b16 v[34:35], v13 offset:23616
v_mfma_f32_32x32x16_bf16 v[56:71], v[112:115], v[104:107], v[56:71]
ds_read_b64_tr_b16 v[36:37], v14 offset:23040
ds_read_b64_tr_b16 v[38:39], v14 offset:23616
s_waitcnt lgkmcnt(5)
v_mfma_f32_32x32x16_bf16 v[40:55], v[20:23], v[16:19], v[40:55]
ds_read_b64 v[164:165], v162
ds_read_b128 v[104:107], v8 offset:40960
ds_read_b64_tr_b16 v[108:109], v13 offset:25344
ds_read_b64_tr_b16 v[110:111], v13 offset:25920
v_mfma_f32_32x32x16_bf16 v[56:71], v[24:27], v[16:19], v[56:71]
ds_read_b64_tr_b16 v[112:113], v14 offset:25344
ds_read_b64_tr_b16 v[114:115], v14 offset:25920
s_waitcnt lgkmcnt(5)
v_min_u32 v164, v164, v165
v_cmp_le_u32 vcc, 24, v164
s_cbranch_vccnz qk_28
s_mov_b64 s[6:7], exec
s_mov_b64 exec, 1
v_mov_b32 v162, 163800
s_mov_b32 s31, 65536
lw_29:
ds_read_b64 v[164:165], v162
s_sub_u32 s31, s31, 1
s_cbranch_scc1 lx_30
s_waitcnt lgkmcnt(0)
v_min_u32 v164, v164, v165
v_cmp_le_u32 vcc, 24, v164
s_cbranch_vccz lw_29
lx_30:
s_waitcnt lgkmcnt(0)
s_mov_b64 exec, s[6:7]
qk_28:
v_mfma_f32_32x32x16_bf16 v[40:55], v[32:35], v[28:31], v[40:55]
ds_read_b128 v[16:19], v5 offset:49152
ds_read_b64_tr_b16 v[20:21], v13 offset:27648
ds_read_b64_tr_b16 v[22:23], v13 offset:28224
v_mfma_f32_32x32x16_bf16 v[56:71], v[36:39], v[28:31], v[56:71]
ds_read_b64_tr_b16 v[24:25], v14 offset:27648
ds_read_b64_tr_b16 v[26:27], v14 offset:28224
s_waitcnt lgkmcnt(5)
v_mfma_f32_32x32x16_bf16 v[40:55], v[108:111], v[104:107], v[40:55]
ds_read_b128 v[28:31], v6 offset:49152
ds_read_b64_tr_b16 v[32:33], v13 offset:29952
ds_read_b64_tr_b16 v[34:35], v13 offset:30528
v_mfma_f32_32x32x16_bf16 v[56:71], v[112:115], v[104:107], v[56:71]
ds_read_b64_tr_b16 v[36:37], v14 offset:29952
ds_read_b64_tr_b16 v[38:39], v14 offset:30528
s_waitcnt lgkmcnt(5)
v_mfma_f32_32x32x16_bf16 v[40:55], v[20:23], v[16:19], v[40:55]
ds_read_b128 v[104:107], v7 offset:49152
ds_read_b64_tr_b16 v[108:109], v13 offset:32256
ds_read_b64_tr_b16 v[110:111], v13 offset:32832
v_mfma_f32_32x32x16_bf16 v[56:71], v[24:27], v[16:19], v[56:71]
ds_read_b64_tr_b16 v[112:113], v14 offset:32256
ds_read_b64_tr_b16 v[114:115], v14 offset:32832
s_waitcnt lgkmcnt(5)
v_mfma_f32_32x32x16_bf16 v[40:55], v[32:35], v[28:31], v[40:55]
ds_read_b64 v[164:165], v162
ds_read_b128 v[16:19], v8 offset:49152
ds_read_b64_tr_b16 v[20:21], v13 offset:34560
ds_read_b64_tr_b16 v[22:23], v13 offset:35136
v_mfma_f32_32x32x16_bf16 v[56:71], v[36:39], v[28:31], v[56:71]
ds_read_b64_tr_b16 v[24:25], v14 offset:34560
ds_read_b64_tr_b16 v[26:27], v14 offset:35136
s_waitcnt lgkmcnt(5)
v_min_u32 v164, v164, v165
v_cmp_le_u32 vcc, 25, v164
s_cbranch_vccnz qk_32
s_mov_b64 s[6:7], exec
s_mov_b64 exec, 1
v_mov_b32 v162, 163800
s_mov_b32 s31, 65536
lw_33:
ds_read_b64 v[164:165], v162
s_sub_u32 s31, s31, 1
s_cbranch_scc1 lx_34
s_waitcnt lgkmcnt(0)
v_min_u32 v164, v164, v165
v_cmp_le_u32 vcc, 25, v164
s_cbranch_vccz lw_33
lx_34:
s_waitcnt lgkmcnt(0)
s_mov_b64 exec, s[6:7]
qk_32:
v_mfma_f32_32x32x16_bf16 v[40:55], v[108:111], v[104:107], v[40:55]
ds_read_b128 v[28:31], v5 offset:57344
ds_read_b64_tr_b16 v[32:33], v13 offset:36864
ds_read_b64_tr_b16 v[34:35], v13 offset:37440
v_mfma_f32_32x32x16_bf16 v[56:71], v[112:115], v[104:107], v[56:71]
ds_read_b64_tr_b16 v[36:37], v14 offset:36864
ds_read_b64_tr_b16 v[38:39], v14 offset:37440
s_waitcnt lgkmcnt(5)
v_mfma_f32_32x32x16_bf16 v[40:55], v[20:23], v[16:19], v[40:55]
ds_read_b128 v[104:107], v6 offset:57344
ds_read_b64_tr_b16 v[108:109], v13 offset:39168
ds_read_b64_tr_b16 v[110:111], v13 offset:39744
v_mfma_f32_32x32x16_bf16 v[56:71], v[24:27], v[16:19], v[56:71]
ds_read_b64_tr_b16 v[112:113], v14 offset:39168
ds_read_b64_tr_b16 v[114:115], v14 offset:39744
s_waitcnt lgkmcnt(5)
v_mfma_f32_32x32x16_bf16 v[40:55], v[32:35], v[28:31], v[40:55]
ds_read_b128 v[16:19], v7 offset:57344
ds_read_b64_tr_b16 v[20:21], v13 offset:41472
ds_read_b64_tr_b16 v[22:23], v13 offset:42048
v_mfma_f32_32x32x16_bf16 v[56:71], v[36:39], v[28:31], v[56:71]
ds_read_b64_tr_b16 v[24:25], v14 offset:41472
ds_read_b64_tr_b16 v[26:27], v14 offset:42048
s_waitcnt lgkmcnt(5)
v_mfma_f32_32x32x16_bf16 v[40:55], v[108:111], v[104:107], v[40:55]
ds_read_b64 v[164:165], v162
ds_read_b128 v[28:31], v8 offset:57344
ds_read_b64_tr_b16 v[32:33], v13 offset:43776
ds_read_b64_tr_b16 v[34:35], v13 offset:44352
v_mfma_f32_32x32x16_bf16 v[56:71], v[112:115], v[104:107], v[56:71]
ds_read_b64_tr_b16 v[36:37], v14 offset:43776
ds_read_b64_tr_b16 v[38:39], v14 offset:44352
s_waitcnt lgkmcnt(5)
v_min_u32 v164, v164, v165
v_cmp_le_u32 vcc, 26, v164
s_cbranch_vccnz qk_36
s_mov_b64 s[6:7], exec
s_mov_b64 exec, 1
v_mov_b32 v162, 163800
s_mov_b32 s31, 65536
lw_37:
ds_read_b64 v[164:165], v162
s_sub_u32 s31, s31, 1
s_cbranch_scc1 lx_38
s_waitcnt lgkmcnt(0)
v_min_u32 v164, v164, v165
v_cmp_le_u32 vcc, 26, v164
s_cbranch_vccz lw_37
lx_38:
s_waitcnt lgkmcnt(0)
s_mov_b64 exec, s[6:7]
qk_36:
v_mfma_f32_32x32x16_bf16 v[40:55], v[20:23], v[16:19], v[40:55]
ds_read_b128 v[104:107], v9 offset:0
ds_read_b64_tr_b16 v[108:109], v13 offset:46080
ds_read_b64_tr_b16 v[110:111], v13 offset:46656
v_mfma_f32_32x32x16_bf16 v[56:71], v[24:27], v[16:19], v[56:71]
ds_read_b64_tr_b16 v[112:113], v14 offset:46080
ds_read_b64_tr_b16 v[114:115], v14 offset:46656
s_waitcnt lgkmcnt(5)
v_mfma_f32_32x32x16_bf16 v[40:55], v[32:35], v[28:31], v[40:55]
ds_read_b128 v[16:19], v10 offset:0
ds_read_b64_tr_b16 v[20:21], v13 offset:0
ds_read_b64_tr_b16 v[22:23], v13 offset:576
v_mfma_f32_32x32x16_bf16 v[56:71], v[36:39], v[28:31], v[56:71]
ds_read_b64_tr_b16 v[24:25], v14 offset:0
ds_read_b64_tr_b16 v[26:27], v14 offset:576
s_waitcnt lgkmcnt(5)
v_mfma_f32_32x32x16_bf16 v[40:55], v[108:111], v[104:107], v[40:55]
ds_read_b128 v[28:31], v11 offset:0
ds_read_b64_tr_b16 v[32:33], v13 offset:2304
ds_read_b64_tr_b16 v[34:35], v13 offset:2880
v_mfma_f32_32x32x16_bf16 v[56:71], v[112:115], v[104:107], v[56:71]
ds_read_b64_tr_b16 v[36:37], v14 offset:2304
ds_read_b64_tr_b16 v[38:39], v14 offset:2880
s_waitcnt lgkmcnt(5)
v_mfma_f32_32x32x16_bf16 v[40:55], v[20:23], v[16:19], v[40:55]
ds_read_b128 v[104:107], v12 offset:0
ds_read_b64_tr_b16 v[108:109], v13 offset:4608
ds_read_b64_tr_b16 v[110:111], v13 offset:5184
v_mfma_f32_32x32x16_bf16 v[56:71], v[24:27], v[16:19], v[56:71]
ds_read_b64_tr_b16 v[112:113], v14 offset:4608
ds_read_b64_tr_b16 v[114:115], v14 offset:5184
s_waitcnt lgkmcnt(5)
v_mfma_f32_32x32x16_bf16 v[40:55], v[32:35], v[28:31], v[40:55]
v_mfma_f32_32x32x16_bf16 v[56:71], v[36:39], v[28:31], v[56:71]
s_waitcnt lgkmcnt(0)
v_mov_b32 v163, 64
s_mov_b64 exec, 1
ds_write_b32 v161, v163
s_mov_b64 exec, -1
v_mfma_f32_32x32x16_bf16 v[40:55], v[108:111], v[104:107], v[40:55]
v_mfma_f32_32x32x16_bf16 v[56:71], v[112:115], v[104:107], v[56:71]
s_nop 7
s_nop 3
s_cmp_eq_u32 s29, 1
s_cbranch_scc1 ss_j1_39
v_cvt_pk_bf16_f32 v104, v40, v41
v_cvt_pk_bf16_f32 v105, v42, v43
v_cvt_pk_bf16_f32 v106, v44, v45
v_cvt_pk_bf16_f32 v107, v46, v47
v_cvt_pk_bf16_f32 v108, v48, v49
v_cvt_pk_bf16_f32 v109, v50, v51
v_cvt_pk_bf16_f32 v110, v52, v53
v_cvt_pk_bf16_f32 v111, v54, v55
v_cvt_pk_bf16_f32 v112, v56, v57
v_cvt_pk_bf16_f32 v113, v58, v59
v_cvt_pk_bf16_f32 v114, v60, v61
v_cvt_pk_bf16_f32 v115, v62, v63
s_branch ss_end_40
ss_j1_39:
v_cvt_pk_bf16_f32 v108, v40, v41
v_cvt_pk_bf16_f32 v109, v42, v43
v_cvt_pk_bf16_f32 v110, v44, v45
v_cvt_pk_bf16_f32 v111, v46, v47
v_cvt_pk_bf16_f32 v112, v48, v49
v_cvt_pk_bf16_f32 v113, v50, v51
v_cvt_pk_bf16_f32 v114, v52, v53
v_cvt_pk_bf16_f32 v115, v54, v55
v_cvt_pk_bf16_f32 v104, v56, v57
v_cvt_pk_bf16_f32 v105, v58, v59
v_cvt_pk_bf16_f32 v106, v60, v61
v_cvt_pk_bf16_f32 v107, v62, v63
ss_end_40:
s_nop 1
v_mfma_f32_32x32x16_bf16 v[88:103], v[72:75], v[104:107], 0
v_mfma_f32_32x32x16_bf16 v[40:55], v[80:83], v[108:111], 0
v_mfma_f32_32x32x16_bf16 v[88:103], v[76:79], v[108:111], v[88:103]
v_mfma_f32_32x32x16_bf16 v[40:55], v[84:87], v[112:115], v[40:55]
s_nop 7
s_nop 3
v_mov_b32 v81, 0
v_mov_b32 v82, 0
v_mov_b32 v83, 0
v_mov_b32 v113, 0
v_mov_b32 v114, 0
v_mov_b32 v115, 0
v_mov_b32 v6, 163792
ds_read_b64 v[4:5], v6
v_max3_f32 v148, v88, v89, v90
v_min3_f32 v149, v88, v89, v90
v_max3_f32 v148, v148, v91, v92
v_min3_f32 v149, v149, v91, v92
v_max3_f32 v148, v148, v93, v94
v_min3_f32 v149, v149, v93, v94
v_max3_f32 v148, v148, v95, v96
v_min3_f32 v149, v149, v95, v96
v_mov_b32 v150, v148
v_mov_b32 v151, v149
s_nop 1
v_permlane32_swap_b32 v148, v150
v_permlane32_swap_b32 v149, v151
s_nop 0
v_max_f32 v148, v148, v150
v_min_f32 v149, v149, v151
v_mul_f32 v152, v160, v148
v_mul_f32 v153, v160, v149
v_fma_f32 v118, v88, v160, -v152
v_fma_f32 v128, -v88, v160, v153
v_fma_f32 v119, v89, v160, -v152
v_fma_f32 v129, -v89, v160, v153
v_fma_f32 v120, v90, v160, -v152
v_fma_f32 v130, -v90, v160, v153
v_exp_f32 v118, v118
v_exp_f32 v128, v128
v_exp_f32 v119, v119
v_exp_f32 v129, v129
v_exp_f32 v120, v120
v_exp_f32 v130, v130
v_fma_f32 v121, v91, v160, -v152
v_fma_f32 v131, -v91, v160, v153
v_fma_f32 v122, v92, v160, -v152
v_fma_f32 v132, -v92, v160, v153
v_fma_f32 v123, v93, v160, -v152
v_fma_f32 v133, -v93, v160, v153
v_exp_f32 v121, v121
v_exp_f32 v131, v131
v_exp_f32 v122, v122
v_exp_f32 v132, v132
v_exp_f32 v123, v123
v_exp_f32 v133, v133
v_fma_f32 v124, v94, v160, -v152
v_fma_f32 v134, -v94, v160, v153
v_fma_f32 v125, v95, v160, -v152
v_fma_f32 v135, -v95, v160, v153
v_fma_f32 v126, v96, v160, -v152
v_fma_f32 v136, -v96, v160, v153
v_exp_f32 v124, v124
v_exp_f32 v134, v134
v_exp_f32 v125, v125
v_exp_f32 v135, v135
v_exp_f32 v126, v126
v_exp_f32 v136, v136
s_nop 0
v_add_f32 v154, v118, v119
v_add_f32 v155, v128, v129
v_add_f32 v156, v120, v121
v_add_f32 v157, v130, v131
v_add_f32 v154, v154, v122
v_add_f32 v155, v155, v132
v_add_f32 v156, v156, v123
v_add_f32 v157, v157, v133
v_add_f32 v154, v154, v124
v_add_f32 v155, v155, v134
v_add_f32 v156, v156, v125
v_add_f32 v157, v157, v135
v_add_f32 v154, v154, v126
v_add_f32 v155, v155, v136
v_add_f32 v154, v154, v156
v_add_f32 v155, v155, v157
v_mov_b32 v150, v154
v_mov_b32 v151, v155
s_nop 1
v_permlane32_swap_b32 v154, v150
v_permlane32_swap_b32 v155, v151
s_nop 0
v_add_f32 v154, v154, v150
v_add_f32 v155, v155, v151
v_rcp_f32 v154, v154
v_rcp_f32 v155, v155
s_nop 0
v_mul_f32 v118, v118, v154
v_mul_f32 v119, v119, v154
v_mul_f32 v128, v128, v155
v_mul_f32 v129, v129, v155
v_cvt_pk_bf16_f32 v72, v118, v119
v_cvt_pk_bf16_f32 v76, v128, v129
v_mul_f32 v120, v120, v154
v_mul_f32 v121, v121, v154
v_mul_f32 v130, v130, v155
v_mul_f32 v131, v131, v155
v_cvt_pk_bf16_f32 v73, v120, v121
v_cvt_pk_bf16_f32 v77, v130, v131
v_mul_f32 v122, v122, v154
v_mul_f32 v123, v123, v154
v_mul_f32 v132, v132, v155
v_mul_f32 v133, v133, v155
v_cvt_pk_bf16_f32 v74, v122, v123
v_cvt_pk_bf16_f32 v78, v132, v133
v_mul_f32 v124, v124, v154
v_mul_f32 v125, v125, v154
v_mul_f32 v134, v134, v155
v_mul_f32 v135, v135, v155
v_cvt_pk_bf16_f32 v75, v124, v125
v_cvt_pk_bf16_f32 v79, v134, v135
v_mul_f32 v126, v126, v154
v_mul_f32 v136, v136, v155
v_cvt_pk_bf16_f32 v80, v126, v136
s_waitcnt lgkmcnt(0)
v_min_u32 v5, v4, v5
v_cmp_ne_u32 vcc, 0, v5
s_cbranch_vccnz rf_41
s_mov_b64 s[6:7], exec
s_mov_b64 exec, 1
v_mov_b32 v6, 163792
s_mov_b32 s31, 65536
lw_42:
ds_read_b64 v[4:5], v6
s_sub_u32 s31, s31, 1
s_cbranch_scc1 lx_43
s_waitcnt lgkmcnt(0)
v_min_u32 v5, v4, v5
v_cmp_ne_u32 vcc, 0, v5
s_cbranch_vccz lw_42
lx_43:
s_waitcnt lgkmcnt(0)
s_mov_b64 exec, s[6:7]
v_readfirstlane_b32 s60, v4
s_nop 0
s_sub_u32 s60, s60, 1
rf_41:
v_readfirstlane_b32 s60, v4
s_nop 0
s_sub_u32 s60, s60, 1
v_max3_f32 v148, v40, v41, v42
v_min3_f32 v149, v40, v41, v42
v_max3_f32 v148, v148, v43, v44
v_min3_f32 v149, v149, v43, v44
v_max3_f32 v148, v148, v45, v46
v_min3_f32 v149, v149, v45, v46
v_max3_f32 v148, v148, v47, v48
v_min3_f32 v149, v149, v47, v48
v_mov_b32 v150, v148
v_mov_b32 v151, v149
s_nop 1
v_permlane32_swap_b32 v148, v150
v_permlane32_swap_b32 v149, v151
s_nop 0
v_max_f32 v148, v148, v150
v_min_f32 v149, v149, v151
v_mul_f32 v152, v160, v148
v_mul_f32 v153, v160, v149
v_fma_f32 v118, v40, v160, -v152
v_fma_f32 v128, -v40, v160, v153
v_fma_f32 v119, v41, v160, -v152
v_fma_f32 v129, -v41, v160, v153
v_fma_f32 v120, v42, v160, -v152
v_fma_f32 v130, -v42, v160, v153
v_exp_f32 v118, v118
v_exp_f32 v128, v128
v_exp_f32 v119, v119
v_exp_f32 v129, v129
v_exp_f32 v120, v120
v_exp_f32 v130, v130
v_fma_f32 v121, v43, v160, -v152
v_fma_f32 v131, -v43, v160, v153
v_fma_f32 v122, v44, v160, -v152
v_fma_f32 v132, -v44, v160, v153
v_fma_f32 v123, v45, v160, -v152
v_fma_f32 v133, -v45, v160, v153
v_exp_f32 v121, v121
v_exp_f32 v131, v131
v_exp_f32 v122, v122
v_exp_f32 v132, v132
v_exp_f32 v123, v123
v_exp_f32 v133, v133
v_fma_f32 v124, v46, v160, -v152
v_fma_f32 v134, -v46, v160, v153
v_fma_f32 v125, v47, v160, -v152
v_fma_f32 v135, -v47, v160, v153
v_fma_f32 v126, v48, v160, -v152
v_fma_f32 v136, -v48, v160, v153
v_exp_f32 v124, v124
v_exp_f32 v134, v134
v_exp_f32 v125, v125
v_exp_f32 v135, v135
v_exp_f32 v126, v126
v_exp_f32 v136, v136
s_nop 0
v_add_f32 v154, v118, v119
v_add_f32 v155, v128, v129
v_add_f32 v156, v120, v121
v_add_f32 v157, v130, v131
v_add_f32 v154, v154, v122
v_add_f32 v155, v155, v132
v_add_f32 v156, v156, v123
v_add_f32 v157, v157, v133
v_add_f32 v154, v154, v124
v_add_f32 v155, v155, v134
s_add_u32 s33, s40, 0
buffer_load_dwordx4 v[16:19], v116, s[20:23], s33 offen
buffer_load_dwordx4 v[20:23], v116, s[20:23], s33 offen offset:640
buffer_load_dwordx4 v[32:35], v116, s[20:23], s33 offen offset:1280
s_add_u32 s33, s40, 1920
buffer_load_dwordx4 v[24:27], v116, s[20:23], s33 offen
buffer_load_dwordx4 v[28:31], v116, s[20:23], s33 offen offset:640
buffer_load_dwordx4 v[36:39], v116, s[20:23], s33 offen offset:1280
v_mov_b32 v163, 65
s_mov_b64 exec, 1
ds_write_b32 v161, v163
s_mov_b64 exec, -1
v_add_f32 v156, v156, v125
v_add_f32 v157, v157, v135
v_add_f32 v154, v154, v126
v_add_f32 v155, v155, v136
v_add_f32 v154, v154, v156
v_add_f32 v155, v155, v157
v_mov_b32 v150, v154
v_mov_b32 v151, v155
s_nop 1
v_permlane32_swap_b32 v154, v150
v_permlane32_swap_b32 v155, v151
s_nop 0
v_add_f32 v154, v154, v150
v_add_f32 v155, v155, v151
v_rcp_f32 v154, v154
v_rcp_f32 v155, v155
s_nop 0
v_mul_f32 v118, v118, v154
v_mul_f32 v119, v119, v154
v_mul_f32 v128, v128, v155
v_mul_f32 v129, v129, v155
v_cvt_pk_bf16_f32 v104, v118, v119
v_cvt_pk_bf16_f32 v108, v128, v129
v_mul_f32 v120, v120, v154
v_mul_f32 v121, v121, v154
v_mul_f32 v130, v130, v155
v_mul_f32 v131, v131, v155
v_cvt_pk_bf16_f32 v105, v120, v121
v_cvt_pk_bf16_f32 v109, v130, v131
v_mul_f32 v122, v122, v154
v_mul_f32 v123, v123, v154
v_mul_f32 v132, v132, v155
v_mul_f32 v133, v133, v155
v_cvt_pk_bf16_f32 v106, v122, v123
v_cvt_pk_bf16_f32 v110, v132, v133
v_mul_f32 v124, v124, v154
v_mul_f32 v125, v125, v154
v_mul_f32 v134, v134, v155
v_mul_f32 v135, v135, v155
v_cvt_pk_bf16_f32 v107, v124, v125
v_cvt_pk_bf16_f32 v111, v134, v135
v_mul_f32 v126, v126, v154
v_mul_f32 v136, v136, v155
v_cvt_pk_bf16_f32 v112, v126, v136
kc_44:
s_waitcnt vmcnt(0)
v_max3_u32 v4, v16, v17, v18
v_max3_u32 v4, v4, v19, v20
v_max3_u32 v4, v4, v21, v22
v_max3_u32 v4, v4, v23, v24
v_max3_u32 v4, v4, v25, v26
v_max3_u32 v4, v4, v27, v28
v_max3_u32 v4, v4, v29, v30
v_max3_u32 v4, v4, v31, v32
v_max_u32 v4, v4, v36
v_cmp_eq_u32 vcc, -1, v4
s_cbranch_vccz kk_45
s_cmp_eq_u32 s61, 0
s_cbranch_scc1 kk_45
s_sub_u32 s61, s61, 1
s_add_u32 s33, s40, 0
v_max3_u32 v4, v16, v17, v18
v_max_u32 v4, v4, v19
v_cmp_eq_u32 vcc, -1, v4
s_and_b64 exec, exec, vcc
s_cbranch_execz ks_46
buffer_load_dwordx4 v[16:19], v116, s[20:23], s33 offen sc1
ks_46:
s_mov_b64 exec, -1
v_max3_u32 v4, v20, v21, v22
v_max_u32 v4, v4, v23
v_cmp_eq_u32 vcc, -1, v4
s_and_b64 exec, exec, vcc
s_cbranch_execz ks_47
buffer_load_dwordx4 v[20:23], v116, s[20:23], s33 offen offset:640 sc1
ks_47:
s_mov_b64 exec, -1
v_max3_u32 v4, v32, v33, v34
v_max_u32 v4, v4, v35
v_cmp_eq_u32 vcc, -1, v4
s_and_b64 exec, exec, vcc
s_cbranch_execz ks_48
buffer_load_dwordx4 v[32:35], v116, s[20:23], s33 offen offset:1280 sc1
ks_48:
s_mov_b64 exec, -1
s_add_u32 s33, s40, 1920
v_max3_u32 v4, v24, v25, v26
v_max_u32 v4, v4, v27
v_cmp_eq_u32 vcc, -1, v4
s_and_b64 exec, exec, vcc
s_cbranch_execz ks_49
buffer_load_dwordx4 v[24:27], v116, s[20:23], s33 offen sc1
ks_49:
s_mov_b64 exec, -1
v_max3_u32 v4, v28, v29, v30
v_max_u32 v4, v4, v31
v_cmp_eq_u32 vcc, -1, v4
s_and_b64 exec, exec, vcc
s_cbranch_execz ks_50
buffer_load_dwordx4 v[28:31], v116, s[20:23], s33 offen offset:640 sc1
ks_50:
s_mov_b64 exec, -1
v_max3_u32 v4, v36, v37, v38
v_max_u32 v4, v4, v39
v_cmp_eq_u32 vcc, -1, v4
s_and_b64 exec, exec, vcc
s_cbranch_execz ks_51
buffer_load_dwordx4 v[36:39], v116, s[20:23], s33 offen offset:1280 sc1
ks_51:
s_mov_b64 exec, -1
s_branch kc_44
kk_45:
v_mfma_f32_32x32x16_bf16 v[88:103], v[16:19], v[72:75], 0
v_mfma_f32_32x32x16_bf16 v[56:71], v[24:27], v[104:107], 0
v_mfma_f32_32x32x16_bf16 v[88:103], v[20:23], v[76:79], v[88:103]
v_mfma_f32_32x32x16_bf16 v[56:71], v[28:31], v[108:111], v[56:71]
v_mfma_f32_32x32x16_bf16 v[88:103], v[32:35], v[80:83], v[88:103]
v_mfma_f32_32x32x16_bf16 v[56:71], v[36:39], v[112:115], v[56:71]
s_nop 7
s_nop 2
v_add_f32 v130, 0x358637bd, v98
v_rcp_f32 v130, v130
s_nop 0
v_mul_f32 v88, v88, v130
v_mul_f32 v89, v89, v130
v_mul_f32 v90, v90, v130
v_mul_f32 v91, v91, v130
v_mul_f32 v92, v92, v130
v_mul_f32 v93, v93, v130
v_mul_f32 v94, v94, v130
v_mul_f32 v95, v95, v130
v_mul_f32 v96, v96, v130
v_mul_f32 v97, v97, v130
v_cvt_pk_bf16_f32 v120, v88, v89
v_cvt_pk_bf16_f32 v121, v90, v91
v_cvt_pk_bf16_f32 v122, v92, v93
v_cvt_pk_bf16_f32 v123, v94, v95
v_cvt_pk_bf16_f32 v128, v96, v97
v_add_f32 v131, 0x358637bd, v66
v_rcp_f32 v131, v131
s_nop 0
v_mul_f32 v56, v56, v131
v_mul_f32 v57, v57, v131
v_mul_f32 v58, v58, v131
v_mul_f32 v59, v59, v131
v_mul_f32 v60, v60, v131
v_mul_f32 v61, v61, v131
v_mul_f32 v62, v62, v131
v_mul_f32 v63, v63, v131
v_mul_f32 v64, v64, v131
v_mul_f32 v65, v65, v131
v_cvt_pk_bf16_f32 v124, v56, v57
v_cvt_pk_bf16_f32 v125, v58, v59
v_cvt_pk_bf16_f32 v126, v60, v61
v_cvt_pk_bf16_f32 v127, v62, v63
v_cvt_pk_bf16_f32 v129, v64, v65
s_cmp_eq_u32 s60, 0
s_cbranch_scc1 slow_52
buffer_store_dwordx4 v[120:123], v2, s[20:23], s41 offen
buffer_store_dwordx4 v[124:127], v2, s[20:23], s41 offen offset:2048
s_mov_b64 exec, s[62:63]
buffer_store_dwordx2 v[128:129], v3, s[20:23], s42 offen
s_mov_b64 exec, -1
s_branch done_53
slow_52:
buffer_store_dwordx4 v[120:123], v2, s[20:23], s41 offen sc1
buffer_store_dwordx4 v[124:127], v2, s[20:23], s41 offen offset:2048 sc1
s_mov_b64 exec, s[62:63]
buffer_store_dwordx2 v[128:129], v3, s[20:23], s42 offen sc1
s_mov_b64 exec, -1
done_53:
s_lshl_b32 s31, s24, 2
s_add_u32 s31, s31, 163776
v_mov_b32 v13, s31
v_mov_b32 v14, 1
s_mov_b64 exec, 1
ds_write_b32 v13, v14
s_mov_b64 exec, -1
s_setprio 2
s_and_b32 s31, s24, 1
s_lshl_b32 s31, s31, 10
s_add_u32 s31, s31, 83664
v_lshl_add_u32 v48, v1, 4, s31
v_add_u32 v49, 32768, v48
v_bfe_u32 v68, v1, 4, 1
v_bfe_u32 v69, v1, 1, 1
v_lshl_add_u32 v68, v68, 1, v69
s_lshr_b32 s31, s24, 1
s_mul_i32 s31, s31, 5
v_add_u32 v68, s31, v68
v_bfe_u32 v69, v1, 2, 2
v_and_b32 v70, 1, v69
v_lshlrev_b32 v71, 2, v68
v_sub_u32 v71, v71, v70
v_add_u32 v71, 2, v71
v_mul_u32_u24 v72, 57, v71
v_lshrrev_b32 v72, 9, v72
v_mul_u32_u24 v72, 9, v72
v_sub_u32 v71, v71, v72
v_and_b32 v72, 1, v1
v_lshlrev_b32 v72, 3, v72
v_lshl_add_u32 v71, v71, 4, v72
v_add_u32 v71, 0, v71
v_lshrrev_b32 v72, 5, v1
v_lshl_add_u32 v73, v72, 2, v69
v_mul_u32_u24 v73, 144, v73
v_add_u32 v50, v73, v71
v_add_u32 v51, 41472, v50
v_mul_u32_u24 v73, 72, v72
v_lshrrev_b32 v74, 1, v69
v_mul_u32_u24 v74, 18, v74
v_add3_u32 v73, v73, v74, v70
v_add_u32 v73, 16, v73
v_mul_u32_u24 v73, 144, v73
v_add_u32 v52, v73, v71
v_add_u32 v53, 5184, v52
s_lshr_b32 s32, s24, 1
s_lshl_b32 s32, s32, 10
s_and_b32 s31, s24, 1
s_lshl_b32 s31, s31, 8
s_add_u32 s31, s31, s32
s_add_u32 s31, s31, 83664
v_and_b32 v68, 15, v1
v_lshrrev_b32 v69, 4, v1
v_lshrrev_b32 v70, 1, v69
v_and_b32 v71, 1, v69
v_lshlrev_b32 v72, 11, v70
v_lshl_add_u32 v72, v71, 9, v72
v_lshl_add_u32 v72, v68, 4, v72
v_add_u32 v54, s31, v72
v_add_u32 v55, 32768, v54
v_bfe_u32 v72, v1, 2, 2
v_and_b32 v73, 1, v72
v_lshlrev_b32 v74, 3, v73
v_and_b32 v75, 1, v1
v_lshlrev_b32 v75, 3, v75
v_lshl_add_u32 v74, v74, 4, v75
v_add_u32 v74, 0, v74
v_mul_u32_u24 v75, 18, v70
v_lshl_add_u32 v75, v71, 2, v75
v_add_u32 v75, v75, v72
v_mul_u32_u24 v75, 144, v75
v_add_u32 v56, v75, v74
v_add_u32 v57, 41472, v56
v_mul_u32_u24 v75, 144, v70
v_mul_u32_u24 v68, 72, v71
v_add_u32 v75, v75, v68
v_lshrrev_b32 v68, 1, v72
v_mul_u32_u24 v68, 18, v68
v_add3_u32 v75, v75, v68, v73
v_add_u32 v75, 16, v75
v_mul_u32_u24 v75, 144, v75
v_add_u32 v58, v75, v74
v_and_b32 v60, 31, v1
s_and_b32 s31, s24, 1
s_lshl_b32 s31, s31, 5
v_add_u32 v60, s31, v60
v_mul_u32_u24 v60, 144, v60
v_lshrrev_b32 v68, 5, v1
v_lshl_add_u32 v60, v68, 3, v60
s_lshr_b32 s31, s24, 1
s_mul_i32 s31, s31, 80
s_add_u32 s31, s31, 83664
v_add_u32 v60, s31, v60
v_and_b32 v61, 15, v1
s_lshl_b32 s31, s24, 4
v_add_u32 v61, s31, v61
v_mul_u32_u24 v61, 144, v61
v_bfe_u32 v68, v1, 4, 1
v_lshl_add_u32 v61, v68, 3, v61
v_add_u32 v61, 83664, v61
s_mul_i32 s44, s25, 147456
s_mul_i32 s32, s26, 144
s_add_u32 s44, s44, s32
s_mov_b32 s58, s24
s_lshl_b32 s31, s58, 6
v_add_u32 v118, s31, v1
v_mul_u32_u24 v116, 7282, v118
v_lshrrev_b32 v116, 16, v116
v_mul_u32_u24 v119, 9, v116
v_sub_u32 v117, v118, v119
v_lshlrev_b32 v118, 4, v118
v_add_u32 v118, 83664, v118
v_mul_u32_u24 v116, 2304, v116
v_lshl_add_u32 v116, v117, 4, v116
s_mov_b32 s58, 8
s_lshl_b32 s31, s58, 6
v_add_u32 v126, s31, v1
v_mul_u32_u24 v124, 7282, v126
v_lshrrev_b32 v124, 16, v124
v_mul_u32_u24 v127, 9, v124
v_sub_u32 v125, v126, v127
v_lshlrev_b32 v126, 4, v126
v_add_u32 v126, 83664, v126
v_mul_u32_u24 v124, 2304, v124
v_lshl_add_u32 v124, v125, 4, v124
s_setprio 2
s_mov_b64 s[6:7], exec
s_mov_b64 exec, 1
v_mov_b32 v20, 163760
s_mov_b32 s31, 65536
lw_54:
ds_read_b128 v[16:19], v20
s_sub_u32 s31, s31, 1
s_cbranch_scc1 lx_55
s_waitcnt lgkmcnt(0)
v_min3_u32 v16, v16, v17, v18
v_min_u32 v16, v16, v19
v_cmp_ne_u32 vcc, 0, v16
s_cbranch_vccz lw_54
lx_55:
s_waitcnt lgkmcnt(0)
s_mov_b64 exec, s[6:7]
ds_read_b64_tr_b16 v[164:165], v50 offset:10368
ds_read_b64_tr_b16 v[166:167], v50 offset:11520
ds_read_b64_tr_b16 v[160:161], v50 offset:15552
ds_read_b64_tr_b16 v[162:163], v50 offset:16704
ds_read_b64_tr_b16 v[156:157], v50 offset:18144
ds_read_b64_tr_b16 v[158:159], v50 offset:19296
ds_read_b64_tr_b16 v[152:153], v50 offset:33696
ds_read_b64_tr_b16 v[154:155], v50 offset:34848
ds_read_b64_tr_b16 v[148:149], v50 offset:36288
ds_read_b64_tr_b16 v[150:151], v50 offset:37440
ds_read_b64_tr_b16 v[144:145], v51 offset:10368
ds_read_b64_tr_b16 v[146:147], v51 offset:11520
s_waitcnt lgkmcnt(2)
ds_read_b64_tr_b16 v[140:141], v51 offset:15552
ds_read_b64_tr_b16 v[142:143], v51 offset:16704
ds_read_b64_tr_b16 v[136:137], v51 offset:18144
ds_read_b64_tr_b16 v[138:139], v51 offset:19296
ds_read_b64_tr_b16 v[132:133], v51 offset:33696
ds_read_b64_tr_b16 v[134:135], v51 offset:34848
ds_read_b64_tr_b16 v[128:129], v51 offset:36288
ds_read_b64_tr_b16 v[130:131], v51 offset:37440
ds_read_b64_tr_b16 v[92:93], v52 offset:0
ds_read_b64_tr_b16 v[94:95], v53 offset:0
ds_read_b64_tr_b16 v[88:89], v52 offset:20736
ds_read_b64_tr_b16 v[90:91], v53 offset:20736
s_waitcnt lgkmcnt(2)
ds_read_b64_tr_b16 v[84:85], v52 offset:62208
ds_read_b64_tr_b16 v[86:87], v53 offset:62208
s_waitcnt lgkmcnt(0)
s_barrier
ds_read_b128 v[16:19], v48 offset:0
ds_read_b64_tr_b16 v[20:21], v50 offset:0
ds_read_b64_tr_b16 v[22:23], v50 offset:1152
ds_read_b128 v[24:27], v48 offset:2048
ds_read_b64_tr_b16 v[28:29], v50 offset:2592
ds_read_b64_tr_b16 v[30:31], v50 offset:3744
ds_read_b128 v[32:35], v54 offset:0
ds_read_b64_tr_b16 v[36:37], v56 offset:0
ds_read_b64_tr_b16 v[38:39], v56 offset:1152
ds_read_b128 v[40:43], v48 offset:4096
ds_read_b64_tr_b16 v[44:45], v50 offset:5184
ds_read_b64_tr_b16 v[46:47], v50 offset:6336
s_waitcnt lgkmcnt(9)
v_mfma_f32_32x32x16_bf16 v[96:111], v[20:23], v[16:19], 0
ds_read_b128 v[68:71], v48 offset:6144
ds_read_b64_tr_b16 v[72:73], v50 offset:7776
ds_read_b64_tr_b16 v[74:75], v50 offset:8928
s_waitcnt lgkmcnt(9)
v_mfma_f32_32x32x16_bf16 v[96:111], v[28:31], v[24:27], v[96:111]
ds_read_b128 v[16:19], v54 offset:4096
ds_read_b64_tr_b16 v[20:21], v56 offset:5184
ds_read_b64_tr_b16 v[22:23], v56 offset:6336
s_waitcnt lgkmcnt(9)
v_mfma_f32_16x16x32_bf16 v[64:67], v[36:39], v[32:35], 0
ds_read_b128 v[24:27], v48 offset:8192
ds_read_b64_tr_b16 v[28:29], v50 offset:20736
ds_read_b64_tr_b16 v[30:31], v50 offset:21888
s_waitcnt lgkmcnt(9)
v_mfma_f32_32x32x16_bf16 v[96:111], v[44:47], v[40:43], v[96:111]
ds_read_b128 v[32:35], v48 offset:10240
ds_read_b64_tr_b16 v[36:37], v50 offset:23328
ds_read_b64_tr_b16 v[38:39], v50 offset:24480
s_waitcnt lgkmcnt(9)
v_mfma_f32_32x32x16_bf16 v[96:111], v[72:75], v[68:71], v[96:111]
ds_read_b128 v[40:43], v54 offset:8192
ds_read_b64_tr_b16 v[44:45], v56 offset:20736
ds_read_b64_tr_b16 v[46:47], v56 offset:21888
s_waitcnt lgkmcnt(9)
v_mfma_f32_16x16x32_bf16 v[64:67], v[20:23], v[16:19], v[64:67]
ds_read_b128 v[68:71], v48 offset:12288
ds_read_b64_tr_b16 v[72:73], v50 offset:25920
ds_read_b64_tr_b16 v[74:75], v50 offset:27072
s_waitcnt lgkmcnt(9)
v_mfma_f32_32x32x16_bf16 v[96:111], v[28:31], v[24:27], v[96:111]
ds_read_b128 v[16:19], v48 offset:14336
ds_read_b64_tr_b16 v[20:21], v50 offset:28512
ds_read_b64_tr_b16 v[22:23], v50 offset:29664
s_waitcnt lgkmcnt(9)
v_mfma_f32_32x32x16_bf16 v[96:111], v[36:39], v[32:35], v[96:111]
ds_read_b128 v[24:27], v54 offset:12288
ds_read_b64_tr_b16 v[28:29], v56 offset:25920
ds_read_b64_tr_b16 v[30:31], v56 offset:27072
s_waitcnt lgkmcnt(9)
v_mfma_f32_16x16x32_bf16 v[64:67], v[44:47], v[40:43], v[64:67]
ds_read_b128 v[32:35], v48 offset:16384
ds_read_b64_tr_b16 v[36:37], v51 offset:0
ds_read_b64_tr_b16 v[38:39], v51 offset:1152
s_waitcnt lgkmcnt(9)
v_mfma_f32_32x32x16_bf16 v[96:111], v[72:75], v[68:71], v[96:111]
ds_read_b128 v[40:43], v48 offset:18432
ds_read_b64_tr_b16 v[44:45], v51 offset:2592
ds_read_b64_tr_b16 v[46:47], v51 offset:3744
s_waitcnt lgkmcnt(9)
v_mfma_f32_32x32x16_bf16 v[96:111], v[20:23], v[16:19], v[96:111]
ds_read_b128 v[68:71], v54 offset:16384
ds_read_b64_tr_b16 v[72:73], v57 offset:0
ds_read_b64_tr_b16 v[74:75], v57 offset:1152
s_waitcnt lgkmcnt(9)
v_mfma_f32_16x16x32_bf16 v[64:67], v[28:31], v[24:27], v[64:67]
ds_read_b128 v[16:19], v48 offset:20480
ds_read_b64_tr_b16 v[20:21], v51 offset:5184
ds_read_b64_tr_b16 v[22:23], v51 offset:6336
s_waitcnt lgkmcnt(9)
v_mfma_f32_32x32x16_bf16 v[96:111], v[36:39], v[32:35], v[96:111]
ds_read_b128 v[24:27], v48 offset:22528
ds_read_b64_tr_b16 v[28:29], v51 offset:7776
ds_read_b64_tr_b16 v[30:31], v51 offset:8928
s_waitcnt lgkmcnt(9)
v_mfma_f32_32x32x16_bf16 v[96:111], v[44:47], v[40:43], v[96:111]
ds_read_b128 v[32:35], v54 offset:20480
ds_read_b64_tr_b16 v[36:37], v57 offset:5184
ds_read_b64_tr_b16 v[38:39], v57 offset:6336
s_waitcnt lgkmcnt(9)
v_mfma_f32_16x16x32_bf16 v[64:67], v[72:75], v[68:71], v[64:67]
ds_read_b128 v[40:43], v48 offset:24576
ds_read_b64_tr_b16 v[44:45], v51 offset:20736
ds_read_b64_tr_b16 v[46:47], v51 offset:21888
s_waitcnt lgkmcnt(9)
v_mfma_f32_32x32x16_bf16 v[96:111], v[20:23], v[16:19], v[96:111]
ds_read_b128 v[68:71], v48 offset:26624
ds_read_b64_tr_b16 v[72:73], v51 offset:23328
ds_read_b64_tr_b16 v[74:75], v51 offset:24480
s_waitcnt lgkmcnt(9)
v_mfma_f32_32x32x16_bf16 v[96:111], v[28:31], v[24:27], v[96:111]
ds_read_b128 v[16:19], v54 offset:24576
ds_read_b64_tr_b16 v[20:21], v57 offset:20736
ds_read_b64_tr_b16 v[22:23], v57 offset:21888
s_waitcnt lgkmcnt(9)
v_mfma_f32_16x16x32_bf16 v[64:67], v[36:39], v[32:35], v[64:67]
ds_read_b128 v[24:27], v48 offset:28672
ds_read_b64_tr_b16 v[28:29], v51 offset:25920
ds_read_b64_tr_b16 v[30:31], v51 offset:27072
s_waitcnt lgkmcnt(9)
v_mfma_f32_32x32x16_bf16 v[96:111], v[44:47], v[40:43], v[96:111]
ds_read_b128 v[32:35], v48 offset:30720
ds_read_b64_tr_b16 v[36:37], v51 offset:28512
ds_read_b64_tr_b16 v[38:39], v51 offset:29664
s_waitcnt lgkmcnt(9)
v_mfma_f32_32x32x16_bf16 v[96:111], v[72:75], v[68:71], v[96:111]
ds_read_b128 v[40:43], v54 offset:28672
ds_read_b64_tr_b16 v[44:45], v57 offset:25920
ds_read_b64_tr_b16 v[46:47], v57 offset:27072
s_waitcnt lgkmcnt(9)
v_mfma_f32_16x16x32_bf16 v[64:67], v[20:23], v[16:19], v[64:67]
s_waitcnt lgkmcnt(6)
v_mfma_f32_32x32x16_bf16 v[96:111], v[28:31], v[24:27], v[96:111]
s_waitcnt lgkmcnt(3)
v_mfma_f32_32x32x16_bf16 v[96:111], v[36:39], v[32:35], v[96:111]
s_waitcnt lgkmcnt(0)
v_mfma_f32_16x16x32_bf16 v[64:67], v[44:47], v[40:43], v[64:67]
s_barrier
ds_read_b128 v[16:19], v49 offset:0
ds_read_b128 v[24:27], v49 offset:2048
ds_read_b64_tr_b16 v[28:29], v50 offset:12960
ds_read_b64_tr_b16 v[30:31], v50 offset:14112
ds_read_b128 v[32:35], v55 offset:0
ds_read_b64_tr_b16 v[36:37], v56 offset:10368
ds_read_b64_tr_b16 v[38:39], v56 offset:11520
ds_read_b128 v[40:43], v49 offset:4096
s_waitcnt lgkmcnt(7)
v_mfma_f32_32x32x16_bf16 v[96:111], v[164:167], v[16:19], v[96:111]
ds_read_b128 v[68:71], v49 offset:6144
s_waitcnt lgkmcnt(5)
v_mfma_f32_32x32x16_bf16 v[96:111], v[28:31], v[24:27], v[96:111]
ds_read_b128 v[16:19], v55 offset:4096
ds_read_b64_tr_b16 v[20:21], v56 offset:15552
ds_read_b64_tr_b16 v[22:23], v56 offset:16704
s_waitcnt lgkmcnt(5)
v_mfma_f32_16x16x32_bf16 v[64:67], v[36:39], v[32:35], v[64:67]
ds_read_b128 v[24:27], v49 offset:8192
ds_read_b64_tr_b16 v[28:29], v50 offset:31104
ds_read_b64_tr_b16 v[30:31], v50 offset:32256
s_waitcnt lgkmcnt(7)
v_mfma_f32_32x32x16_bf16 v[96:111], v[160:163], v[40:43], v[96:111]
ds_read_b128 v[32:35], v49 offset:10240
s_waitcnt lgkmcnt(7)
v_mfma_f32_32x32x16_bf16 v[96:111], v[156:159], v[68:71], v[96:111]
ds_read_b128 v[40:43], v55 offset:8192
ds_read_b64_tr_b16 v[44:45], v56 offset:31104
ds_read_b64_tr_b16 v[46:47], v56 offset:32256
s_waitcnt lgkmcnt(7)
v_mfma_f32_16x16x32_bf16 v[64:67], v[20:23], v[16:19], v[64:67]
ds_read_b128 v[68:71], v49 offset:12288
s_waitcnt lgkmcnt(5)
v_mfma_f32_32x32x16_bf16 v[96:111], v[28:31], v[24:27], v[96:111]
ds_read_b128 v[16:19], v49 offset:14336
ds_read_b64_tr_b16 v[20:21], v50 offset:38880
ds_read_b64_tr_b16 v[22:23], v50 offset:40032
s_waitcnt lgkmcnt(7)
v_mfma_f32_32x32x16_bf16 v[96:111], v[152:155], v[32:35], v[96:111]
ds_read_b128 v[24:27], v55 offset:12288
ds_read_b64_tr_b16 v[28:29], v56 offset:36288
ds_read_b64_tr_b16 v[30:31], v56 offset:37440
s_waitcnt lgkmcnt(7)
v_mfma_f32_16x16x32_bf16 v[64:67], v[44:47], v[40:43], v[64:67]
ds_read_b128 v[32:35], v49 offset:16384
s_waitcnt lgkmcnt(7)
v_mfma_f32_32x32x16_bf16 v[96:111], v[148:151], v[68:71], v[96:111]
ds_read_b128 v[40:43], v49 offset:18432
ds_read_b64_tr_b16 v[44:45], v51 offset:12960
ds_read_b64_tr_b16 v[46:47], v51 offset:14112
s_waitcnt lgkmcnt(7)
v_mfma_f32_32x32x16_bf16 v[96:111], v[20:23], v[16:19], v[96:111]
ds_read_b128 v[68:71], v55 offset:16384
ds_read_b64_tr_b16 v[72:73], v57 offset:10368
ds_read_b64_tr_b16 v[74:75], v57 offset:11520
s_waitcnt lgkmcnt(7)
v_mfma_f32_16x16x32_bf16 v[64:67], v[28:31], v[24:27], v[64:67]
ds_read_b128 v[16:19], v49 offset:20480
s_waitcnt lgkmcnt(7)
v_mfma_f32_32x32x16_bf16 v[96:111], v[144:147], v[32:35], v[96:111]
ds_read_b128 v[24:27], v49 offset:22528
s_waitcnt lgkmcnt(5)
v_mfma_f32_32x32x16_bf16 v[96:111], v[44:47], v[40:43], v[96:111]
ds_read_b128 v[32:35], v55 offset:20480
ds_read_b64_tr_b16 v[36:37], v57 offset:15552
ds_read_b64_tr_b16 v[38:39], v57 offset:16704
s_waitcnt lgkmcnt(5)
v_mfma_f32_16x16x32_bf16 v[64:67], v[72:75], v[68:71], v[64:67]
ds_read_b128 v[40:43], v49 offset:24576
ds_read_b64_tr_b16 v[44:45], v51 offset:31104
ds_read_b64_tr_b16 v[46:47], v51 offset:32256
s_waitcnt lgkmcnt(7)
v_mfma_f32_32x32x16_bf16 v[96:111], v[140:143], v[16:19], v[96:111]
ds_read_b128 v[68:71], v49 offset:26624
s_waitcnt lgkmcnt(7)
v_mfma_f32_32x32x16_bf16 v[96:111], v[136:139], v[24:27], v[96:111]
ds_read_b128 v[16:19], v55 offset:24576
ds_read_b64_tr_b16 v[20:21], v57 offset:31104
ds_read_b64_tr_b16 v[22:23], v57 offset:32256
s_waitcnt lgkmcnt(7)
v_mfma_f32_16x16x32_bf16 v[64:67], v[36:39], v[32:35], v[64:67]
ds_read_b128 v[24:27], v49 offset:28672
s_waitcnt lgkmcnt(5)
v_mfma_f32_32x32x16_bf16 v[96:111], v[44:47], v[40:43], v[96:111]
ds_read_b128 v[32:35], v49 offset:30720
ds_read_b64_tr_b16 v[36:37], v51 offset:38880
ds_read_b64_tr_b16 v[38:39], v51 offset:40032
s_waitcnt lgkmcnt(7)
v_mfma_f32_32x32x16_bf16 v[96:111], v[132:135], v[68:71], v[96:111]
ds_read_b128 v[40:43], v55 offset:28672
ds_read_b64_tr_b16 v[44:45], v57 offset:36288
ds_read_b64_tr_b16 v[46:47], v57 offset:37440
s_waitcnt lgkmcnt(7)
v_mfma_f32_16x16x32_bf16 v[64:67], v[20:23], v[16:19], v[64:67]
ds_read_b128 v[68:71], v49 offset:32768
s_waitcnt lgkmcnt(7)
v_mfma_f32_32x32x16_bf16 v[96:111], v[128:131], v[24:27], v[96:111]
ds_read_b128 v[16:19], v49 offset:34816
s_waitcnt lgkmcnt(5)
v_mfma_f32_32x32x16_bf16 v[96:111], v[36:39], v[32:35], v[96:111]
ds_read_b128 v[24:27], v55 offset:32768
ds_read_b64_tr_b16 v[28:29], v58 offset:0
ds_read_b64_tr_b16 v[30:31], v58 offset:5184
s_waitcnt lgkmcnt(5)
v_mfma_f32_16x16x32_bf16 v[64:67], v[44:47], v[40:43], v[64:67]
ds_read_b128 v[32:35], v49 offset:36864
ds_read_b64_tr_b16 v[36:37], v52 offset:41472
ds_read_b64_tr_b16 v[38:39], v53 offset:41472
s_waitcnt lgkmcnt(7)
v_mfma_f32_32x32x16_bf16 v[96:111], v[92:95], v[68:71], v[96:111]
ds_read_b128 v[40:43], v49 offset:38912
s_waitcnt lgkmcnt(7)
v_mfma_f32_32x32x16_bf16 v[96:111], v[88:91], v[16:19], v[96:111]
ds_read_b128 v[68:71], v55 offset:36864
ds_read_b64_tr_b16 v[72:73], v58 offset:41472
ds_read_b64_tr_b16 v[74:75], v58 offset:46656
s_waitcnt lgkmcnt(7)
v_mfma_f32_16x16x32_bf16 v[64:67], v[28:31], v[24:27], v[64:67]
s_waitcnt lgkmcnt(4)
v_mfma_f32_32x32x16_bf16 v[96:111], v[36:39], v[32:35], v[96:111]
s_waitcnt lgkmcnt(3)
v_mfma_f32_32x32x16_bf16 v[96:111], v[84:87], v[40:43], v[96:111]
s_waitcnt lgkmcnt(0)
v_mfma_f32_16x16x32_bf16 v[64:67], v[72:75], v[68:71], v[64:67]
s_nop 7
s_nop 1
v_cvt_pk_bf16_f32 v24, v64, v65
v_cvt_pk_bf16_f32 v25, v66, v67
v_cvt_pk_bf16_f32 v16, v96, v97
v_cvt_pk_bf16_f32 v17, v98, v99
ds_write_b64 v61, v[24:25] offset:64
ds_write_b64 v60, v[16:17] offset:0
v_cvt_pk_bf16_f32 v18, v100, v101
v_cvt_pk_bf16_f32 v19, v102, v103
ds_write_b64 v60, v[18:19] offset:16
v_cvt_pk_bf16_f32 v20, v104, v105
v_cvt_pk_bf16_f32 v21, v106, v107
ds_write_b64 v60, v[20:21] offset:32
v_cvt_pk_bf16_f32 v22, v108, v109
v_cvt_pk_bf16_f32 v23, v110, v111
ds_write_b64 v60, v[22:23] offset:48
L_st:
s_waitcnt lgkmcnt(0)
s_barrier
ds_read_b128 v[112:115], v118
s_cmp_eq_u32 s24, 7
s_cbranch_scc1 o7_57
s_waitcnt lgkmcnt(0)
buffer_store_dwordx4 v[112:115], v116, s[48:51], s44 offen
s_branch oe_58
o7_57:
ds_read_b128 v[120:123], v126
s_waitcnt lgkmcnt(1)
buffer_store_dwordx4 v[112:115], v116, s[48:51], s44 offen
s_waitcnt lgkmcnt(0)
buffer_store_dwordx4 v[120:123], v124, s[48:51], s44 offen
oe_58:
s_branch L_end
L_g1:
s_load_dwordx4 s[8:11], s[0:1], 32
s_load_dwordx4 s[12:15], s[0:1], 48
s_load_dwordx4 s[16:19], s[0:1], 64
s_load_dwordx2 s[42:43], s[0:1], 80
v_and_b32 v16, 31, v1
s_lshl_b32 s31, s30, 5
v_add_u32 v16, s31, v16
v_lshrrev_b32 v17, 1, v16
v_and_b32 v17, 7, v17
v_lshrrev_b32 v18, 5, v1
v_xor_b32 v17, v17, v18
v_lshlrev_b32 v17, 4, v17
v_lshlrev_b32 v16, 7, v16
v_add_u32 v16, v16, v17
v_xor_b32 v5, 0, v16
v_add_u32 v9, 0x10000, v5
v_xor_b32 v6, 32, v16
v_add_u32 v10, 0x10000, v6
v_xor_b32 v7, 64, v16
v_add_u32 v11, 0x10000, v7
v_xor_b32 v8, 96, v16
v_add_u32 v12, 0x10000, v8
v_lshrrev_b32 v16, 5, v1
v_bfe_u32 v17, v1, 2, 2
v_lshl_add_u32 v16, v16, 3, v17
v_mul_u32_u24 v16, 144, v16
v_add_u32 v16, 73728, v16
v_and_b32 v17, 1, v17
v_and_b32 v18, 1, v1
v_lshl_add_u32 v16, v18, 3, v16
v_lshl_add_u32 v14, v17, 7, v16
v_bfe_u32 v18, v1, 4, 1
v_bfe_u32 v19, v1, 1, 1
v_lshl_add_u32 v18, v18, 1, v19
s_mul_i32 s31, s29, 5
v_add_u32 v18, s31, v18
v_lshlrev_b32 v18, 2, v18
v_sub_u32 v18, v18, v17
v_add_u32 v18, 2, v18
v_mul_u32_u24 v19, 57, v18
v_lshrrev_b32 v19, 9, v19
v_mul_u32_u24 v19, 9, v19
v_sub_u32 v18, v18, v19
v_lshl_add_u32 v13, v18, 4, v16
s_waitcnt lgkmcnt(0)
s_sub_u32 s37, s24, 4
s_sub_u32 s59, s24, 4
s_setprio 1
s_lshr_b32 s38, s37, 1
s_lshr_b32 s39, s2, 3
s_lshl_b32 s39, s39, 1
s_add_u32 s38, s38, s39
s_and_b32 s39, s2, 7
s_mul_i32 s36, s39, 72
s_add_u32 s36, s36, s38
s_and_b32 s39, s37, 1
s_lshl_b32 s38, s36, 8
s_lshl_b32 s39, s39, 7
s_add_u32 s38, s38, s39
v_lshlrev_b32 v62, 1, v1
v_add_u32 v62, s38, v62
s_lshl_b32 s38, s36, 1
v_mov_b32 v64, s38
global_load_ushort v16, v62, s[10:11]
global_load_ushort v17, v62, s[12:13]
global_load_ushort v18, v62, s[14:15]
global_load_ushort v19, v62, s[16:17]
global_load_ushort v3, v64, s[42:43]
global_load_ushort v20, v64, s[18:19]
s_mul_i32 s38, s37, 4896
s_add_u32 s38, s38, 131328
s_mov_b32 m0, s38
v_and_b32 v54, 15, v1
v_lshrrev_b32 v56, 4, v1
v_lshl_add_u32 v60, v56, 4, s38
v_mul_u32_u24 v58, 288, v54
v_add_u32 v68, v58, v60
v_bfe_u32 v58, v54, 1, 1
v_add3_u32 v58, v58, v54, 0
v_lshrrev_b32 v58, 1, v58
v_mul_u32_u24 v58, 288, v58
v_add_u32 v69, v58, v60
v_bfe_u32 v58, v54, 2, 1
v_add3_u32 v58, v58, v54, 1
v_lshrrev_b32 v58, 2, v58
v_mul_u32_u24 v58, 288, v58
v_add_u32 v70, v58, v60
v_bfe_u32 v58, v54, 3, 1
v_add3_u32 v58, v58, v54, 3
v_lshrrev_b32 v58, 3, v58
v_mul_u32_u24 v58, 288, v58
v_add_u32 v71, v58, v60
v_lshlrev_b32 v58, 5, v54
v_lshl_add_u32 v58, v56, 3, v58
v_sub_u32 v2, 504, v58
s_waitcnt vmcnt(0)
v_lshlrev_b32 v62, 16, v20
v_lshlrev_b32 v64, 16, v16
v_mul_f32 v62, 0x3fb8aa3b, v62
v_mul_f32 v64, 0x3fb8aa3b, v64
v_exp_f32 v62, v62
v_exp_f32 v64, v64
v_mov_b32 v66, 0x3f80
v_lshlrev_b32 v25, 16, v17
v_cvt_pk_bf16_f32 v62, v62, v62
v_cvt_pk_bf16_f32 v64, v64, v64
v_and_b32 v62, 0xffff0000, v62
v_lshlrev_b32 v26, 16, v18
v_mul_f32 v21, 0xbfb8aa3b, v62
v_and_b32 v64, 0xffff0000, v64
v_mul_f32 v22, 0x3e22f983, v62
v_lshlrev_b32 v27, 16, v19
v_add_f32 v23, v62, v62
v_mul_f32 v24, v64, v21
v_mul_f32 v25, v25, v22
v_mul_f32 v26, v26, v23
v_mul_f32 v27, v27, v23
ds_write_addtid_b32 v66
v_mul_f32 v36, 0x41800000, v24
v_mul_f32 v38, 0x43800000, v24
v_exp_f32 v28, v24
v_mul_f32 v62, 0x41800000, v25
v_mul_f32 v64, 0x43800000, v25
v_fract_f32 v54, v25
v_exp_f32 v36, v36
v_exp_f32 v38, v38
v_cos_f32 v55, v54
v_fract_f32 v62, v62
v_fract_f32 v64, v64
v_cos_f32 v63, v62
v_cos_f32 v65, v64
v_sin_f32 v54, v54
v_sin_f32 v62, v62
v_sin_f32 v64, v64
s_nop 0
s_nop 0
s_nop 0
v_mul_f32_e64 v29, v28, v54
v_mul_f32_e64 v37, -v36, v62
v_mul_f32_e64 v39, v38, v64
v_mul_f32 v28, v28, v55
v_mul_f32 v36, v36, v63
v_mul_f32 v38, v38, v65
v_mul_f32 v62, v37, v37
v_mul_f32 v64, v29, v29
v_mul_f32 v63, v37, v36
v_mul_f32 v65, v28, v29
v_fma_f32 v56, v36, v36, -v62
v_fma_f32 v30, v28, v28, -v64
v_fma_f32 v57, v36, v37, v63
v_add_f32 v31, v65, v65
v_cvt_pk_bf16_f32 v66, v36, v37
v_mul_f32 v64, v27, v39
ds_write_addtid_b32 v66 offset:288
v_mul_f32 v65, v27, v38
v_mul_f32 v62, v57, v37
v_mul_f32 v63, v57, v36
v_fma_f32 v40, v26, v38, -v64
v_fma_f32 v54, v56, v36, -v62
v_fma_f32 v41, v26, v39, v65
v_fma_f32 v55, v56, v37, v63
v_mul_f32 v64, v41, v31
v_cvt_pk_bf16_f32 v66, v56, v57
v_mul_f32 v65, v41, v30
ds_write_addtid_b32 v66 offset:576
v_fma_f32 v60, v40, v30, -v64
v_mul_f32 v62, v55, v37
v_mul_f32 v63, v55, v36
v_fma_f32 v61, v40, v31, v65
v_fma_f32 v56, v54, v36, -v62
v_cvt_pk_bf16_f32 v152, v40, v41
v_fma_f32 v57, v54, v37, v63
v_mul_f32 v64, v61, v31
s_barrier
v_cvt_pk_bf16_f32 v66, v54, v55
v_mul_f32 v65, v61, v30
ds_write_addtid_b32 v66 offset:864
v_fma_f32 v58, v60, v30, -v64
v_mul_f32 v62, v57, v37
v_fma_f32 v59, v60, v31, v65
v_mul_f32 v63, v57, v36
v_fma_f32 v54, v56, v36, -v62
v_cvt_pk_bf16_f32 v153, v60, v61
v_fma_f32 v55, v56, v37, v63
v_mul_f32 v64, v59, v31
v_cvt_pk_bf16_f32 v66, v56, v57
v_mul_f32 v65, v59, v30
ds_write_addtid_b32 v66 offset:1152
v_fma_f32 v60, v58, v30, -v64
v_mul_f32 v62, v55, v37
v_fma_f32 v61, v58, v31, v65
v_mul_f32 v63, v55, v36
v_fma_f32 v56, v54, v36, -v62
v_cvt_pk_bf16_f32 v154, v58, v59
v_fma_f32 v57, v54, v37, v63
v_mul_f32 v64, v61, v31
v_cvt_pk_bf16_f32 v66, v54, v55
v_mul_f32 v65, v61, v30
ds_write_addtid_b32 v66 offset:1440
v_fma_f32 v58, v60, v30, -v64
v_mul_f32 v62, v57, v37
v_fma_f32 v59, v60, v31, v65
v_mul_f32 v63, v57, v36
v_cvt_pk_bf16_f32 v155, v60, v61
v_fma_f32 v54, v56, v36, -v62
v_fma_f32 v55, v56, v37, v63
v_mul_f32 v64, v59, v31
v_cvt_pk_bf16_f32 v66, v56, v57
v_mul_f32 v65, v59, v30
ds_write_addtid_b32 v66 offset:1728
v_fma_f32 v60, v58, v30, -v64
v_mul_f32 v62, v55, v37
v_fma_f32 v61, v58, v31, v65
v_mul_f32 v63, v55, v36
v_cvt_pk_bf16_f32 v156, v58, v59
v_fma_f32 v56, v54, v36, -v62
v_mul_f32 v64, v61, v31
v_fma_f32 v57, v54, v37, v63
v_cvt_pk_bf16_f32 v66, v54, v55
v_mul_f32 v65, v61, v30
ds_write_addtid_b32 v66 offset:2016
v_fma_f32 v58, v60, v30, -v64
v_mul_f32 v62, v57, v37
v_fma_f32 v59, v60, v31, v65
v_mul_f32 v63, v57, v36
v_cvt_pk_bf16_f32 v157, v60, v61
v_fma_f32 v54, v56, v36, -v62
v_mul_f32 v64, v59, v31
v_fma_f32 v55, v56, v37, v63
v_cvt_pk_bf16_f32 v66, v56, v57
v_mul_f32 v65, v59, v30
ds_write_addtid_b32 v66 offset:2304
v_fma_f32 v60, v58, v30, -v64
v_mul_f32 v62, v55, v37
v_fma_f32 v61, v58, v31, v65
v_mul_f32 v63, v55, v36
v_cvt_pk_bf16_f32 v158, v58, v59
v_fma_f32 v56, v54, v36, -v62
v_mul_f32 v64, v61, v31
v_fma_f32 v57, v54, v37, v63
v_mul_f32 v65, v61, v30
v_cvt_pk_bf16_f32 v66, v54, v55
ds_write_addtid_b32 v66 offset:2592
v_fma_f32 v58, v60, v30, -v64
v_mul_f32 v62, v57, v37
v_fma_f32 v59, v60, v31, v65
v_mul_f32 v63, v57, v36
v_cvt_pk_bf16_f32 v159, v60, v61
s_barrier
v_fma_f32 v54, v56, v36, -v62
v_cvt_pk_bf16_f32 v160, v58, v59
v_fma_f32 v55, v56, v37, v63
v_mul_f32 v64, v41, v39
v_cvt_pk_bf16_f32 v66, v56, v57
v_mul_f32 v65, v41, v38
ds_write_addtid_b32 v66 offset:2880
v_mul_f32 v62, v55, v37
v_fma_f32 v42, v40, v38, -v64
v_mul_f32 v63, v55, v36
v_fma_f32 v43, v40, v39, v65
v_fma_f32 v56, v54, v36, -v62
v_mul_f32 v64, v43, v39
v_fma_f32 v57, v54, v37, v63
v_mul_f32 v65, v43, v38
v_cvt_pk_bf16_f32 v66, v54, v55
v_fma_f32 v44, v42, v38, -v64
ds_write_addtid_b32 v66 offset:3168
v_mul_f32 v62, v57, v37
v_fma_f32 v45, v42, v39, v65
v_mul_f32 v63, v57, v36
v_mul_f32 v64, v45, v39
v_fma_f32 v54, v56, v36, -v62
v_mul_f32 v65, v45, v38
v_fma_f32 v55, v56, v37, v63
v_fma_f32 v46, v44, v38, -v64
v_cvt_pk_bf16_f32 v66, v56, v57
v_fma_f32 v47, v44, v39, v65
ds_write_addtid_b32 v66 offset:3456
v_mul_f32 v64, v47, v39
v_mul_f32 v62, v55, v37
v_mul_f32 v63, v55, v36
v_mul_f32 v65, v47, v38
v_fma_f32 v56, v54, v36, -v62
v_fma_f32 v48, v46, v38, -v64
v_fma_f32 v57, v54, v37, v63
v_fma_f32 v49, v46, v39, v65
v_cvt_pk_bf16_f32 v66, v54, v55
v_mul_f32 v64, v49, v39
ds_write_addtid_b32 v66 offset:3744
v_mul_f32 v65, v49, v38
v_mul_f32 v62, v57, v37
v_mul_f32 v63, v57, v36
v_fma_f32 v50, v48, v38, -v64
v_fma_f32 v54, v56, v36, -v62
v_fma_f32 v51, v48, v39, v65
v_fma_f32 v55, v56, v37, v63
v_mul_f32 v64, v51, v39
v_cvt_pk_bf16_f32 v66, v56, v57
v_mul_f32 v65, v51, v38
ds_write_addtid_b32 v66 offset:4032
v_fma_f32 v52, v50, v38, -v64
v_cvt_pk_bf16_f32 v66, v54, v55
v_fma_f32 v53, v50, v39, v65
ds_write_addtid_b32 v66 offset:4320
ds_read_b128 v[120:123], v68 offset:0
ds_read_b128 v[124:127], v68 offset:64
ds_read_b128 v[128:131], v68 offset:128
ds_read_b128 v[132:135], v68 offset:192
ds_write_addtid_b32 v152 offset:0
ds_write_addtid_b32 v153 offset:288
ds_write_addtid_b32 v154 offset:576
ds_write_addtid_b32 v155 offset:864
ds_write_addtid_b32 v156 offset:1152
ds_write_addtid_b32 v157 offset:1440
ds_write_addtid_b32 v158 offset:1728
ds_write_addtid_b32 v159 offset:2016
ds_write_addtid_b32 v160 offset:2304
s_barrier
ds_read_b128 v[136:139], v69 offset:0
ds_read_b128 v[140:143], v69 offset:64
ds_read_b128 v[144:147], v69 offset:128
ds_read_b128 v[148:151], v69 offset:192
v_mul_f32 v62, v27, v29
v_mul_f32 v64, v31, v31
v_mul_f32 v63, v27, v28
v_mul_f32 v65, v30, v31
v_fma_f32 v56, v26, v28, -v62
v_fma_f32 v32, v30, v30, -v64
v_fma_f32 v57, v26, v29, v63
v_add_f32 v33, v65, v65
v_cvt_pk_bf16_f32 v66, v26, v27
v_mul_f32 v64, v33, v33
ds_write_addtid_b32 v66 offset:0
v_mul_f32 v62, v57, v29
v_mul_f32 v65, v32, v33
v_mul_f32 v63, v57, v28
v_fma_f32 v34, v32, v32, -v64
v_fma_f32 v54, v56, v28, -v62
v_add_f32 v35, v65, v65
v_fma_f32 v55, v56, v29, v63
s_waitcnt lgkmcnt(1)
v_cvt_pk_bf16_f32 v66, v56, v57
v_mfma_f32_16x16x32_bf16 v[92:95], v[136:139], v[120:123], 0
ds_write_addtid_b32 v66 offset:288
v_mul_f32 v62, v55, v29
v_mfma_f32_16x16x32_bf16 v[92:95], v[140:143], v[124:127], v[92:95]
v_mul_f32 v63, v55, v28
v_mfma_f32_16x16x32_bf16 v[92:95], v[144:147], v[128:131], v[92:95]
v_fma_f32 v56, v54, v28, -v62
v_mfma_f32_16x16x32_bf16 v[92:95], v[148:151], v[132:135], v[92:95]
v_fma_f32 v57, v54, v29, v63
v_mul_f32 v64, v43, v33
v_cvt_pk_bf16_f32 v66, v54, v55
v_mul_f32 v65, v43, v32
ds_write_addtid_b32 v66 offset:576
v_mul_f32 v62, v57, v29
v_fma_f32 v60, v42, v32, -v64
v_mul_f32 v63, v57, v28
v_fma_f32 v61, v42, v33, v65
v_fma_f32 v54, v56, v28, -v62
v_cvt_pk_bf16_f32 v152, v42, v43
v_fma_f32 v55, v56, v29, v63
v_mul_f32 v64, v61, v33
v_cvt_pk_bf16_f32 v66, v56, v57
v_mul_f32 v65, v61, v32
ds_write_addtid_b32 v66 offset:864
v_fma_f32 v58, v60, v32, -v64
v_mul_f32 v62, v55, v29
v_mul_f32 v63, v55, v28
v_fma_f32 v59, v60, v33, v65
v_fma_f32 v56, v54, v28, -v62
v_cvt_pk_bf16_f32 v153, v60, v61
v_fma_f32 v57, v54, v29, v63
v_mul_f32 v64, v59, v33
v_cvt_pk_bf16_f32 v66, v54, v55
s_barrier
v_mul_f32 v65, v59, v32
ds_write_addtid_b32 v66 offset:1152
v_fma_f32 v60, v58, v32, -v64
v_mul_f32 v62, v57, v29
v_mul_f32 v63, v57, v28
v_fma_f32 v61, v58, v33, v65
v_fma_f32 v54, v56, v28, -v62
v_cvt_pk_bf16_f32 v154, v58, v59
v_fma_f32 v55, v56, v29, v63
v_mul_f32 v64, v61, v33
v_cvt_pk_bf16_f32 v66, v56, v57
v_mul_f32 v65, v61, v32
ds_write_addtid_b32 v66 offset:1440
v_fma_f32 v58, v60, v32, -v64
v_mul_f32 v62, v55, v29
v_mul_f32 v63, v55, v28
v_fma_f32 v59, v60, v33, v65
v_fma_f32 v56, v54, v28, -v62
v_cvt_pk_bf16_f32 v155, v60, v61
v_fma_f32 v57, v54, v29, v63
v_cvt_pk_bf16_f32 v156, v58, v59
v_cvt_pk_bf16_f32 v66, v54, v55
v_mul_f32 v64, v45, v33
ds_write_addtid_b32 v66 offset:1728
v_mul_f32 v65, v45, v32
v_mul_f32 v62, v57, v29
v_mul_f32 v63, v57, v28
v_fma_f32 v60, v44, v32, -v64
v_fma_f32 v54, v56, v28, -v62
v_fma_f32 v61, v44, v33, v65
v_fma_f32 v55, v56, v29, v63
v_cvt_pk_bf16_f32 v157, v44, v45
v_cvt_pk_bf16_f32 v66, v56, v57
v_mul_f32 v64, v61, v33
ds_write_addtid_b32 v66 offset:2016
v_mul_f32 v65, v61, v32
v_mul_f32 v62, v55, v29
v_mul_f32 v63, v55, v28
v_fma_f32 v58, v60, v32, -v64
v_fma_f32 v56, v54, v28, -v62
v_fma_f32 v59, v60, v33, v65
v_fma_f32 v57, v54, v29, v63
v_cvt_pk_bf16_f32 v158, v60, v61
v_cvt_pk_bf16_f32 v66, v54, v55
v_mul_f32 v64, v59, v33
ds_write_addtid_b32 v66 offset:2304
v_mul_f32 v65, v59, v32
v_mul_f32 v62, v57, v29
v_mul_f32 v63, v57, v28
v_fma_f32 v60, v58, v32, -v64
v_fma_f32 v54, v56, v28, -v62
v_fma_f32 v61, v58, v33, v65
v_fma_f32 v55, v56, v29, v63
v_cvt_pk_bf16_f32 v159, v58, v59
v_cvt_pk_bf16_f32 v66, v56, v57
v_mul_f32 v64, v61, v33
ds_write_addtid_b32 v66 offset:2592
v_mul_f32 v65, v61, v32
v_mul_f32 v62, v55, v29
v_mul_f32 v63, v55, v28
v_fma_f32 v58, v60, v32, -v64
v_fma_f32 v56, v54, v28, -v62
v_fma_f32 v59, v60, v33, v65
v_fma_f32 v57, v54, v29, v63
v_cvt_pk_bf16_f32 v160, v60, v61
v_cvt_pk_bf16_f32 v66, v54, v55
v_cvt_pk_bf16_f32 v161, v58, v59
ds_write_addtid_b32 v66 offset:2880
v_mul_f32 v64, v47, v35
v_mul_f32 v62, v57, v29
v_mul_f32 v63, v57, v28
v_mul_f32 v65, v47, v34
v_fma_f32 v54, v56, v28, -v62
v_fma_f32 v60, v46, v34, -v64
s_barrier
v_fma_f32 v55, v56, v29, v63
v_fma_f32 v61, v46, v35, v65
v_cvt_pk_bf16_f32 v66, v56, v57
v_cvt_pk_bf16_f32 v162, v46, v47
ds_write_addtid_b32 v66 offset:3168
v_mul_f32 v64, v61, v35
v_mul_f32 v62, v55, v29
v_mul_f32 v65, v61, v34
v_mul_f32 v63, v55, v28
v_fma_f32 v56, v54, v28, -v62
v_fma_f32 v58, v60, v34, -v64
v_fma_f32 v57, v54, v29, v63
v_fma_f32 v59, v60, v35, v65
v_cvt_pk_bf16_f32 v66, v54, v55
v_cvt_pk_bf16_f32 v163, v60, v61
ds_write_addtid_b32 v66 offset:3456
v_cvt_pk_bf16_f32 v164, v58, v59
v_mul_f32 v62, v57, v29
v_mul_f32 v64, v49, v35
v_mul_f32 v63, v57, v28
v_fma_f32 v54, v56, v28, -v62
v_mul_f32 v65, v49, v34
v_fma_f32 v55, v56, v29, v63
v_fma_f32 v60, v48, v34, -v64
v_cvt_pk_bf16_f32 v66, v56, v57
v_fma_f32 v61, v48, v35, v65
ds_write_addtid_b32 v66 offset:3744
v_cvt_pk_bf16_f32 v165, v48, v49
v_mul_f32 v62, v55, v29
v_mul_f32 v64, v61, v35
v_mul_f32 v63, v55, v28
v_fma_f32 v56, v54, v28, -v62
v_mul_f32 v65, v61, v34
v_fma_f32 v57, v54, v29, v63
v_fma_f32 v58, v60, v34, -v64
v_cvt_pk_bf16_f32 v66, v54, v55
v_fma_f32 v59, v60, v35, v65
ds_write_addtid_b32 v66 offset:4032
v_cvt_pk_bf16_f32 v166, v60, v61
v_cvt_pk_bf16_f32 v66, v56, v57
v_cvt_pk_bf16_f32 v167, v58, v59
ds_write_addtid_b32 v66 offset:4320
ds_read_b128 v[136:139], v68 offset:0
ds_read_b128 v[140:143], v68 offset:64
ds_read_b128 v[144:147], v68 offset:128
ds_read_b128 v[148:151], v68 offset:192
ds_write_addtid_b32 v152 offset:0
ds_write_addtid_b32 v153 offset:288
ds_write_addtid_b32 v154 offset:576
ds_write_addtid_b32 v155 offset:864
ds_write_addtid_b32 v156 offset:1152
ds_write_addtid_b32 v157 offset:1440
ds_write_addtid_b32 v158 offset:1728
ds_write_addtid_b32 v159 offset:2016
ds_write_addtid_b32 v160 offset:2304
ds_write_addtid_b32 v161 offset:2592
ds_write_addtid_b32 v162 offset:2880
ds_write_addtid_b32 v163 offset:3168
ds_write_addtid_b32 v164 offset:3456
ds_write_addtid_b32 v165 offset:3744
ds_write_addtid_b32 v166 offset:4032
ds_write_addtid_b32 v167 offset:4320
ds_read_b128 v[16:19], v70 offset:0
ds_read_b128 v[20:23], v70 offset:64
s_barrier
ds_read_b128 v[24:27], v70 offset:128
ds_read_b128 v[28:31], v70 offset:192
v_mul_f32 v62, v51, v35
v_mul_f32 v64, v53, v35
v_mul_f32 v63, v51, v34
v_mul_f32 v65, v53, v34
v_fma_f32 v56, v50, v34, -v62
v_fma_f32 v60, v52, v34, -v64
v_fma_f32 v57, v50, v35, v63
v_fma_f32 v61, v52, v35, v65
v_cvt_pk_bf16_f32 v152, v50, v51
v_cvt_pk_bf16_f32 v155, v52, v53
v_mul_f32 v62, v57, v35
s_waitcnt lgkmcnt(15)
v_mfma_f32_16x16x32_bf16 v[88:91], v[136:139], v[120:123], 0
v_mfma_f32_16x16x32_bf16 v[88:91], v[140:143], v[124:127], v[88:91]
v_mfma_f32_16x16x32_bf16 v[88:91], v[144:147], v[128:131], v[88:91]
v_mfma_f32_16x16x32_bf16 v[88:91], v[148:151], v[132:135], v[88:91]
ds_read_b128 v[136:139], v70 offset:1440
ds_read_b128 v[140:143], v70 offset:1504
ds_read_b128 v[144:147], v70 offset:1568
ds_read_b128 v[148:151], v70 offset:1632
v_mul_f32 v64, v61, v35
v_mul_f32 v63, v57, v34
v_mul_f32 v65, v61, v34
v_fma_f32 v54, v56, v34, -v62
v_fma_f32 v58, v60, v34, -v64
v_fma_f32 v55, v56, v35, v63
v_fma_f32 v59, v60, v35, v65
v_cvt_pk_bf16_f32 v153, v56, v57
v_cvt_pk_bf16_f32 v156, v60, v61
v_cvt_pk_bf16_f32 v154, v54, v55
v_cvt_pk_bf16_f32 v157, v58, v59
s_waitcnt lgkmcnt(4)
v_mfma_f32_16x16x32_bf16 v[96:99], v[16:19], v[120:123], 0
v_mfma_f32_16x16x32_bf16 v[96:99], v[20:23], v[124:127], v[96:99]
v_mfma_f32_16x16x32_bf16 v[96:99], v[24:27], v[128:131], v[96:99]
v_mfma_f32_16x16x32_bf16 v[96:99], v[28:31], v[132:135], v[96:99]
ds_read_b128 v[16:19], v71 offset:2880
ds_read_b128 v[20:23], v71 offset:2944
ds_read_b128 v[24:27], v71 offset:3008
s_barrier
ds_read_b128 v[28:31], v71 offset:3072
s_waitcnt lgkmcnt(4)
v_mfma_f32_16x16x32_bf16 v[100:103], v[136:139], v[120:123], 0
v_mfma_f32_16x16x32_bf16 v[100:103], v[140:143], v[124:127], v[100:103]
v_mfma_f32_16x16x32_bf16 v[100:103], v[144:147], v[128:131], v[100:103]
v_mfma_f32_16x16x32_bf16 v[100:103], v[148:151], v[132:135], v[100:103]
ds_read_b128 v[136:139], v71 offset:3744
ds_read_b128 v[140:143], v71 offset:3808
ds_read_b128 v[144:147], v71 offset:3872
ds_read_b128 v[148:151], v71 offset:3936
ds_write_addtid_b32 v152 offset:0
ds_write_addtid_b32 v153 offset:288
ds_write_addtid_b32 v154 offset:576
ds_write_addtid_b32 v155 offset:864
ds_write_addtid_b32 v156 offset:1152
ds_write_addtid_b32 v157 offset:1440
s_waitcnt lgkmcnt(10)
v_mfma_f32_16x16x32_bf16 v[104:107], v[16:19], v[120:123], 0
v_mfma_f32_16x16x32_bf16 v[104:107], v[20:23], v[124:127], v[104:107]
v_mfma_f32_16x16x32_bf16 v[104:107], v[24:27], v[128:131], v[104:107]
v_mfma_f32_16x16x32_bf16 v[104:107], v[28:31], v[132:135], v[104:107]
ds_read_b128 v[16:19], v71 offset:0
ds_read_b128 v[20:23], v71 offset:64
ds_read_b128 v[24:27], v71 offset:128
ds_read_b128 v[28:31], v71 offset:192
s_waitcnt lgkmcnt(10)
v_mfma_f32_16x16x32_bf16 v[108:111], v[136:139], v[120:123], 0
v_mfma_f32_16x16x32_bf16 v[108:111], v[140:143], v[124:127], v[108:111]
s_barrier
v_mfma_f32_16x16x32_bf16 v[108:111], v[144:147], v[128:131], v[108:111]
v_mfma_f32_16x16x32_bf16 v[108:111], v[148:151], v[132:135], v[108:111]
ds_read_b128 v[136:139], v71 offset:864
ds_read_b128 v[140:143], v71 offset:928
ds_read_b128 v[144:147], v71 offset:992
ds_read_b128 v[148:151], v71 offset:1056
s_waitcnt lgkmcnt(4)
v_mfma_f32_16x16x32_bf16 v[112:115], v[16:19], v[120:123], 0
v_mfma_f32_16x16x32_bf16 v[112:115], v[20:23], v[124:127], v[112:115]
v_mfma_f32_16x16x32_bf16 v[112:115], v[24:27], v[128:131], v[112:115]
v_mfma_f32_16x16x32_bf16 v[112:115], v[28:31], v[132:135], v[112:115]
s_waitcnt lgkmcnt(0)
v_mfma_f32_16x16x32_bf16 v[116:119], v[136:139], v[120:123], 0
v_mfma_f32_16x16x32_bf16 v[116:119], v[140:143], v[124:127], v[116:119]
v_mfma_f32_16x16x32_bf16 v[116:119], v[144:147], v[128:131], v[116:119]
v_mfma_f32_16x16x32_bf16 v[116:119], v[148:151], v[132:135], v[116:119]
s_nop 7
s_mul_i32 s38, s37, 4896
s_add_u32 s38, s38, 131328
v_lshl_add_u32 v62, v1, 4, s38
s_bitcmp1_b32 s37, 0
s_cbranch_scc1 kx1_59
ds_write_b128 v62, v[104:107] offset:0
ds_write_b128 v62, v[108:111] offset:1024
ds_write_b128 v62, v[112:115] offset:2048
ds_write_b128 v62, v[116:119] offset:3072
s_branch kxe_60
kx1_59:
ds_write_b128 v62, v[88:91] offset:0
ds_write_b128 v62, v[92:95] offset:1024
ds_write_b128 v62, v[96:99] offset:2048
ds_write_b128 v62, v[100:103] offset:3072
kxe_60:
s_waitcnt lgkmcnt(0)
s_barrier
s_xor_b32 s38, s37, 1
s_mul_i32 s38, s38, 4896
s_add_u32 s38, s38, 131328
v_lshl_add_u32 v62, v1, 4, s38
ds_read_b128 v[136:139], v62 offset:0
ds_read_b128 v[140:143], v62 offset:1024
ds_read_b128 v[144:147], v62 offset:2048
ds_read_b128 v[148:151], v62 offset:3072
s_mul_i32 s38, s36, 4112
s_add_u32 s38, s38, 11534336
v_lshlrev_b32 v3, 16, v3
v_cmp_eq_u32 vcc, 0, v1
v_and_b32 v64, 3, v1
v_mov_b32 v65, 0
v_lshlrev_b32 v64, 2, v64
s_add_u32 s39, s38, 4096
buffer_store_dword v65, v64, s[20:23], s39 offen
s_bitcmp1_b32 s37, 0
s_cselect_b64 vcc, 0, vcc
s_nop 1
v_cndmask_b32 v3, 0, v3, vcc
s_bitcmp1_b32 s37, 0
s_cbranch_scc0 kf1_61
v_mov_b32 v88, v104
v_mov_b32 v89, v105
v_mov_b32 v90, v106
v_mov_b32 v91, v107
v_mov_b32 v92, v108
v_mov_b32 v93, v109
v_mov_b32 v94, v110
v_mov_b32 v95, v111
v_mov_b32 v96, v112
v_mov_b32 v97, v113
v_mov_b32 v98, v114
v_mov_b32 v99, v115
v_mov_b32 v100, v116
v_mov_b32 v101, v117
v_mov_b32 v102, v118
v_mov_b32 v103, v119
s_sub_u32 s38, s38, 2048
kf1_61:
s_add_u32 s38, s38, 2048
s_waitcnt lgkmcnt(0)
v_add_f32 v88, v88, v3
v_add_f32 v88, v88, v136
v_add_f32 v89, v89, v137
v_add_f32 v90, v90, v138
v_add_f32 v91, v91, v139
v_add_f32 v92, v92, v140
v_add_f32 v93, v93, v141
v_add_f32 v94, v94, v142
v_add_f32 v95, v95, v143
v_add_f32 v96, v96, v144
v_add_f32 v97, v97, v145
v_add_f32 v98, v98, v146
v_add_f32 v99, v99, v147
v_add_f32 v100, v100, v148
v_add_f32 v101, v101, v149
v_add_f32 v102, v102, v150
v_add_f32 v103, v103, v151
v_cvt_pk_bf16_f32 v152, v91, v90
v_cvt_pk_bf16_f32 v153, v89, v88
buffer_store_dwordx2 v[152:153], v2, s[20:23], s38 offen offset:1536
v_cvt_pk_bf16_f32 v154, v95, v94
v_cvt_pk_bf16_f32 v155, v93, v92
buffer_store_dwordx2 v[154:155], v2, s[20:23], s38 offen offset:1024
v_cvt_pk_bf16_f32 v156, v99, v98
v_cvt_pk_bf16_f32 v157, v97, v96
buffer_store_dwordx2 v[156:157], v2, s[20:23], s38 offen offset:512
v_cvt_pk_bf16_f32 v158, v103, v102
v_cvt_pk_bf16_f32 v159, v101, v100
buffer_store_dwordx2 v[158:159], v2, s[20:23], s38 offen offset:0
v_and_b32 v16, 31, v1
s_lshl_b32 s31, s30, 5
v_add_u32 v16, s31, v16
v_mul_u32_u24 v16, 200, v16
v_lshrrev_b32 v17, 5, v1
v_add_u32 v16, 143104, v16
v_lshl_add_u32 v72, v17, 3, v16
v_mul_u32_u24 v18, 20, v17
v_add_u32 v73, v16, v18
s_and_b32 s31, s24, 3
v_lshrrev_b32 v16, 5, v1
v_bfe_u32 v17, v1, 2, 2
v_lshl_add_u32 v16, v16, 3, v17
v_bfe_u32 v17, v1, 4, 1
v_and_b32 v18, 3, v1
v_lshl_add_u32 v17, v17, 2, v18
v_mul_u32_u24 v19, 328, v16
s_mul_i32 s32, s31, 80
s_add_u32 s32, s32, 122112
v_add_u32 v19, s32, v19
v_lshl_add_u32 v74, v17, 3, v19
v_and_b32 v18, 1, v1
v_lshl_add_u32 v75, v18, 3, v19
v_add_u32 v75, 64, v75
v_min_u32 v17, 5, v17
v_mul_u32_u24 v19, 200, v16
s_mul_i32 s32, s31, 48
s_add_u32 s32, s32, 143104
v_add_u32 v19, s32, v19
v_lshl_add_u32 v76, v17, 3, v19
s_barrier
s_setprio 0
ds_read_b128 v[16:19], v5 offset:0
ds_read_b64_tr_b16 v[20:21], v13 offset:34560
ds_read_b64_tr_b16 v[22:23], v13 offset:35136
ds_read_b64_tr_b16 v[24:25], v14 offset:34560
ds_read_b64_tr_b16 v[26:27], v14 offset:35136
ds_read_b128 v[28:31], v6 offset:0
ds_read_b64_tr_b16 v[32:33], v13 offset:36864
ds_read_b64_tr_b16 v[34:35], v13 offset:37440
ds_read_b64_tr_b16 v[36:37], v14 offset:36864
ds_read_b64_tr_b16 v[38:39], v14 offset:37440
s_waitcnt lgkmcnt(5)
v_mfma_f32_32x32x16_bf16 v[40:55], v[20:23], v[16:19], 0
ds_read_b128 v[104:107], v7 offset:0
ds_read_b64_tr_b16 v[108:109], v13 offset:39168
ds_read_b64_tr_b16 v[110:111], v13 offset:39744
v_mfma_f32_32x32x16_bf16 v[56:71], v[24:27], v[16:19], 0
ds_read_b64_tr_b16 v[112:113], v14 offset:39168
ds_read_b64_tr_b16 v[114:115], v14 offset:39744
s_waitcnt lgkmcnt(5)
v_mfma_f32_32x32x16_bf16 v[40:55], v[32:35], v[28:31], v[40:55]
ds_read_b128 v[16:19], v8 offset:0
ds_read_b64_tr_b16 v[20:21], v13 offset:41472
ds_read_b64_tr_b16 v[22:23], v13 offset:42048
v_mfma_f32_32x32x16_bf16 v[56:71], v[36:39], v[28:31], v[56:71]
ds_read_b64_tr_b16 v[24:25], v14 offset:41472
ds_read_b64_tr_b16 v[26:27], v14 offset:42048
s_waitcnt lgkmcnt(5)
s_barrier
v_mfma_f32_32x32x16_bf16 v[40:55], v[108:111], v[104:107], v[40:55]
ds_read_b128 v[28:31], v5 offset:8192
ds_read_b64_tr_b16 v[32:33], v13 offset:43776
ds_read_b64_tr_b16 v[34:35], v13 offset:44352
v_mfma_f32_32x32x16_bf16 v[56:71], v[112:115], v[104:107], v[56:71]
ds_read_b64_tr_b16 v[36:37], v14 offset:43776
ds_read_b64_tr_b16 v[38:39], v14 offset:44352
s_waitcnt lgkmcnt(5)
v_mfma_f32_32x32x16_bf16 v[40:55], v[20:23], v[16:19], v[40:55]
ds_read_b128 v[104:107], v6 offset:8192
ds_read_b64_tr_b16 v[108:109], v13 offset:46080
ds_read_b64_tr_b16 v[110:111], v13 offset:46656
v_mfma_f32_32x32x16_bf16 v[56:71], v[24:27], v[16:19], v[56:71]
ds_read_b64_tr_b16 v[112:113], v14 offset:46080
ds_read_b64_tr_b16 v[114:115], v14 offset:46656
s_waitcnt lgkmcnt(5)
v_mfma_f32_32x32x16_bf16 v[40:55], v[32:35], v[28:31], v[40:55]
ds_read_b128 v[16:19], v7 offset:8192
ds_read_b64_tr_b16 v[20:21], v13 offset:0
ds_read_b64_tr_b16 v[22:23], v13 offset:576
v_mfma_f32_32x32x16_bf16 v[56:71], v[36:39], v[28:31], v[56:71]
ds_read_b64_tr_b16 v[24:25], v14 offset:0
ds_read_b64_tr_b16 v[26:27], v14 offset:576
s_waitcnt lgkmcnt(5)
v_mfma_f32_32x32x16_bf16 v[40:55], v[108:111], v[104:107], v[40:55]
ds_read_b128 v[28:31], v8 offset:8192
ds_read_b64_tr_b16 v[32:33], v13 offset:2304
ds_read_b64_tr_b16 v[34:35], v13 offset:2880
v_mfma_f32_32x32x16_bf16 v[56:71], v[112:115], v[104:107], v[56:71]
ds_read_b64_tr_b16 v[36:37], v14 offset:2304
ds_read_b64_tr_b16 v[38:39], v14 offset:2880
s_waitcnt lgkmcnt(5)
s_barrier
v_mfma_f32_32x32x16_bf16 v[40:55], v[20:23], v[16:19], v[40:55]
ds_read_b128 v[104:107], v5 offset:16384
ds_read_b64_tr_b16 v[108:109], v13 offset:4608
ds_read_b64_tr_b16 v[110:111], v13 offset:5184
v_mfma_f32_32x32x16_bf16 v[56:71], v[24:27], v[16:19], v[56:71]
ds_read_b64_tr_b16 v[112:113], v14 offset:4608
ds_read_b64_tr_b16 v[114:115], v14 offset:5184
s_waitcnt lgkmcnt(5)
v_mfma_f32_32x32x16_bf16 v[40:55], v[32:35], v[28:31], v[40:55]
ds_read_b128 v[16:19], v6 offset:16384
ds_read_b64_tr_b16 v[20:21], v13 offset:6912
ds_read_b64_tr_b16 v[22:23], v13 offset:7488
v_mfma_f32_32x32x16_bf16 v[56:71], v[36:39], v[28:31], v[56:71]
ds_read_b64_tr_b16 v[24:25], v14 offset:6912
ds_read_b64_tr_b16 v[26:27], v14 offset:7488
s_waitcnt lgkmcnt(5)
v_mfma_f32_32x32x16_bf16 v[40:55], v[108:111], v[104:107], v[40:55]
ds_read_b128 v[28:31], v7 offset:16384
ds_read_b64_tr_b16 v[32:33], v13 offset:9216
ds_read_b64_tr_b16 v[34:35], v13 offset:9792
v_mfma_f32_32x32x16_bf16 v[56:71], v[112:115], v[104:107], v[56:71]
ds_read_b64_tr_b16 v[36:37], v14 offset:9216
ds_read_b64_tr_b16 v[38:39], v14 offset:9792
s_waitcnt lgkmcnt(5)
v_mfma_f32_32x32x16_bf16 v[40:55], v[20:23], v[16:19], v[40:55]
ds_read_b128 v[104:107], v8 offset:16384
ds_read_b64_tr_b16 v[108:109], v13 offset:11520
ds_read_b64_tr_b16 v[110:111], v13 offset:12096
v_mfma_f32_32x32x16_bf16 v[56:71], v[24:27], v[16:19], v[56:71]
ds_read_b64_tr_b16 v[112:113], v14 offset:11520
ds_read_b64_tr_b16 v[114:115], v14 offset:12096
s_waitcnt lgkmcnt(5)
s_barrier
v_mfma_f32_32x32x16_bf16 v[40:55], v[32:35], v[28:31], v[40:55]
ds_read_b128 v[16:19], v5 offset:24576
ds_read_b64_tr_b16 v[20:21], v13 offset:13824
ds_read_b64_tr_b16 v[22:23], v13 offset:14400
v_mfma_f32_32x32x16_bf16 v[56:71], v[36:39], v[28:31], v[56:71]
ds_read_b64_tr_b16 v[24:25], v14 offset:13824
ds_read_b64_tr_b16 v[26:27], v14 offset:14400
s_waitcnt lgkmcnt(5)
v_mfma_f32_32x32x16_bf16 v[40:55], v[108:111], v[104:107], v[40:55]
ds_read_b128 v[28:31], v6 offset:24576
ds_read_b64_tr_b16 v[32:33], v13 offset:16128
ds_read_b64_tr_b16 v[34:35], v13 offset:16704
v_mfma_f32_32x32x16_bf16 v[56:71], v[112:115], v[104:107], v[56:71]
ds_read_b64_tr_b16 v[36:37], v14 offset:16128
ds_read_b64_tr_b16 v[38:39], v14 offset:16704
s_waitcnt lgkmcnt(5)
v_mfma_f32_32x32x16_bf16 v[40:55], v[20:23], v[16:19], v[40:55]
ds_read_b128 v[104:107], v7 offset:24576
ds_read_b64_tr_b16 v[108:109], v13 offset:18432
ds_read_b64_tr_b16 v[110:111], v13 offset:19008
v_mfma_f32_32x32x16_bf16 v[56:71], v[24:27], v[16:19], v[56:71]
ds_read_b64_tr_b16 v[112:113], v14 offset:18432
ds_read_b64_tr_b16 v[114:115], v14 offset:19008
s_waitcnt lgkmcnt(5)
v_mfma_f32_32x32x16_bf16 v[40:55], v[32:35], v[28:31], v[40:55]
ds_read_b128 v[16:19], v8 offset:24576
ds_read_b64_tr_b16 v[20:21], v13 offset:20736
ds_read_b64_tr_b16 v[22:23], v13 offset:21312
v_mfma_f32_32x32x16_bf16 v[56:71], v[36:39], v[28:31], v[56:71]
ds_read_b64_tr_b16 v[24:25], v14 offset:20736
ds_read_b64_tr_b16 v[26:27], v14 offset:21312
s_waitcnt lgkmcnt(5)
s_barrier
v_mfma_f32_32x32x16_bf16 v[40:55], v[108:111], v[104:107], v[40:55]
ds_read_b128 v[28:31], v5 offset:32768
ds_read_b64_tr_b16 v[32:33], v13 offset:23040
ds_read_b64_tr_b16 v[34:35], v13 offset:23616
v_mfma_f32_32x32x16_bf16 v[56:71], v[112:115], v[104:107], v[56:71]
ds_read_b64_tr_b16 v[36:37], v14 offset:23040
ds_read_b64_tr_b16 v[38:39], v14 offset:23616
s_waitcnt lgkmcnt(5)
v_mfma_f32_32x32x16_bf16 v[40:55], v[20:23], v[16:19], v[40:55]
ds_read_b128 v[104:107], v6 offset:32768
ds_read_b64_tr_b16 v[108:109], v13 offset:25344
ds_read_b64_tr_b16 v[110:111], v13 offset:25920
v_mfma_f32_32x32x16_bf16 v[56:71], v[24:27], v[16:19], v[56:71]
ds_read_b64_tr_b16 v[112:113], v14 offset:25344
ds_read_b64_tr_b16 v[114:115], v14 offset:25920
s_waitcnt lgkmcnt(5)
v_mfma_f32_32x32x16_bf16 v[40:55], v[32:35], v[28:31], v[40:55]
ds_read_b128 v[16:19], v7 offset:32768
ds_read_b64_tr_b16 v[20:21], v13 offset:27648
ds_read_b64_tr_b16 v[22:23], v13 offset:28224
v_mfma_f32_32x32x16_bf16 v[56:71], v[36:39], v[28:31], v[56:71]
ds_read_b64_tr_b16 v[24:25], v14 offset:27648
ds_read_b64_tr_b16 v[26:27], v14 offset:28224
s_waitcnt lgkmcnt(5)
v_mfma_f32_32x32x16_bf16 v[40:55], v[108:111], v[104:107], v[40:55]
ds_read_b128 v[28:31], v8 offset:32768
ds_read_b64_tr_b16 v[32:33], v13 offset:29952
ds_read_b64_tr_b16 v[34:35], v13 offset:30528
v_mfma_f32_32x32x16_bf16 v[56:71], v[112:115], v[104:107], v[56:71]
ds_read_b64_tr_b16 v[36:37], v14 offset:29952
ds_read_b64_tr_b16 v[38:39], v14 offset:30528
s_waitcnt lgkmcnt(5)
s_barrier
v_mfma_f32_32x32x16_bf16 v[40:55], v[20:23], v[16:19], v[40:55]
ds_read_b128 v[104:107], v5 offset:40960
ds_read_b64_tr_b16 v[108:109], v13 offset:32256
ds_read_b64_tr_b16 v[110:111], v13 offset:32832
v_mfma_f32_32x32x16_bf16 v[56:71], v[24:27], v[16:19], v[56:71]
ds_read_b64_tr_b16 v[112:113], v14 offset:32256
ds_read_b64_tr_b16 v[114:115], v14 offset:32832
s_waitcnt lgkmcnt(5)
v_mfma_f32_32x32x16_bf16 v[40:55], v[32:35], v[28:31], v[40:55]
ds_read_b128 v[16:19], v6 offset:40960
ds_read_b64_tr_b16 v[20:21], v13 offset:34560
ds_read_b64_tr_b16 v[22:23], v13 offset:35136
v_mfma_f32_32x32x16_bf16 v[56:71], v[36:39], v[28:31], v[56:71]
ds_read_b64_tr_b16 v[24:25], v14 offset:34560
ds_read_b64_tr_b16 v[26:27], v14 offset:35136
s_waitcnt lgkmcnt(5)
v_mfma_f32_32x32x16_bf16 v[40:55], v[108:111], v[104:107], v[40:55]
ds_read_b128 v[28:31], v7 offset:40960
ds_read_b64_tr_b16 v[32:33], v13 offset:36864
ds_read_b64_tr_b16 v[34:35], v13 offset:37440
v_mfma_f32_32x32x16_bf16 v[56:71], v[112:115], v[104:107], v[56:71]
ds_read_b64_tr_b16 v[36:37], v14 offset:36864
ds_read_b64_tr_b16 v[38:39], v14 offset:37440
s_waitcnt lgkmcnt(5)
v_mfma_f32_32x32x16_bf16 v[40:55], v[20:23], v[16:19], v[40:55]
ds_read_b128 v[104:107], v8 offset:40960
ds_read_b64_tr_b16 v[108:109], v13 offset:39168
ds_read_b64_tr_b16 v[110:111], v13 offset:39744
v_mfma_f32_32x32x16_bf16 v[56:71], v[24:27], v[16:19], v[56:71]
ds_read_b64_tr_b16 v[112:113], v14 offset:39168
ds_read_b64_tr_b16 v[114:115], v14 offset:39744
s_waitcnt lgkmcnt(5)
s_waitcnt vmcnt(0)
s_barrier
v_mfma_f32_32x32x16_bf16 v[40:55], v[32:35], v[28:31], v[40:55]
ds_read_b128 v[16:19], v5 offset:49152
ds_read_b64_tr_b16 v[20:21], v13 offset:41472
ds_read_b64_tr_b16 v[22:23], v13 offset:42048
v_mfma_f32_32x32x16_bf16 v[56:71], v[36:39], v[28:31], v[56:71]
ds_read_b64_tr_b16 v[24:25], v14 offset:41472
ds_read_b64_tr_b16 v[26:27], v14 offset:42048
s_waitcnt lgkmcnt(5)
v_mfma_f32_32x32x16_bf16 v[40:55], v[108:111], v[104:107], v[40:55]
ds_read_b128 v[28:31], v6 offset:49152
ds_read_b64_tr_b16 v[32:33], v13 offset:43776
ds_read_b64_tr_b16 v[34:35], v13 offset:44352
v_mfma_f32_32x32x16_bf16 v[56:71], v[112:115], v[104:107], v[56:71]
ds_read_b64_tr_b16 v[36:37], v14 offset:43776
ds_read_b64_tr_b16 v[38:39], v14 offset:44352
s_waitcnt lgkmcnt(5)
v_mfma_f32_32x32x16_bf16 v[40:55], v[20:23], v[16:19], v[40:55]
ds_read_b128 v[104:107], v7 offset:49152
ds_read_b64_tr_b16 v[108:109], v13 offset:46080
ds_read_b64_tr_b16 v[110:111], v13 offset:46656
v_mfma_f32_32x32x16_bf16 v[56:71], v[24:27], v[16:19], v[56:71]
ds_read_b64_tr_b16 v[112:113], v14 offset:46080
ds_read_b64_tr_b16 v[114:115], v14 offset:46656
s_waitcnt lgkmcnt(5)
v_mfma_f32_32x32x16_bf16 v[40:55], v[32:35], v[28:31], v[40:55]
ds_read_b128 v[16:19], v8 offset:49152
ds_read_b64_tr_b16 v[20:21], v13 offset:0
ds_read_b64_tr_b16 v[22:23], v13 offset:576
v_mfma_f32_32x32x16_bf16 v[56:71], v[36:39], v[28:31], v[56:71]
ds_read_b64_tr_b16 v[24:25], v14 offset:0
ds_read_b64_tr_b16 v[26:27], v14 offset:576
s_waitcnt lgkmcnt(5)
s_barrier
v_mfma_f32_32x32x16_bf16 v[40:55], v[108:111], v[104:107], v[40:55]
ds_read_b128 v[28:31], v5 offset:57344
ds_read_b64_tr_b16 v[32:33], v13 offset:2304
ds_read_b64_tr_b16 v[34:35], v13 offset:2880
v_mfma_f32_32x32x16_bf16 v[56:71], v[112:115], v[104:107], v[56:71]
ds_read_b64_tr_b16 v[36:37], v14 offset:2304
ds_read_b64_tr_b16 v[38:39], v14 offset:2880
s_waitcnt lgkmcnt(5)
v_mfma_f32_32x32x16_bf16 v[40:55], v[20:23], v[16:19], v[40:55]
ds_read_b128 v[104:107], v6 offset:57344
ds_read_b64_tr_b16 v[108:109], v13 offset:4608
ds_read_b64_tr_b16 v[110:111], v13 offset:5184
v_mfma_f32_32x32x16_bf16 v[56:71], v[24:27], v[16:19], v[56:71]
ds_read_b64_tr_b16 v[112:113], v14 offset:4608
ds_read_b64_tr_b16 v[114:115], v14 offset:5184
s_waitcnt lgkmcnt(5)
v_mfma_f32_32x32x16_bf16 v[40:55], v[32:35], v[28:31], v[40:55]
ds_read_b128 v[16:19], v7 offset:57344
ds_read_b64_tr_b16 v[20:21], v13 offset:6912
ds_read_b64_tr_b16 v[22:23], v13 offset:7488
v_mfma_f32_32x32x16_bf16 v[56:71], v[36:39], v[28:31], v[56:71]
ds_read_b64_tr_b16 v[24:25], v14 offset:6912
ds_read_b64_tr_b16 v[26:27], v14 offset:7488
s_waitcnt lgkmcnt(5)
v_mfma_f32_32x32x16_bf16 v[40:55], v[108:111], v[104:107], v[40:55]
ds_read_b128 v[28:31], v8 offset:57344
ds_read_b64_tr_b16 v[32:33], v13 offset:9216
ds_read_b64_tr_b16 v[34:35], v13 offset:9792
v_mfma_f32_32x32x16_bf16 v[56:71], v[112:115], v[104:107], v[56:71]
ds_read_b64_tr_b16 v[36:37], v14 offset:9216
ds_read_b64_tr_b16 v[38:39], v14 offset:9792
s_waitcnt lgkmcnt(5)
s_barrier
v_mfma_f32_32x32x16_bf16 v[40:55], v[20:23], v[16:19], v[40:55]
ds_read_b128 v[104:107], v9 offset:0
ds_read_b64_tr_b16 v[108:109], v13 offset:11520
ds_read_b64_tr_b16 v[110:111], v13 offset:12096
v_mfma_f32_32x32x16_bf16 v[56:71], v[24:27], v[16:19], v[56:71]
ds_read_b64_tr_b16 v[112:113], v14 offset:11520
ds_read_b64_tr_b16 v[114:115], v14 offset:12096
s_waitcnt lgkmcnt(5)
v_mfma_f32_32x32x16_bf16 v[40:55], v[32:35], v[28:31], v[40:55]
ds_read_b128 v[16:19], v10 offset:0
ds_read_b64_tr_b16 v[20:21], v13 offset:13824
ds_read_b64_tr_b16 v[22:23], v13 offset:14400
v_mfma_f32_32x32x16_bf16 v[56:71], v[36:39], v[28:31], v[56:71]
ds_read_b64_tr_b16 v[24:25], v14 offset:13824
ds_read_b64_tr_b16 v[26:27], v14 offset:14400
s_waitcnt lgkmcnt(5)
v_mfma_f32_32x32x16_bf16 v[40:55], v[108:111], v[104:107], v[40:55]
ds_read_b128 v[28:31], v11 offset:0
ds_read_b64_tr_b16 v[32:33], v13 offset:16128
ds_read_b64_tr_b16 v[34:35], v13 offset:16704
v_mfma_f32_32x32x16_bf16 v[56:71], v[112:115], v[104:107], v[56:71]
ds_read_b64_tr_b16 v[36:37], v14 offset:16128
ds_read_b64_tr_b16 v[38:39], v14 offset:16704
s_waitcnt lgkmcnt(5)
v_mfma_f32_32x32x16_bf16 v[40:55], v[20:23], v[16:19], v[40:55]
ds_read_b128 v[104:107], v12 offset:0
ds_read_b64_tr_b16 v[108:109], v13 offset:18432
ds_read_b64_tr_b16 v[110:111], v13 offset:19008
v_mfma_f32_32x32x16_bf16 v[56:71], v[24:27], v[16:19], v[56:71]
ds_read_b64_tr_b16 v[112:113], v14 offset:18432
ds_read_b64_tr_b16 v[114:115], v14 offset:19008
s_waitcnt lgkmcnt(0)
s_barrier
v_mfma_f32_32x32x16_bf16 v[40:55], v[32:35], v[28:31], v[40:55]
v_mfma_f32_32x32x16_bf16 v[56:71], v[36:39], v[28:31], v[56:71]
s_waitcnt lgkmcnt(0)
v_mfma_f32_32x32x16_bf16 v[40:55], v[108:111], v[104:107], v[40:55]
v_mfma_f32_32x32x16_bf16 v[56:71], v[112:115], v[104:107], v[56:71]
s_setprio 3
s_lshl_b32 s31, s59, 2
s_add_u32 s31, s31, 163824
v_mov_b32 v21, s31
s_nop 7
s_nop 3
v_cvt_pk_bf16_f32 v88, v40, v41
v_cvt_pk_bf16_f32 v89, v42, v43
v_cvt_pk_bf16_f32 v90, v44, v45
v_cvt_pk_bf16_f32 v91, v46, v47
v_cvt_pk_bf16_f32 v92, v48, v49
v_cvt_pk_bf16_f32 v93, v50, v51
v_cvt_pk_bf16_f32 v94, v52, v53
v_cvt_pk_bf16_f32 v95, v54, v55
v_cvt_pk_bf16_f32 v96, v56, v57
v_cvt_pk_bf16_f32 v97, v58, v59
s_cmp_eq_u32 s29, 1
s_cbranch_scc1 vw_j1_66
ds_write_b32 v72, v88 offset:0
ds_write_b32 v72, v89 offset:4
ds_write_b32 v72, v90 offset:16
ds_write_b32 v72, v91 offset:20
ds_write_b32 v73, v92 offset:32
ds_write_b32 v72, v93 offset:48
ds_write_b32 v72, v94 offset:60
ds_write_b32 v72, v95 offset:64
s_branch vw_end_67
vw_j1_66:
ds_write_b32 v72, v88 offset:104
ds_write_b32 v72, v89 offset:108
ds_write_b32 v72, v90 offset:120
ds_write_b32 v73, v91 offset:124
ds_write_b32 v72, v92 offset:148
ds_write_b32 v72, v93 offset:152
ds_write_b32 v72, v94 offset:164
ds_write_b32 v72, v95 offset:168
vw_end_67:
ds_write_b32 v73, v96 offset:76
ds_write_b32 v73, v97 offset:80
s_waitcnt lgkmcnt(0)
v_mov_b32 v22, 1
s_mov_b64 exec, 1
ds_write_b32 v21, v22
s_mov_b64 exec, -1
s_mov_b64 s[6:7], exec
s_mov_b64 exec, 1
v_mov_b32 v20, 163824
s_mov_b32 s31, 65536
lw_68:
ds_read_b128 v[16:19], v20
s_sub_u32 s31, s31, 1
s_cbranch_scc1 lx_69
s_waitcnt lgkmcnt(0)
v_min3_u32 v16, v16, v17, v18
v_min_u32 v16, v16, v19
v_cmp_le_u32 vcc, 1, v16
s_cbranch_vccz lw_68
lx_69:
s_waitcnt lgkmcnt(0)
s_mov_b64 exec, s[6:7]
ds_read_b64_tr_b16 v[88:89], v74 offset:0
ds_read_b64_tr_b16 v[120:121], v76 offset:0
ds_read_b64_tr_b16 v[104:105], v75 offset:0
ds_read_b64_tr_b16 v[90:91], v74 offset:1312
ds_read_b64_tr_b16 v[122:123], v76 offset:800
ds_read_b64_tr_b16 v[106:107], v75 offset:1312
ds_read_b64_tr_b16 v[92:93], v74 offset:5248
ds_read_b64_tr_b16 v[124:125], v76 offset:3200
ds_read_b64_tr_b16 v[108:109], v75 offset:5248
ds_read_b64_tr_b16 v[94:95], v74 offset:6560
ds_read_b64_tr_b16 v[126:127], v76 offset:4000
ds_read_b64_tr_b16 v[110:111], v75 offset:6560
ds_read_b64_tr_b16 v[96:97], v74 offset:10496
ds_read_b64_tr_b16 v[128:129], v76 offset:6400
ds_read_b64_tr_b16 v[112:113], v75 offset:10496
ds_read_b64_tr_b16 v[98:99], v74 offset:11808
ds_read_b64_tr_b16 v[130:131], v76 offset:7200
ds_read_b64_tr_b16 v[114:115], v75 offset:11808
ds_read_b64_tr_b16 v[100:101], v74 offset:15744
ds_read_b64_tr_b16 v[132:133], v76 offset:9600
ds_read_b64_tr_b16 v[116:117], v75 offset:15744
ds_read_b64_tr_b16 v[102:103], v74 offset:17056
ds_read_b64_tr_b16 v[134:135], v76 offset:10400
ds_read_b64_tr_b16 v[118:119], v75 offset:17056
v_and_b32 v136, 31, v1
v_lshrrev_b32 v137, 5, v1
v_cmp_gt_u32 vcc, 19, v136
v_cmp_eq_u32 s[44:45], 20, v136
s_or_b64 s[44:45], s[44:45], vcc
v_min_u32 v136, 19, v136
v_mul_u32_u24 v137, 20, v137
v_add_u32 v136, v136, v137
v_lshlrev_b32 v136, 4, v136
s_lshl_b32 s47, s26, 5
s_add_u32 s47, s47, s25
s_lshl_b32 s47, s47, 2
s_and_b32 s31, s24, 3
s_add_u32 s47, s47, s31
s_mul_i32 s47, s47, 1920
s_add_u32 s47, s47, 5242880
s_waitcnt lgkmcnt(0)
v_mov_b32 v22, 2
s_mov_b64 exec, 1
ds_write_b32 v21, v22
s_mov_b64 exec, -1
v_mfma_f32_32x32x16_bf16 v[40:55], v[88:91], v[120:123], 0
v_mfma_f32_32x32x16_bf16 v[56:71], v[104:107], v[120:123], 0
v_mfma_f32_32x32x16_bf16 v[40:55], v[92:95], v[124:127], v[40:55]
v_mfma_f32_32x32x16_bf16 v[56:71], v[108:111], v[124:127], v[56:71]
v_mfma_f32_32x32x16_bf16 v[40:55], v[96:99], v[128:131], v[40:55]
v_mfma_f32_32x32x16_bf16 v[56:71], v[112:115], v[128:131], v[56:71]
v_mfma_f32_32x32x16_bf16 v[40:55], v[100:103], v[132:135], v[40:55]
v_mfma_f32_32x32x16_bf16 v[56:71], v[116:119], v[132:135], v[56:71]
s_nop 7
s_nop 3
v_cvt_pk_bf16_f32 v88, v40, v41
v_cvt_pk_bf16_f32 v89, v42, v43
v_cvt_pk_bf16_f32 v90, v44, v45
v_cvt_pk_bf16_f32 v91, v46, v47
v_cvt_pk_bf16_f32 v92, v48, v49
v_cvt_pk_bf16_f32 v93, v50, v51
v_cvt_pk_bf16_f32 v94, v52, v53
v_cvt_pk_bf16_f32 v95, v54, v55
v_cvt_pk_bf16_f32 v96, v56, v57
v_mov_b32 v97, 0
v_mov_b32 v98, 0
v_mov_b32 v99, 0
s_mov_b64 exec, s[44:45]
buffer_store_dwordx4 v[88:91], v136, s[20:23], s47 offen sc1
buffer_store_dwordx4 v[92:95], v136, s[20:23], s47 offen offset:640 sc1
buffer_store_dwordx4 v[96:99], v136, s[20:23], s47 offen offset:1280 sc1
s_mov_b64 exec, -1
s_setprio 0
s_cmp_eq_u32 s59, 3
s_cbranch_scc1 L_red
s_cmp_ge_u32 s57, 24
s_cbranch_scc1 L_idle
v_lshlrev_b32 v14, 4, v1
s_mul_i32 s40, s56, 72
s_mul_i32 s31, s57, 3
s_add_u32 s40, s40, s31
s_add_u32 s40, s40, s59
s_mul_i32 s41, s59, 12928
s_add_u32 s41, s41, 122112
s_mul_i32 s42, s40, 4112
s_add_u32 s42, s42, 11534336
s_lshl_b32 s43, s40, 12
s_add_u32 s43, s43, 8388608
s_mov_b64 s[6:7], exec
s_mov_b64 exec, 1
v_mov_b32 v20, 163824
s_mov_b32 s31, 65536
lw_70:
ds_read_b128 v[16:19], v20
s_sub_u32 s31, s31, 1
s_cbranch_scc1 lx_71
s_waitcnt lgkmcnt(0)
v_min3_u32 v16, v16, v17, v18
v_min_u32 v16, v16, v19
v_cmp_le_u32 vcc, 2, v16
s_cbranch_vccz lw_70
lx_71:
s_waitcnt lgkmcnt(0)
s_mov_b64 exec, s[6:7]
v_mov_b32 v12, 0
v_mov_b32 v13, 0
v_min_u32 v8, 59, v1
v_lshlrev_b32 v8, 3, v8
v_add_u32 v8, s41, v8
ds_write_b64 v8, v[12:13] offset:8320
v_and_b32 v8, 31, v1
v_lshrrev_b32 v9, 4, v8
v_mul_u32_u24 v9, 4096, v9
v_lshl_add_u32 v8, v8, 2, v9
v_add_u32 v8, s41, v8
ds_write_b32 v8, v12 offset:4096
v_and_b32 v8, 15, v1
v_lshrrev_b32 v9, 4, v1
v_lshlrev_b32 v11, 5, v8
v_lshl_add_u32 v11, v9, 4, v11
v_add_u32 v6, s41, v11
v_add_u32 v6, 8320, v6
v_lshlrev_b32 v11, 3, v9
v_sub_u32 v11, v11, v8
v_and_b32 v12, 1, v8
v_xor_b32 v12, 1, v12
v_sub_u32 v11, v11, v12
v_lshlrev_b32 v11, 1, v11
v_mul_u32_u24 v12, 4160, v12
v_add3_u32 v11, v11, v12, s41
v_add_u32 v2, 3102, v11
v_add_u32 v3, 2078, v11
v_add_u32 v4, 1054, v11
v_add_u32 v5, 30, v11
v_and_b32 v11, 1, v9
v_lshlrev_b32 v11, 9, v11
v_lshl_add_u32 v11, v8, 5, v11
v_lshrrev_b32 v12, 1, v9
v_lshl_add_u32 v7, v12, 4, v11
s_mov_b64 s[6:7], exec
s_mov_b64 exec, 1
v_mov_b32 v18, 163792
s_mov_b32 s31, 65536
lw_72:
ds_read_b32 v16, v18
s_sub_u32 s31, s31, 1
s_cbranch_scc1 lx_73
s_waitcnt lgkmcnt(0)
v_cmp_ne_u32 vcc, 0, v16
s_cbranch_vccz lw_72
lx_73:
s_waitcnt lgkmcnt(0)
s_mov_b64 exec, s[6:7]
v_readfirstlane_b32 s60, v16
s_nop 0
s_sub_u32 s60, s60, 1
s_add_u32 m0, s41, 8800
s_add_u32 s58, s43, 0
buffer_load_dwordx4 v14, s[20:23], s58 offen sc1 lds
s_add_u32 m0, s41, 0
s_add_u32 s58, s42, 0
buffer_load_dwordx4 v14, s[20:23], s58 offen sc1 lds
s_add_u32 m0, s41, 4160
s_add_u32 s58, s42, 2
buffer_load_dwordx4 v14, s[20:23], s58 offen sc1 lds
s_add_u32 m0, s41, 9824
s_add_u32 s58, s43, 1024
buffer_load_dwordx4 v14, s[20:23], s58 offen sc1 lds
s_add_u32 m0, s41, 1024
s_add_u32 s58, s42, 1024
buffer_load_dwordx4 v14, s[20:23], s58 offen sc1 lds
s_add_u32 m0, s41, 5184
s_add_u32 s58, s42, 1026
buffer_load_dwordx4 v14, s[20:23], s58 offen sc1 lds
s_add_u32 m0, s41, 10848
s_add_u32 s58, s43, 2048
buffer_load_dwordx4 v14, s[20:23], s58 offen sc1 lds
s_add_u32 m0, s41, 2048
s_add_u32 s58, s42, 2048
buffer_load_dwordx4 v14, s[20:23], s58 offen sc1 lds
s_add_u32 m0, s41, 6208
s_add_u32 s58, s42, 2050
buffer_load_dwordx4 v14, s[20:23], s58 offen sc1 lds
s_add_u32 m0, s41, 11872
s_add_u32 s58, s43, 3072
buffer_load_dwordx4 v14, s[20:23], s58 offen sc1 lds
s_add_u32 m0, s41, 3072
s_add_u32 s58, s42, 3072
buffer_load_dwordx4 v14, s[20:23], s58 offen sc1 lds
s_add_u32 m0, s41, 7232
s_add_u32 s58, s42, 3074
buffer_load_dwordx4 v14, s[20:23], s58 offen sc1 lds
s_waitcnt vmcnt(0) lgkmcnt(0)
s_lshl_b32 s31, s59, 2
s_add_u32 s31, s31, 163744
v_mov_b32 v12, s31
v_mov_b32 v13, 1
s_mov_b64 exec, 1
ds_write_b32 v12, v13
s_mov_b64 exec, -1
s_setprio 2
ds_read_b128 v[104:107], v6 offset:448
ds_read_b128 v[108:111], v6 offset:960
ds_read_b128 v[112:115], v6 offset:1472
ds_read_b128 v[116:119], v6 offset:1984
ds_read_b128 v[120:123], v6 offset:2496
ds_read_b128 v[124:127], v6 offset:3008
ds_read_b128 v[128:131], v6 offset:3520
ds_read_b128 v[132:135], v6 offset:4032
ds_read2_b32 v[40:41], v2 offset0:240 offset1:241
ds_read2_b32 v[42:43], v2 offset0:242 offset1:243
ds_read2_b32 v[44:45], v2 offset0:112 offset1:113
ds_read2_b32 v[46:47], v2 offset0:114 offset1:115
ds_read2_b32 v[48:49], v3 offset0:240 offset1:241
ds_read2_b32 v[50:51], v3 offset0:242 offset1:243
ds_read2_b32 v[52:53], v3 offset0:112 offset1:113
ds_read2_b32 v[54:55], v3 offset0:114 offset1:115
ds_read2_b32 v[56:57], v4 offset0:240 offset1:241
ds_read2_b32 v[58:59], v4 offset0:242 offset1:243
ds_read2_b32 v[60:61], v4 offset0:112 offset1:113
ds_read2_b32 v[62:63], v4 offset0:114 offset1:115
ds_read2_b32 v[64:65], v5 offset0:240 offset1:241
ds_read2_b32 v[66:67], v5 offset0:242 offset1:243
ds_read2_b32 v[68:69], v5 offset0:112 offset1:113
ds_read2_b32 v[70:71], v5 offset0:114 offset1:115
s_waitcnt lgkmcnt(0)
v_mfma_f32_16x16x32_bf16 v[16:19], v[40:43], v[112:115], 0
ds_read_b128 v[136:139], v6 offset:384
v_mfma_f32_16x16x32_bf16 v[20:23], v[40:43], v[116:119], 0
ds_read_b128 v[140:143], v6 offset:896
v_mfma_f32_16x16x32_bf16 v[24:27], v[40:43], v[120:123], 0
ds_read_b128 v[144:147], v6 offset:1408
v_mfma_f32_16x16x32_bf16 v[28:31], v[40:43], v[124:127], 0
ds_read_b128 v[148:151], v6 offset:1920
v_mfma_f32_16x16x32_bf16 v[32:35], v[40:43], v[128:131], 0
ds_read_b128 v[152:155], v6 offset:2432
v_mfma_f32_16x16x32_bf16 v[36:39], v[40:43], v[132:135], 0
ds_read_b128 v[156:159], v6 offset:2944
v_mfma_f32_16x16x32_bf16 v[16:19], v[44:47], v[108:111], v[16:19]
ds_read_b128 v[160:163], v6 offset:3456
v_mfma_f32_16x16x32_bf16 v[20:23], v[44:47], v[112:115], v[20:23]
ds_read_b128 v[164:167], v6 offset:3968
v_mfma_f32_16x16x32_bf16 v[24:27], v[44:47], v[116:119], v[24:27]
ds_read2_b32 v[72:73], v2 offset0:224 offset1:225
v_mfma_f32_16x16x32_bf16 v[28:31], v[44:47], v[120:123], v[28:31]
ds_read2_b32 v[74:75], v2 offset0:226 offset1:227
v_mfma_f32_16x16x32_bf16 v[32:35], v[44:47], v[124:127], v[32:35]
ds_read2_b32 v[76:77], v2 offset0:96 offset1:97
v_mfma_f32_16x16x32_bf16 v[36:39], v[44:47], v[128:131], v[36:39]
ds_read2_b32 v[78:79], v2 offset0:98 offset1:99
v_mfma_f32_16x16x32_bf16 v[16:19], v[48:51], v[104:107], v[16:19]
ds_read2_b32 v[80:81], v3 offset0:224 offset1:225
v_mfma_f32_16x16x32_bf16 v[20:23], v[48:51], v[108:111], v[20:23]
ds_read2_b32 v[82:83], v3 offset0:226 offset1:227
v_mfma_f32_16x16x32_bf16 v[24:27], v[48:51], v[112:115], v[24:27]
ds_read2_b32 v[84:85], v3 offset0:96 offset1:97
v_mfma_f32_16x16x32_bf16 v[28:31], v[48:51], v[116:119], v[28:31]
ds_read2_b32 v[86:87], v3 offset0:98 offset1:99
v_mfma_f32_16x16x32_bf16 v[32:35], v[48:51], v[120:123], v[32:35]
ds_read2_b32 v[88:89], v4 offset0:224 offset1:225
v_mfma_f32_16x16x32_bf16 v[36:39], v[48:51], v[124:127], v[36:39]
ds_read2_b32 v[90:91], v4 offset0:226 offset1:227
v_mfma_f32_16x16x32_bf16 v[20:23], v[52:55], v[104:107], v[20:23]
ds_read2_b32 v[92:93], v4 offset0:96 offset1:97
v_mfma_f32_16x16x32_bf16 v[24:27], v[52:55], v[108:111], v[24:27]
ds_read2_b32 v[94:95], v4 offset0:98 offset1:99
v_mfma_f32_16x16x32_bf16 v[28:31], v[52:55], v[112:115], v[28:31]
ds_read2_b32 v[96:97], v5 offset0:224 offset1:225
v_mfma_f32_16x16x32_bf16 v[32:35], v[52:55], v[116:119], v[32:35]
ds_read2_b32 v[98:99], v5 offset0:226 offset1:227
v_mfma_f32_16x16x32_bf16 v[36:39], v[52:55], v[120:123], v[36:39]
ds_read2_b32 v[100:101], v5 offset0:96 offset1:97
v_mfma_f32_16x16x32_bf16 v[24:27], v[56:59], v[104:107], v[24:27]
ds_read2_b32 v[102:103], v5 offset0:98 offset1:99
v_mfma_f32_16x16x32_bf16 v[28:31], v[56:59], v[108:111], v[28:31]
v_mfma_f32_16x16x32_bf16 v[32:35], v[56:59], v[112:115], v[32:35]
v_mfma_f32_16x16x32_bf16 v[36:39], v[56:59], v[116:119], v[36:39]
v_mfma_f32_16x16x32_bf16 v[28:31], v[60:63], v[104:107], v[28:31]
v_mfma_f32_16x16x32_bf16 v[32:35], v[60:63], v[108:111], v[32:35]
v_mfma_f32_16x16x32_bf16 v[36:39], v[60:63], v[112:115], v[36:39]
v_mfma_f32_16x16x32_bf16 v[32:35], v[64:67], v[104:107], v[32:35]
v_mfma_f32_16x16x32_bf16 v[36:39], v[64:67], v[108:111], v[36:39]
v_mfma_f32_16x16x32_bf16 v[36:39], v[68:71], v[104:107], v[36:39]
s_waitcnt lgkmcnt(0)
v_mfma_f32_16x16x32_bf16 v[16:19], v[72:75], v[144:147], v[16:19]
ds_read_b128 v[104:107], v6 offset:320
v_mfma_f32_16x16x32_bf16 v[20:23], v[72:75], v[148:151], v[20:23]
ds_read_b128 v[108:111], v6 offset:832
v_mfma_f32_16x16x32_bf16 v[24:27], v[72:75], v[152:155], v[24:27]
ds_read_b128 v[112:115], v6 offset:1344
v_mfma_f32_16x16x32_bf16 v[28:31], v[72:75], v[156:159], v[28:31]
ds_read_b128 v[116:119], v6 offset:1856
v_mfma_f32_16x16x32_bf16 v[32:35], v[72:75], v[160:163], v[32:35]
ds_read_b128 v[120:123], v6 offset:2368
v_mfma_f32_16x16x32_bf16 v[36:39], v[72:75], v[164:167], v[36:39]
ds_read_b128 v[124:127], v6 offset:2880
v_mfma_f32_16x16x32_bf16 v[16:19], v[76:79], v[140:143], v[16:19]
ds_read_b128 v[128:131], v6 offset:3392
v_mfma_f32_16x16x32_bf16 v[20:23], v[76:79], v[144:147], v[20:23]
ds_read_b128 v[132:135], v6 offset:3904
v_mfma_f32_16x16x32_bf16 v[24:27], v[76:79], v[148:151], v[24:27]
ds_read2_b32 v[40:41], v2 offset0:208 offset1:209
v_mfma_f32_16x16x32_bf16 v[28:31], v[76:79], v[152:155], v[28:31]
ds_read2_b32 v[42:43], v2 offset0:210 offset1:211
v_mfma_f32_16x16x32_bf16 v[32:35], v[76:79], v[156:159], v[32:35]
ds_read2_b32 v[44:45], v2 offset0:80 offset1:81
v_mfma_f32_16x16x32_bf16 v[36:39], v[76:79], v[160:163], v[36:39]
ds_read2_b32 v[46:47], v2 offset0:82 offset1:83
v_mfma_f32_16x16x32_bf16 v[16:19], v[80:83], v[136:139], v[16:19]
ds_read2_b32 v[48:49], v3 offset0:208 offset1:209
v_mfma_f32_16x16x32_bf16 v[20:23], v[80:83], v[140:143], v[20:23]
ds_read2_b32 v[50:51], v3 offset0:210 offset1:211
v_mfma_f32_16x16x32_bf16 v[24:27], v[80:83], v[144:147], v[24:27]
ds_read2_b32 v[52:53], v3 offset0:80 offset1:81
v_mfma_f32_16x16x32_bf16 v[28:31], v[80:83], v[148:151], v[28:31]
ds_read2_b32 v[54:55], v3 offset0:82 offset1:83
v_mfma_f32_16x16x32_bf16 v[32:35], v[80:83], v[152:155], v[32:35]
ds_read2_b32 v[56:57], v4 offset0:208 offset1:209
v_mfma_f32_16x16x32_bf16 v[36:39], v[80:83], v[156:159], v[36:39]
ds_read2_b32 v[58:59], v4 offset0:210 offset1:211
v_mfma_f32_16x16x32_bf16 v[20:23], v[84:87], v[136:139], v[20:23]
ds_read2_b32 v[60:61], v4 offset0:80 offset1:81
v_mfma_f32_16x16x32_bf16 v[24:27], v[84:87], v[140:143], v[24:27]
ds_read2_b32 v[62:63], v4 offset0:82 offset1:83
v_mfma_f32_16x16x32_bf16 v[28:31], v[84:87], v[144:147], v[28:31]
ds_read2_b32 v[64:65], v5 offset0:208 offset1:209
v_mfma_f32_16x16x32_bf16 v[32:35], v[84:87], v[148:151], v[32:35]
ds_read2_b32 v[66:67], v5 offset0:210 offset1:211
v_mfma_f32_16x16x32_bf16 v[36:39], v[84:87], v[152:155], v[36:39]
ds_read2_b32 v[68:69], v5 offset0:80 offset1:81
v_mfma_f32_16x16x32_bf16 v[24:27], v[88:91], v[136:139], v[24:27]
ds_read2_b32 v[70:71], v5 offset0:82 offset1:83
v_mfma_f32_16x16x32_bf16 v[28:31], v[88:91], v[140:143], v[28:31]
v_mfma_f32_16x16x32_bf16 v[32:35], v[88:91], v[144:147], v[32:35]
v_mfma_f32_16x16x32_bf16 v[36:39], v[88:91], v[148:151], v[36:39]
v_mfma_f32_16x16x32_bf16 v[28:31], v[92:95], v[136:139], v[28:31]
v_mfma_f32_16x16x32_bf16 v[32:35], v[92:95], v[140:143], v[32:35]
v_mfma_f32_16x16x32_bf16 v[36:39], v[92:95], v[144:147], v[36:39]
v_mfma_f32_16x16x32_bf16 v[32:35], v[96:99], v[136:139], v[32:35]
v_mfma_f32_16x16x32_bf16 v[36:39], v[96:99], v[140:143], v[36:39]
v_mfma_f32_16x16x32_bf16 v[36:39], v[100:103], v[136:139], v[36:39]
s_waitcnt lgkmcnt(0)
v_mfma_f32_16x16x32_bf16 v[16:19], v[40:43], v[112:115], v[16:19]
ds_read_b128 v[136:139], v6 offset:256
v_mfma_f32_16x16x32_bf16 v[20:23], v[40:43], v[116:119], v[20:23]
ds_read_b128 v[140:143], v6 offset:768
v_mfma_f32_16x16x32_bf16 v[24:27], v[40:43], v[120:123], v[24:27]
ds_read_b128 v[144:147], v6 offset:1280
v_mfma_f32_16x16x32_bf16 v[28:31], v[40:43], v[124:127], v[28:31]
ds_read_b128 v[148:151], v6 offset:1792
v_mfma_f32_16x16x32_bf16 v[32:35], v[40:43], v[128:131], v[32:35]
ds_read_b128 v[152:155], v6 offset:2304
v_mfma_f32_16x16x32_bf16 v[36:39], v[40:43], v[132:135], v[36:39]
ds_read_b128 v[156:159], v6 offset:2816
v_mfma_f32_16x16x32_bf16 v[16:19], v[44:47], v[108:111], v[16:19]
ds_read_b128 v[160:163], v6 offset:3328
v_mfma_f32_16x16x32_bf16 v[20:23], v[44:47], v[112:115], v[20:23]
ds_read_b128 v[164:167], v6 offset:3840
v_mfma_f32_16x16x32_bf16 v[24:27], v[44:47], v[116:119], v[24:27]
ds_read2_b32 v[72:73], v2 offset0:192 offset1:193
v_mfma_f32_16x16x32_bf16 v[28:31], v[44:47], v[120:123], v[28:31]
ds_read2_b32 v[74:75], v2 offset0:194 offset1:195
v_mfma_f32_16x16x32_bf16 v[32:35], v[44:47], v[124:127], v[32:35]
ds_read2_b32 v[76:77], v2 offset0:64 offset1:65
v_mfma_f32_16x16x32_bf16 v[36:39], v[44:47], v[128:131], v[36:39]
ds_read2_b32 v[78:79], v2 offset0:66 offset1:67
v_mfma_f32_16x16x32_bf16 v[16:19], v[48:51], v[104:107], v[16:19]
ds_read2_b32 v[80:81], v3 offset0:192 offset1:193
v_mfma_f32_16x16x32_bf16 v[20:23], v[48:51], v[108:111], v[20:23]
ds_read2_b32 v[82:83], v3 offset0:194 offset1:195
v_mfma_f32_16x16x32_bf16 v[24:27], v[48:51], v[112:115], v[24:27]
ds_read2_b32 v[84:85], v3 offset0:64 offset1:65
v_mfma_f32_16x16x32_bf16 v[28:31], v[48:51], v[116:119], v[28:31]
ds_read2_b32 v[86:87], v3 offset0:66 offset1:67
v_mfma_f32_16x16x32_bf16 v[32:35], v[48:51], v[120:123], v[32:35]
ds_read2_b32 v[88:89], v4 offset0:192 offset1:193
v_mfma_f32_16x16x32_bf16 v[36:39], v[48:51], v[124:127], v[36:39]
ds_read2_b32 v[90:91], v4 offset0:194 offset1:195
v_mfma_f32_16x16x32_bf16 v[20:23], v[52:55], v[104:107], v[20:23]
ds_read2_b32 v[92:93], v4 offset0:64 offset1:65
v_mfma_f32_16x16x32_bf16 v[24:27], v[52:55], v[108:111], v[24:27]
ds_read2_b32 v[94:95], v4 offset0:66 offset1:67
v_mfma_f32_16x16x32_bf16 v[28:31], v[52:55], v[112:115], v[28:31]
ds_read2_b32 v[96:97], v5 offset0:192 offset1:193
v_mfma_f32_16x16x32_bf16 v[32:35], v[52:55], v[116:119], v[32:35]
ds_read2_b32 v[98:99], v5 offset0:194 offset1:195
v_mfma_f32_16x16x32_bf16 v[36:39], v[52:55], v[120:123], v[36:39]
ds_read2_b32 v[100:101], v5 offset0:64 offset1:65
v_mfma_f32_16x16x32_bf16 v[24:27], v[56:59], v[104:107], v[24:27]
ds_read2_b32 v[102:103], v5 offset0:66 offset1:67
v_mfma_f32_16x16x32_bf16 v[28:31], v[56:59], v[108:111], v[28:31]
v_mfma_f32_16x16x32_bf16 v[32:35], v[56:59], v[112:115], v[32:35]
v_mfma_f32_16x16x32_bf16 v[36:39], v[56:59], v[116:119], v[36:39]
v_mfma_f32_16x16x32_bf16 v[28:31], v[60:63], v[104:107], v[28:31]
v_mfma_f32_16x16x32_bf16 v[32:35], v[60:63], v[108:111], v[32:35]
v_mfma_f32_16x16x32_bf16 v[36:39], v[60:63], v[112:115], v[36:39]
v_mfma_f32_16x16x32_bf16 v[32:35], v[64:67], v[104:107], v[32:35]
v_mfma_f32_16x16x32_bf16 v[36:39], v[64:67], v[108:111], v[36:39]
v_mfma_f32_16x16x32_bf16 v[36:39], v[68:71], v[104:107], v[36:39]
s_waitcnt lgkmcnt(0)
v_mfma_f32_16x16x32_bf16 v[16:19], v[72:75], v[144:147], v[16:19]
ds_read_b128 v[104:107], v6 offset:192
v_mfma_f32_16x16x32_bf16 v[20:23], v[72:75], v[148:151], v[20:23]
ds_read_b128 v[108:111], v6 offset:704
v_mfma_f32_16x16x32_bf16 v[24:27], v[72:75], v[152:155], v[24:27]
ds_read_b128 v[112:115], v6 offset:1216
v_mfma_f32_16x16x32_bf16 v[28:31], v[72:75], v[156:159], v[28:31]
ds_read_b128 v[116:119], v6 offset:1728
v_mfma_f32_16x16x32_bf16 v[32:35], v[72:75], v[160:163], v[32:35]
ds_read_b128 v[120:123], v6 offset:2240
v_mfma_f32_16x16x32_bf16 v[36:39], v[72:75], v[164:167], v[36:39]
ds_read_b128 v[124:127], v6 offset:2752
v_mfma_f32_16x16x32_bf16 v[16:19], v[76:79], v[140:143], v[16:19]
ds_read_b128 v[128:131], v6 offset:3264
v_mfma_f32_16x16x32_bf16 v[20:23], v[76:79], v[144:147], v[20:23]
ds_read_b128 v[132:135], v6 offset:3776
v_mfma_f32_16x16x32_bf16 v[24:27], v[76:79], v[148:151], v[24:27]
ds_read2_b32 v[40:41], v2 offset0:176 offset1:177
v_mfma_f32_16x16x32_bf16 v[28:31], v[76:79], v[152:155], v[28:31]
ds_read2_b32 v[42:43], v2 offset0:178 offset1:179
v_mfma_f32_16x16x32_bf16 v[32:35], v[76:79], v[156:159], v[32:35]
ds_read2_b32 v[44:45], v2 offset0:48 offset1:49
v_mfma_f32_16x16x32_bf16 v[36:39], v[76:79], v[160:163], v[36:39]
ds_read2_b32 v[46:47], v2 offset0:50 offset1:51
v_mfma_f32_16x16x32_bf16 v[16:19], v[80:83], v[136:139], v[16:19]
ds_read2_b32 v[48:49], v3 offset0:176 offset1:177
v_mfma_f32_16x16x32_bf16 v[20:23], v[80:83], v[140:143], v[20:23]
ds_read2_b32 v[50:51], v3 offset0:178 offset1:179
v_mfma_f32_16x16x32_bf16 v[24:27], v[80:83], v[144:147], v[24:27]
ds_read2_b32 v[52:53], v3 offset0:48 offset1:49
v_mfma_f32_16x16x32_bf16 v[28:31], v[80:83], v[148:151], v[28:31]
ds_read2_b32 v[54:55], v3 offset0:50 offset1:51
v_mfma_f32_16x16x32_bf16 v[32:35], v[80:83], v[152:155], v[32:35]
ds_read2_b32 v[56:57], v4 offset0:176 offset1:177
v_mfma_f32_16x16x32_bf16 v[36:39], v[80:83], v[156:159], v[36:39]
ds_read2_b32 v[58:59], v4 offset0:178 offset1:179
v_mfma_f32_16x16x32_bf16 v[20:23], v[84:87], v[136:139], v[20:23]
ds_read2_b32 v[60:61], v4 offset0:48 offset1:49
v_mfma_f32_16x16x32_bf16 v[24:27], v[84:87], v[140:143], v[24:27]
ds_read2_b32 v[62:63], v4 offset0:50 offset1:51
v_mfma_f32_16x16x32_bf16 v[28:31], v[84:87], v[144:147], v[28:31]
ds_read2_b32 v[64:65], v5 offset0:176 offset1:177
v_mfma_f32_16x16x32_bf16 v[32:35], v[84:87], v[148:151], v[32:35]
ds_read2_b32 v[66:67], v5 offset0:178 offset1:179
v_mfma_f32_16x16x32_bf16 v[36:39], v[84:87], v[152:155], v[36:39]
ds_read2_b32 v[68:69], v5 offset0:48 offset1:49
v_mfma_f32_16x16x32_bf16 v[24:27], v[88:91], v[136:139], v[24:27]
ds_read2_b32 v[70:71], v5 offset0:50 offset1:51
v_mfma_f32_16x16x32_bf16 v[28:31], v[88:91], v[140:143], v[28:31]
v_mfma_f32_16x16x32_bf16 v[32:35], v[88:91], v[144:147], v[32:35]
v_mfma_f32_16x16x32_bf16 v[36:39], v[88:91], v[148:151], v[36:39]
v_mfma_f32_16x16x32_bf16 v[28:31], v[92:95], v[136:139], v[28:31]
v_mfma_f32_16x16x32_bf16 v[32:35], v[92:95], v[140:143], v[32:35]
v_mfma_f32_16x16x32_bf16 v[36:39], v[92:95], v[144:147], v[36:39]
v_mfma_f32_16x16x32_bf16 v[32:35], v[96:99], v[136:139], v[32:35]
v_mfma_f32_16x16x32_bf16 v[36:39], v[96:99], v[140:143], v[36:39]
v_mfma_f32_16x16x32_bf16 v[36:39], v[100:103], v[136:139], v[36:39]
s_waitcnt lgkmcnt(0)
v_mfma_f32_16x16x32_bf16 v[16:19], v[40:43], v[112:115], v[16:19]
ds_read_b128 v[136:139], v6 offset:128
v_mfma_f32_16x16x32_bf16 v[20:23], v[40:43], v[116:119], v[20:23]
ds_read_b128 v[140:143], v6 offset:640
v_mfma_f32_16x16x32_bf16 v[24:27], v[40:43], v[120:123], v[24:27]
ds_read_b128 v[144:147], v6 offset:1152
v_mfma_f32_16x16x32_bf16 v[28:31], v[40:43], v[124:127], v[28:31]
ds_read_b128 v[148:151], v6 offset:1664
v_mfma_f32_16x16x32_bf16 v[32:35], v[40:43], v[128:131], v[32:35]
ds_read_b128 v[152:155], v6 offset:2176
v_mfma_f32_16x16x32_bf16 v[36:39], v[40:43], v[132:135], v[36:39]
ds_read_b128 v[156:159], v6 offset:2688
v_mfma_f32_16x16x32_bf16 v[16:19], v[44:47], v[108:111], v[16:19]
ds_read_b128 v[160:163], v6 offset:3200
v_mfma_f32_16x16x32_bf16 v[20:23], v[44:47], v[112:115], v[20:23]
ds_read_b128 v[164:167], v6 offset:3712
v_mfma_f32_16x16x32_bf16 v[24:27], v[44:47], v[116:119], v[24:27]
ds_read2_b32 v[72:73], v2 offset0:160 offset1:161
v_mfma_f32_16x16x32_bf16 v[28:31], v[44:47], v[120:123], v[28:31]
ds_read2_b32 v[74:75], v2 offset0:162 offset1:163
v_mfma_f32_16x16x32_bf16 v[32:35], v[44:47], v[124:127], v[32:35]
ds_read2_b32 v[76:77], v2 offset0:32 offset1:33
v_mfma_f32_16x16x32_bf16 v[36:39], v[44:47], v[128:131], v[36:39]
ds_read2_b32 v[78:79], v2 offset0:34 offset1:35
v_mfma_f32_16x16x32_bf16 v[16:19], v[48:51], v[104:107], v[16:19]
ds_read2_b32 v[80:81], v3 offset0:160 offset1:161
v_mfma_f32_16x16x32_bf16 v[20:23], v[48:51], v[108:111], v[20:23]
ds_read2_b32 v[82:83], v3 offset0:162 offset1:163
v_mfma_f32_16x16x32_bf16 v[24:27], v[48:51], v[112:115], v[24:27]
ds_read2_b32 v[84:85], v3 offset0:32 offset1:33
v_mfma_f32_16x16x32_bf16 v[28:31], v[48:51], v[116:119], v[28:31]
ds_read2_b32 v[86:87], v3 offset0:34 offset1:35
v_mfma_f32_16x16x32_bf16 v[32:35], v[48:51], v[120:123], v[32:35]
ds_read2_b32 v[88:89], v4 offset0:160 offset1:161
v_mfma_f32_16x16x32_bf16 v[36:39], v[48:51], v[124:127], v[36:39]
ds_read2_b32 v[90:91], v4 offset0:162 offset1:163
v_mfma_f32_16x16x32_bf16 v[20:23], v[52:55], v[104:107], v[20:23]
ds_read2_b32 v[92:93], v4 offset0:32 offset1:33
v_mfma_f32_16x16x32_bf16 v[24:27], v[52:55], v[108:111], v[24:27]
ds_read2_b32 v[94:95], v4 offset0:34 offset1:35
v_mfma_f32_16x16x32_bf16 v[28:31], v[52:55], v[112:115], v[28:31]
ds_read2_b32 v[96:97], v5 offset0:160 offset1:161
v_mfma_f32_16x16x32_bf16 v[32:35], v[52:55], v[116:119], v[32:35]
ds_read2_b32 v[98:99], v5 offset0:162 offset1:163
v_mfma_f32_16x16x32_bf16 v[36:39], v[52:55], v[120:123], v[36:39]
ds_read2_b32 v[100:101], v5 offset0:32 offset1:33
v_mfma_f32_16x16x32_bf16 v[24:27], v[56:59], v[104:107], v[24:27]
ds_read2_b32 v[102:103], v5 offset0:34 offset1:35
v_mfma_f32_16x16x32_bf16 v[28:31], v[56:59], v[108:111], v[28:31]
v_mfma_f32_16x16x32_bf16 v[32:35], v[56:59], v[112:115], v[32:35]
v_mfma_f32_16x16x32_bf16 v[36:39], v[56:59], v[116:119], v[36:39]
v_mfma_f32_16x16x32_bf16 v[28:31], v[60:63], v[104:107], v[28:31]
v_mfma_f32_16x16x32_bf16 v[32:35], v[60:63], v[108:111], v[32:35]
v_mfma_f32_16x16x32_bf16 v[36:39], v[60:63], v[112:115], v[36:39]
v_mfma_f32_16x16x32_bf16 v[32:35], v[64:67], v[104:107], v[32:35]
v_mfma_f32_16x16x32_bf16 v[36:39], v[64:67], v[108:111], v[36:39]
v_mfma_f32_16x16x32_bf16 v[36:39], v[68:71], v[104:107], v[36:39]
s_waitcnt lgkmcnt(0)
v_mfma_f32_16x16x32_bf16 v[16:19], v[72:75], v[144:147], v[16:19]
ds_read_b128 v[104:107], v6 offset:64
v_mfma_f32_16x16x32_bf16 v[20:23], v[72:75], v[148:151], v[20:23]
ds_read_b128 v[108:111], v6 offset:576
v_mfma_f32_16x16x32_bf16 v[24:27], v[72:75], v[152:155], v[24:27]
ds_read_b128 v[112:115], v6 offset:1088
v_mfma_f32_16x16x32_bf16 v[28:31], v[72:75], v[156:159], v[28:31]
ds_read_b128 v[116:119], v6 offset:1600
v_mfma_f32_16x16x32_bf16 v[32:35], v[72:75], v[160:163], v[32:35]
ds_read_b128 v[120:123], v6 offset:2112
v_mfma_f32_16x16x32_bf16 v[36:39], v[72:75], v[164:167], v[36:39]
ds_read_b128 v[124:127], v6 offset:2624
v_mfma_f32_16x16x32_bf16 v[16:19], v[76:79], v[140:143], v[16:19]
ds_read_b128 v[128:131], v6 offset:3136
v_mfma_f32_16x16x32_bf16 v[20:23], v[76:79], v[144:147], v[20:23]
ds_read_b128 v[132:135], v6 offset:3648
v_mfma_f32_16x16x32_bf16 v[24:27], v[76:79], v[148:151], v[24:27]
ds_read2_b32 v[40:41], v2 offset0:144 offset1:145
v_mfma_f32_16x16x32_bf16 v[28:31], v[76:79], v[152:155], v[28:31]
ds_read2_b32 v[42:43], v2 offset0:146 offset1:147
v_mfma_f32_16x16x32_bf16 v[32:35], v[76:79], v[156:159], v[32:35]
ds_read2_b32 v[44:45], v2 offset0:16 offset1:17
v_mfma_f32_16x16x32_bf16 v[36:39], v[76:79], v[160:163], v[36:39]
ds_read2_b32 v[46:47], v2 offset0:18 offset1:19
v_mfma_f32_16x16x32_bf16 v[16:19], v[80:83], v[136:139], v[16:19]
ds_read2_b32 v[48:49], v3 offset0:144 offset1:145
v_mfma_f32_16x16x32_bf16 v[20:23], v[80:83], v[140:143], v[20:23]
ds_read2_b32 v[50:51], v3 offset0:146 offset1:147
v_mfma_f32_16x16x32_bf16 v[24:27], v[80:83], v[144:147], v[24:27]
ds_read2_b32 v[52:53], v3 offset0:16 offset1:17
v_mfma_f32_16x16x32_bf16 v[28:31], v[80:83], v[148:151], v[28:31]
ds_read2_b32 v[54:55], v3 offset0:18 offset1:19
v_mfma_f32_16x16x32_bf16 v[32:35], v[80:83], v[152:155], v[32:35]
ds_read2_b32 v[56:57], v4 offset0:144 offset1:145
v_mfma_f32_16x16x32_bf16 v[36:39], v[80:83], v[156:159], v[36:39]
ds_read2_b32 v[58:59], v4 offset0:146 offset1:147
v_mfma_f32_16x16x32_bf16 v[20:23], v[84:87], v[136:139], v[20:23]
ds_read2_b32 v[60:61], v4 offset0:16 offset1:17
v_mfma_f32_16x16x32_bf16 v[24:27], v[84:87], v[140:143], v[24:27]
ds_read2_b32 v[62:63], v4 offset0:18 offset1:19
v_mfma_f32_16x16x32_bf16 v[28:31], v[84:87], v[144:147], v[28:31]
ds_read2_b32 v[64:65], v5 offset0:144 offset1:145
v_mfma_f32_16x16x32_bf16 v[32:35], v[84:87], v[148:151], v[32:35]
ds_read2_b32 v[66:67], v5 offset0:146 offset1:147
v_mfma_f32_16x16x32_bf16 v[36:39], v[84:87], v[152:155], v[36:39]
ds_read2_b32 v[68:69], v5 offset0:16 offset1:17
v_mfma_f32_16x16x32_bf16 v[24:27], v[88:91], v[136:139], v[24:27]
ds_read2_b32 v[70:71], v5 offset0:18 offset1:19
v_mfma_f32_16x16x32_bf16 v[28:31], v[88:91], v[140:143], v[28:31]
v_mfma_f32_16x16x32_bf16 v[32:35], v[88:91], v[144:147], v[32:35]
v_mfma_f32_16x16x32_bf16 v[36:39], v[88:91], v[148:151], v[36:39]
v_mfma_f32_16x16x32_bf16 v[28:31], v[92:95], v[136:139], v[28:31]
v_mfma_f32_16x16x32_bf16 v[32:35], v[92:95], v[140:143], v[32:35]
v_mfma_f32_16x16x32_bf16 v[36:39], v[92:95], v[144:147], v[36:39]
v_mfma_f32_16x16x32_bf16 v[32:35], v[96:99], v[136:139], v[32:35]
v_mfma_f32_16x16x32_bf16 v[36:39], v[96:99], v[140:143], v[36:39]
v_mfma_f32_16x16x32_bf16 v[36:39], v[100:103], v[136:139], v[36:39]
s_waitcnt lgkmcnt(0)
v_mfma_f32_16x16x32_bf16 v[16:19], v[40:43], v[112:115], v[16:19]
ds_read_b128 v[136:139], v6 offset:0
v_mfma_f32_16x16x32_bf16 v[20:23], v[40:43], v[116:119], v[20:23]
ds_read_b128 v[140:143], v6 offset:512
v_mfma_f32_16x16x32_bf16 v[24:27], v[40:43], v[120:123], v[24:27]
ds_read_b128 v[144:147], v6 offset:1024
v_mfma_f32_16x16x32_bf16 v[28:31], v[40:43], v[124:127], v[28:31]
ds_read_b128 v[148:151], v6 offset:1536
v_mfma_f32_16x16x32_bf16 v[32:35], v[40:43], v[128:131], v[32:35]
ds_read_b128 v[152:155], v6 offset:2048
v_mfma_f32_16x16x32_bf16 v[36:39], v[40:43], v[132:135], v[36:39]
ds_read_b128 v[156:159], v6 offset:2560
v_mfma_f32_16x16x32_bf16 v[16:19], v[44:47], v[108:111], v[16:19]
ds_read_b128 v[160:163], v6 offset:3072
v_mfma_f32_16x16x32_bf16 v[20:23], v[44:47], v[112:115], v[20:23]
ds_read_b128 v[164:167], v6 offset:3584
v_mfma_f32_16x16x32_bf16 v[24:27], v[44:47], v[116:119], v[24:27]
ds_read2_b32 v[72:73], v2 offset0:128 offset1:129
v_mfma_f32_16x16x32_bf16 v[28:31], v[44:47], v[120:123], v[28:31]
ds_read2_b32 v[74:75], v2 offset0:130 offset1:131
v_mfma_f32_16x16x32_bf16 v[32:35], v[44:47], v[124:127], v[32:35]
ds_read2_b32 v[76:77], v2 offset0:0 offset1:1
v_mfma_f32_16x16x32_bf16 v[36:39], v[44:47], v[128:131], v[36:39]
ds_read2_b32 v[78:79], v2 offset0:2 offset1:3
v_mfma_f32_16x16x32_bf16 v[16:19], v[48:51], v[104:107], v[16:19]
ds_read2_b32 v[80:81], v3 offset0:128 offset1:129
v_mfma_f32_16x16x32_bf16 v[20:23], v[48:51], v[108:111], v[20:23]
ds_read2_b32 v[82:83], v3 offset0:130 offset1:131
v_mfma_f32_16x16x32_bf16 v[24:27], v[48:51], v[112:115], v[24:27]
ds_read2_b32 v[84:85], v3 offset0:0 offset1:1
v_mfma_f32_16x16x32_bf16 v[28:31], v[48:51], v[116:119], v[28:31]
ds_read2_b32 v[86:87], v3 offset0:2 offset1:3
v_mfma_f32_16x16x32_bf16 v[32:35], v[48:51], v[120:123], v[32:35]
ds_read2_b32 v[88:89], v4 offset0:128 offset1:129
v_mfma_f32_16x16x32_bf16 v[36:39], v[48:51], v[124:127], v[36:39]
ds_read2_b32 v[90:91], v4 offset0:130 offset1:131
v_mfma_f32_16x16x32_bf16 v[20:23], v[52:55], v[104:107], v[20:23]
ds_read2_b32 v[92:93], v4 offset0:0 offset1:1
v_mfma_f32_16x16x32_bf16 v[24:27], v[52:55], v[108:111], v[24:27]
ds_read2_b32 v[94:95], v4 offset0:2 offset1:3
v_mfma_f32_16x16x32_bf16 v[28:31], v[52:55], v[112:115], v[28:31]
ds_read2_b32 v[96:97], v5 offset0:128 offset1:129
v_mfma_f32_16x16x32_bf16 v[32:35], v[52:55], v[116:119], v[32:35]
ds_read2_b32 v[98:99], v5 offset0:130 offset1:131
v_mfma_f32_16x16x32_bf16 v[36:39], v[52:55], v[120:123], v[36:39]
ds_read2_b32 v[100:101], v5 offset0:0 offset1:1
v_mfma_f32_16x16x32_bf16 v[24:27], v[56:59], v[104:107], v[24:27]
ds_read2_b32 v[102:103], v5 offset0:2 offset1:3
v_mfma_f32_16x16x32_bf16 v[28:31], v[56:59], v[108:111], v[28:31]
v_mfma_f32_16x16x32_bf16 v[32:35], v[56:59], v[112:115], v[32:35]
v_mfma_f32_16x16x32_bf16 v[36:39], v[56:59], v[116:119], v[36:39]
v_mfma_f32_16x16x32_bf16 v[28:31], v[60:63], v[104:107], v[28:31]
v_mfma_f32_16x16x32_bf16 v[32:35], v[60:63], v[108:111], v[32:35]
v_mfma_f32_16x16x32_bf16 v[36:39], v[60:63], v[112:115], v[36:39]
v_mfma_f32_16x16x32_bf16 v[32:35], v[64:67], v[104:107], v[32:35]
v_mfma_f32_16x16x32_bf16 v[36:39], v[64:67], v[108:111], v[36:39]
v_mfma_f32_16x16x32_bf16 v[36:39], v[68:71], v[104:107], v[36:39]
s_waitcnt lgkmcnt(0)
v_mfma_f32_16x16x32_bf16 v[16:19], v[72:75], v[144:147], v[16:19]
v_mfma_f32_16x16x32_bf16 v[20:23], v[72:75], v[148:151], v[20:23]
v_mfma_f32_16x16x32_bf16 v[24:27], v[72:75], v[152:155], v[24:27]
v_mfma_f32_16x16x32_bf16 v[28:31], v[72:75], v[156:159], v[28:31]
v_mfma_f32_16x16x32_bf16 v[32:35], v[72:75], v[160:163], v[32:35]
v_mfma_f32_16x16x32_bf16 v[36:39], v[72:75], v[164:167], v[36:39]
v_mfma_f32_16x16x32_bf16 v[16:19], v[76:79], v[140:143], v[16:19]
v_mfma_f32_16x16x32_bf16 v[20:23], v[76:79], v[144:147], v[20:23]
v_mfma_f32_16x16x32_bf16 v[24:27], v[76:79], v[148:151], v[24:27]
v_mfma_f32_16x16x32_bf16 v[28:31], v[76:79], v[152:155], v[28:31]
v_mfma_f32_16x16x32_bf16 v[32:35], v[76:79], v[156:159], v[32:35]
v_mfma_f32_16x16x32_bf16 v[36:39], v[76:79], v[160:163], v[36:39]
v_mfma_f32_16x16x32_bf16 v[16:19], v[80:83], v[136:139], v[16:19]
v_mfma_f32_16x16x32_bf16 v[20:23], v[80:83], v[140:143], v[20:23]
v_mfma_f32_16x16x32_bf16 v[24:27], v[80:83], v[144:147], v[24:27]
v_mfma_f32_16x16x32_bf16 v[28:31], v[80:83], v[148:151], v[28:31]
v_mfma_f32_16x16x32_bf16 v[32:35], v[80:83], v[152:155], v[32:35]
v_mfma_f32_16x16x32_bf16 v[36:39], v[80:83], v[156:159], v[36:39]
v_mfma_f32_16x16x32_bf16 v[20:23], v[84:87], v[136:139], v[20:23]
v_mfma_f32_16x16x32_bf16 v[24:27], v[84:87], v[140:143], v[24:27]
v_mfma_f32_16x16x32_bf16 v[28:31], v[84:87], v[144:147], v[28:31]
v_mfma_f32_16x16x32_bf16 v[32:35], v[84:87], v[148:151], v[32:35]
v_mfma_f32_16x16x32_bf16 v[36:39], v[84:87], v[152:155], v[36:39]
v_mfma_f32_16x16x32_bf16 v[24:27], v[88:91], v[136:139], v[24:27]
v_mfma_f32_16x16x32_bf16 v[28:31], v[88:91], v[140:143], v[28:31]
v_mfma_f32_16x16x32_bf16 v[32:35], v[88:91], v[144:147], v[32:35]
v_mfma_f32_16x16x32_bf16 v[36:39], v[88:91], v[148:151], v[36:39]
v_mfma_f32_16x16x32_bf16 v[28:31], v[92:95], v[136:139], v[28:31]
v_mfma_f32_16x16x32_bf16 v[32:35], v[92:95], v[140:143], v[32:35]
v_mfma_f32_16x16x32_bf16 v[36:39], v[92:95], v[144:147], v[36:39]
v_mfma_f32_16x16x32_bf16 v[32:35], v[96:99], v[136:139], v[32:35]
v_mfma_f32_16x16x32_bf16 v[36:39], v[96:99], v[140:143], v[36:39]
v_mfma_f32_16x16x32_bf16 v[36:39], v[100:103], v[136:139], v[36:39]
s_setprio 0
s_lshl_b32 s42, s40, 12
s_add_u32 s42, s42, 14680064
s_nop 6
v_cvt_pk_bf16_f32 v104, v16, v17
v_cvt_pk_bf16_f32 v105, v18, v19
v_cvt_pk_bf16_f32 v106, v20, v21
v_cvt_pk_bf16_f32 v107, v22, v23
v_cvt_pk_bf16_f32 v108, v24, v25
v_cvt_pk_bf16_f32 v109, v26, v27
v_cvt_pk_bf16_f32 v110, v28, v29
v_cvt_pk_bf16_f32 v111, v30, v31
v_cvt_pk_bf16_f32 v112, v32, v33
v_cvt_pk_bf16_f32 v113, v34, v35
v_cvt_pk_bf16_f32 v114, v36, v37
v_cvt_pk_bf16_f32 v115, v38, v39
v_permlane16_swap_b32 v104, v106
v_permlane16_swap_b32 v105, v107
v_permlane16_swap_b32 v108, v110
v_permlane16_swap_b32 v109, v111
v_permlane16_swap_b32 v112, v114
v_permlane16_swap_b32 v113, v115
s_cmp_eq_u32 s60, 0
s_cbranch_scc1 slow_74
buffer_store_dwordx4 v[104:107], v7, s[20:23], s42 offen offset:1024
buffer_store_dwordx4 v[108:111], v7, s[20:23], s42 offen offset:2048
buffer_store_dwordx4 v[112:115], v7, s[20:23], s42 offen offset:3072
s_branch done_75
slow_74:
buffer_store_dwordx4 v[104:107], v7, s[20:23], s42 offen offset:1024 sc1
buffer_store_dwordx4 v[108:111], v7, s[20:23], s42 offen offset:2048 sc1
buffer_store_dwordx4 v[112:115], v7, s[20:23], s42 offen offset:3072 sc1
done_75:
s_branch L_g1t
L_red:
s_lshr_b32 s31, s2, 3
s_and_b32 s32, s2, 7
s_lshl_b32 s32, s32, 4
v_and_b32 v2, 15, v1
v_add_u32 v3, s32, v2
v_cmp_gt_u32 s[44:45], 16, v1
v_cmp_gt_u32 vcc, 120, v3
s_and_b64 s[44:45], s[44:45], vcc
v_min_u32 v3, 119, v3
v_lshlrev_b32 v3, 4, v3
v_lshrrev_b32 v4, 4, v1
v_mul_u32_u24 v4, 7680, v4
v_add_u32 v4, v4, v3
s_lshr_b32 s32, s31, 2
s_lshl_b32 s32, s32, 7
s_and_b32 s33, s31, 3
s_add_u32 s32, s32, s33
s_mul_i32 s41, s32, 1920
s_add_u32 s41, s41, 5242880
s_mul_i32 s40, s31, 1920
s_add_u32 s40, s40, 7340032
s_setprio 3
s_mov_b64 s[6:7], exec
s_mov_b64 exec, 1
v_mov_b32 v20, 163796
s_mov_b32 s31, 65536
lw_76:
ds_read_b32 v16, v20
s_sub_u32 s31, s31, 1
s_cbranch_scc1 lx_77
s_waitcnt lgkmcnt(0)
v_cmp_ne_u32 vcc, 0, v16
s_cbranch_vccz lw_76
lx_77:
s_waitcnt lgkmcnt(0)
s_mov_b64 exec, s[6:7]
s_add_u32 s33, s41, 0
buffer_load_dwordx4 v[16:19], v4, s[20:23], s33 offen sc1
s_add_u32 s33, s41, 30720
buffer_load_dwordx4 v[20:23], v4, s[20:23], s33 offen sc1
s_add_u32 s33, s41, 61440
buffer_load_dwordx4 v[24:27], v4, s[20:23], s33 offen sc1
s_add_u32 s33, s41, 92160
buffer_load_dwordx4 v[28:31], v4, s[20:23], s33 offen sc1
s_add_u32 s33, s41, 122880
buffer_load_dwordx4 v[32:35], v4, s[20:23], s33 offen sc1
s_add_u32 s33, s41, 153600
buffer_load_dwordx4 v[36:39], v4, s[20:23], s33 offen sc1
s_add_u32 s33, s41, 184320
buffer_load_dwordx4 v[40:43], v4, s[20:23], s33 offen sc1
s_add_u32 s33, s41, 215040
buffer_load_dwordx4 v[44:47], v4, s[20:23], s33 offen sc1
s_mov_b32 s43, 0xff
v_mov_b32 v64, 0
v_mov_b32 v65, 0
v_mov_b32 v66, 0
v_mov_b32 v67, 0
v_and_b32 v8, 15, v1
v_mov_b32 v9, 0x3f80
v_and_b32 v10, 1, v8
v_lshlrev_b32 v10, 4, v10
v_lshlrev_b32 v9, v10, v9
v_lshrrev_b32 v8, 1, v8
v_cmp_eq_u32 s[8:9], 0, v8
v_cmp_eq_u32 s[10:11], 1, v8
v_cmp_eq_u32 s[12:13], 2, v8
v_cmp_eq_u32 s[14:15], 3, v8
v_cndmask_b32 v48, 0, v9, s[8:9]
v_cndmask_b32 v49, 0, v9, s[10:11]
v_cndmask_b32 v50, 0, v9, s[12:13]
v_cndmask_b32 v51, 0, v9, s[14:15]
s_setprio 3
rs_78:
s_waitcnt vmcnt(0)
s_bitcmp1_b32 s43, 0
s_cbranch_scc0 rx_80
v_max3_u32 v5, v16, v17, v18
v_max_u32 v5, v5, v19
v_cmp_eq_u32 vcc, -1, v5
s_cbranch_vccz ra_81
s_cmp_eq_u32 s61, 0
s_cbranch_scc1 ra_81
s_add_u32 s33, s41, 0
buffer_load_dwordx4 v[16:19], v4, s[20:23], s33 offen sc1
s_branch rx_80
ra_81:
v_mfma_f32_16x16x32_bf16 v[64:67], v[48:51], v[16:19], v[64:67]
s_bitset0_b32 s43, 0
rx_80:
s_bitcmp1_b32 s43, 1
s_cbranch_scc0 rx_82
v_max3_u32 v5, v20, v21, v22
v_max_u32 v5, v5, v23
v_cmp_eq_u32 vcc, -1, v5
s_cbranch_vccz ra_83
s_cmp_eq_u32 s61, 0
s_cbranch_scc1 ra_83
s_add_u32 s33, s41, 30720
buffer_load_dwordx4 v[20:23], v4, s[20:23], s33 offen sc1
s_branch rx_82
ra_83:
v_mfma_f32_16x16x32_bf16 v[64:67], v[48:51], v[20:23], v[64:67]
s_bitset0_b32 s43, 1
rx_82:
s_bitcmp1_b32 s43, 2
s_cbranch_scc0 rx_84
v_max3_u32 v5, v24, v25, v26
v_max_u32 v5, v5, v27
v_cmp_eq_u32 vcc, -1, v5
s_cbranch_vccz ra_85
s_cmp_eq_u32 s61, 0
s_cbranch_scc1 ra_85
s_add_u32 s33, s41, 61440
buffer_load_dwordx4 v[24:27], v4, s[20:23], s33 offen sc1
s_branch rx_84
ra_85:
v_mfma_f32_16x16x32_bf16 v[64:67], v[48:51], v[24:27], v[64:67]
s_bitset0_b32 s43, 2
rx_84:
s_bitcmp1_b32 s43, 3
s_cbranch_scc0 rx_86
v_max3_u32 v5, v28, v29, v30
v_max_u32 v5, v5, v31
v_cmp_eq_u32 vcc, -1, v5
s_cbranch_vccz ra_87
s_cmp_eq_u32 s61, 0
s_cbranch_scc1 ra_87
s_add_u32 s33, s41, 92160
buffer_load_dwordx4 v[28:31], v4, s[20:23], s33 offen sc1
s_branch rx_86
ra_87:
v_mfma_f32_16x16x32_bf16 v[64:67], v[48:51], v[28:31], v[64:67]
s_bitset0_b32 s43, 3
rx_86:
s_bitcmp1_b32 s43, 4
s_cbranch_scc0 rx_88
v_max3_u32 v5, v32, v33, v34
v_max_u32 v5, v5, v35
v_cmp_eq_u32 vcc, -1, v5
s_cbranch_vccz ra_89
s_cmp_eq_u32 s61, 0
s_cbranch_scc1 ra_89
s_add_u32 s33, s41, 122880
buffer_load_dwordx4 v[32:35], v4, s[20:23], s33 offen sc1
s_branch rx_88
ra_89:
v_mfma_f32_16x16x32_bf16 v[64:67], v[48:51], v[32:35], v[64:67]
s_bitset0_b32 s43, 4
rx_88:
s_bitcmp1_b32 s43, 5
s_cbranch_scc0 rx_90
v_max3_u32 v5, v36, v37, v38
v_max_u32 v5, v5, v39
v_cmp_eq_u32 vcc, -1, v5
s_cbranch_vccz ra_91
s_cmp_eq_u32 s61, 0
s_cbranch_scc1 ra_91
s_add_u32 s33, s41, 153600
buffer_load_dwordx4 v[36:39], v4, s[20:23], s33 offen sc1
s_branch rx_90
ra_91:
v_mfma_f32_16x16x32_bf16 v[64:67], v[48:51], v[36:39], v[64:67]
s_bitset0_b32 s43, 5
rx_90:
s_bitcmp1_b32 s43, 6
s_cbranch_scc0 rx_92
v_max3_u32 v5, v40, v41, v42
v_max_u32 v5, v5, v43
v_cmp_eq_u32 vcc, -1, v5
s_cbranch_vccz ra_93
s_cmp_eq_u32 s61, 0
s_cbranch_scc1 ra_93
s_add_u32 s33, s41, 184320
buffer_load_dwordx4 v[40:43], v4, s[20:23], s33 offen sc1
s_branch rx_92
ra_93:
v_mfma_f32_16x16x32_bf16 v[64:67], v[48:51], v[40:43], v[64:67]
s_bitset0_b32 s43, 6
rx_92:
s_bitcmp1_b32 s43, 7
s_cbranch_scc0 rx_94
v_max3_u32 v5, v44, v45, v46
v_max_u32 v5, v5, v47
v_cmp_eq_u32 vcc, -1, v5
s_cbranch_vccz ra_95
s_cmp_eq_u32 s61, 0
s_cbranch_scc1 ra_95
s_add_u32 s33, s41, 215040
buffer_load_dwordx4 v[44:47], v4, s[20:23], s33 offen sc1
s_branch rx_94
ra_95:
v_mfma_f32_16x16x32_bf16 v[64:67], v[48:51], v[44:47], v[64:67]
s_bitset0_b32 s43, 7
rx_94:
s_cmp_eq_u32 s43, 0
s_cbranch_scc1 rk_79
s_sub_u32 s61, s61, 1
s_branch rs_78
rk_79:
s_nop 7
s_nop 3
v_cvt_pk_bf16_f32 v16, v64, v65
v_cvt_pk_bf16_f32 v17, v66, v67
s_nop 0
v_mov_b32 v18, v16
v_mov_b32 v19, v17
s_nop 1
v_permlane16_swap_b32 v16, v18
v_permlane16_swap_b32 v17, v19
s_mov_b64 exec, s[44:45]
buffer_store_dwordx4 v[16:19], v3, s[20:23], s40 offen sc1
s_mov_b64 exec, -1
s_setprio 0
s_cmp_ge_u32 s57, 24
s_cbranch_scc1 L_g1t
v_and_b32 v68, 15, v1
v_lshrrev_b32 v69, 4, v1
v_lshlrev_b32 v70, 5, v68
v_lshl_add_u32 v70, v69, 4, v70
v_add_u32 v11, 130432, v70
v_lshlrev_b32 v70, 3, v69
v_sub_u32 v70, v70, v68
v_and_b32 v71, 1, v68
v_xor_b32 v71, 1, v71
v_sub_u32 v70, v70, v71
v_lshlrev_b32 v70, 1, v70
v_mul_u32_u24 v71, 4160, v71
v_add_u32 v70, v70, v71
v_add_u32 v5, 125214, v70
v_add_u32 v6, 124190, v70
v_and_b32 v70, 1, v69
v_lshlrev_b32 v70, 9, v70
v_lshl_add_u32 v70, v68, 5, v70
v_lshrrev_b32 v71, 1, v69
v_lshl_add_u32 v14, v71, 4, v70
v_add_u32 v12, 12928, v11
v_add_u32 v7, 12928, v5
v_add_u32 v8, 12928, v6
v_add_u32 v13, 25856, v11
v_add_u32 v9, 25856, v5
v_add_u32 v10, 25856, v6
s_mov_b64 s[6:7], exec
s_mov_b64 exec, 1
v_mov_b32 v70, 163792
s_mov_b32 s31, 65536
lw_96:
ds_read_b32 v68, v70
s_sub_u32 s31, s31, 1
s_cbranch_scc1 lx_97
s_waitcnt lgkmcnt(0)
v_cmp_ne_u32 vcc, 0, v68
s_cbranch_vccz lw_96
lx_97:
s_waitcnt lgkmcnt(0)
s_mov_b64 exec, s[6:7]
v_readfirstlane_b32 s60, v68
s_nop 0
s_sub_u32 s60, s60, 1
s_mov_b64 s[6:7], exec
s_mov_b64 exec, 1
v_mov_b32 v72, 163744
s_mov_b32 s31, 65536
lw_98:
ds_read_b128 v[68:71], v72
s_sub_u32 s31, s31, 1
s_cbranch_scc1 lx_99
s_waitcnt lgkmcnt(0)
v_min3_u32 v68, v68, v69, v70
v_cmp_ne_u32 vcc, 0, v68
s_cbranch_vccz lw_98
lx_99:
s_waitcnt lgkmcnt(0)
s_mov_b64 exec, s[6:7]
s_setprio 2
ds_read_b128 v[84:87], v11 offset:448
ds_read_b128 v[88:91], v11 offset:960
ds_read2_b32 v[68:69], v5 offset0:240 offset1:241
ds_read2_b32 v[70:71], v5 offset0:242 offset1:243
ds_read2_b32 v[72:73], v5 offset0:112 offset1:113
ds_read2_b32 v[74:75], v5 offset0:114 offset1:115
ds_read_b128 v[116:119], v12 offset:448
ds_read_b128 v[120:123], v12 offset:960
ds_read2_b32 v[100:101], v7 offset0:240 offset1:241
ds_read2_b32 v[102:103], v7 offset0:242 offset1:243
ds_read2_b32 v[104:105], v7 offset0:112 offset1:113
ds_read2_b32 v[106:107], v7 offset0:114 offset1:115
s_waitcnt lgkmcnt(6)
v_mfma_f32_16x16x32_bf16 v[20:23], v[68:71], v[84:87], 0
ds_read_b128 v[148:151], v13 offset:448
ds_read_b128 v[152:155], v13 offset:960
v_mfma_f32_16x16x32_bf16 v[24:27], v[68:71], v[88:91], 0
ds_read2_b32 v[132:133], v9 offset0:240 offset1:241
ds_read2_b32 v[134:135], v9 offset0:242 offset1:243
v_mfma_f32_16x16x32_bf16 v[24:27], v[72:75], v[84:87], v[24:27]
ds_read2_b32 v[136:137], v9 offset0:112 offset1:113
ds_read2_b32 v[138:139], v9 offset0:114 offset1:115
s_waitcnt lgkmcnt(6)
v_mfma_f32_16x16x32_bf16 v[36:39], v[100:103], v[116:119], 0
ds_read_b128 v[84:87], v11 offset:384
ds_read_b128 v[88:91], v11 offset:896
v_mfma_f32_16x16x32_bf16 v[40:43], v[100:103], v[120:123], 0
ds_read2_b32 v[68:69], v5 offset0:224 offset1:225
ds_read2_b32 v[70:71], v5 offset0:226 offset1:227
v_mfma_f32_16x16x32_bf16 v[40:43], v[104:107], v[116:119], v[40:43]
ds_read2_b32 v[72:73], v5 offset0:96 offset1:97
ds_read2_b32 v[74:75], v5 offset0:98 offset1:99
s_waitcnt lgkmcnt(6)
v_mfma_f32_16x16x32_bf16 v[52:55], v[132:135], v[148:151], 0
ds_read_b128 v[116:119], v12 offset:384
ds_read_b128 v[120:123], v12 offset:896
v_mfma_f32_16x16x32_bf16 v[56:59], v[132:135], v[152:155], 0
ds_read2_b32 v[100:101], v7 offset0:224 offset1:225
ds_read2_b32 v[102:103], v7 offset0:226 offset1:227
v_mfma_f32_16x16x32_bf16 v[56:59], v[136:139], v[148:151], v[56:59]
ds_read2_b32 v[104:105], v7 offset0:96 offset1:97
ds_read2_b32 v[106:107], v7 offset0:98 offset1:99
s_waitcnt lgkmcnt(6)
v_mfma_f32_16x16x32_bf16 v[20:23], v[68:71], v[84:87], v[20:23]
ds_read_b128 v[148:151], v13 offset:384
ds_read_b128 v[152:155], v13 offset:896
v_mfma_f32_16x16x32_bf16 v[24:27], v[68:71], v[88:91], v[24:27]
ds_read2_b32 v[132:133], v9 offset0:224 offset1:225
ds_read2_b32 v[134:135], v9 offset0:226 offset1:227
v_mfma_f32_16x16x32_bf16 v[24:27], v[72:75], v[84:87], v[24:27]
ds_read2_b32 v[136:137], v9 offset0:96 offset1:97
ds_read2_b32 v[138:139], v9 offset0:98 offset1:99
s_waitcnt lgkmcnt(6)
v_mfma_f32_16x16x32_bf16 v[36:39], v[100:103], v[116:119], v[36:39]
ds_read_b128 v[84:87], v11 offset:320
ds_read_b128 v[88:91], v11 offset:832
v_mfma_f32_16x16x32_bf16 v[40:43], v[100:103], v[120:123], v[40:43]
ds_read2_b32 v[68:69], v5 offset0:208 offset1:209
ds_read2_b32 v[70:71], v5 offset0:210 offset1:211
v_mfma_f32_16x16x32_bf16 v[40:43], v[104:107], v[116:119], v[40:43]
ds_read2_b32 v[72:73], v5 offset0:80 offset1:81
ds_read2_b32 v[74:75], v5 offset0:82 offset1:83
s_waitcnt lgkmcnt(6)
v_mfma_f32_16x16x32_bf16 v[52:55], v[132:135], v[148:151], v[52:55]
ds_read_b128 v[116:119], v12 offset:320
ds_read_b128 v[120:123], v12 offset:832
v_mfma_f32_16x16x32_bf16 v[56:59], v[132:135], v[152:155], v[56:59]
ds_read2_b32 v[100:101], v7 offset0:208 offset1:209
ds_read2_b32 v[102:103], v7 offset0:210 offset1:211
v_mfma_f32_16x16x32_bf16 v[56:59], v[136:139], v[148:151], v[56:59]
ds_read2_b32 v[104:105], v7 offset0:80 offset1:81
ds_read2_b32 v[106:107], v7 offset0:82 offset1:83
s_waitcnt lgkmcnt(6)
v_mfma_f32_16x16x32_bf16 v[20:23], v[68:71], v[84:87], v[20:23]
ds_read_b128 v[148:151], v13 offset:320
ds_read_b128 v[152:155], v13 offset:832
v_mfma_f32_16x16x32_bf16 v[24:27], v[68:71], v[88:91], v[24:27]
ds_read2_b32 v[132:133], v9 offset0:208 offset1:209
ds_read2_b32 v[134:135], v9 offset0:210 offset1:211
v_mfma_f32_16x16x32_bf16 v[24:27], v[72:75], v[84:87], v[24:27]
ds_read2_b32 v[136:137], v9 offset0:80 offset1:81
ds_read2_b32 v[138:139], v9 offset0:82 offset1:83
s_waitcnt lgkmcnt(6)
v_mfma_f32_16x16x32_bf16 v[36:39], v[100:103], v[116:119], v[36:39]
ds_read_b128 v[84:87], v11 offset:256
ds_read_b128 v[88:91], v11 offset:768
v_mfma_f32_16x16x32_bf16 v[40:43], v[100:103], v[120:123], v[40:43]
ds_read2_b32 v[68:69], v5 offset0:192 offset1:193
ds_read2_b32 v[70:71], v5 offset0:194 offset1:195
v_mfma_f32_16x16x32_bf16 v[40:43], v[104:107], v[116:119], v[40:43]
ds_read2_b32 v[72:73], v5 offset0:64 offset1:65
ds_read2_b32 v[74:75], v5 offset0:66 offset1:67
s_waitcnt lgkmcnt(6)
v_mfma_f32_16x16x32_bf16 v[52:55], v[132:135], v[148:151], v[52:55]
ds_read_b128 v[116:119], v12 offset:256
ds_read_b128 v[120:123], v12 offset:768
v_mfma_f32_16x16x32_bf16 v[56:59], v[132:135], v[152:155], v[56:59]
ds_read2_b32 v[100:101], v7 offset0:192 offset1:193
ds_read2_b32 v[102:103], v7 offset0:194 offset1:195
v_mfma_f32_16x16x32_bf16 v[56:59], v[136:139], v[148:151], v[56:59]
ds_read2_b32 v[104:105], v7 offset0:64 offset1:65
ds_read2_b32 v[106:107], v7 offset0:66 offset1:67
s_waitcnt lgkmcnt(6)
v_mfma_f32_16x16x32_bf16 v[20:23], v[68:71], v[84:87], v[20:23]
ds_read_b128 v[148:151], v13 offset:256
ds_read_b128 v[152:155], v13 offset:768
v_mfma_f32_16x16x32_bf16 v[24:27], v[68:71], v[88:91], v[24:27]
ds_read2_b32 v[132:133], v9 offset0:192 offset1:193
ds_read2_b32 v[134:135], v9 offset0:194 offset1:195
v_mfma_f32_16x16x32_bf16 v[24:27], v[72:75], v[84:87], v[24:27]
ds_read2_b32 v[136:137], v9 offset0:64 offset1:65
ds_read2_b32 v[138:139], v9 offset0:66 offset1:67
s_waitcnt lgkmcnt(6)
v_mfma_f32_16x16x32_bf16 v[36:39], v[100:103], v[116:119], v[36:39]
ds_read_b128 v[84:87], v11 offset:192
ds_read_b128 v[88:91], v11 offset:704
v_mfma_f32_16x16x32_bf16 v[40:43], v[100:103], v[120:123], v[40:43]
ds_read2_b32 v[68:69], v5 offset0:176 offset1:177
ds_read2_b32 v[70:71], v5 offset0:178 offset1:179
v_mfma_f32_16x16x32_bf16 v[40:43], v[104:107], v[116:119], v[40:43]
ds_read2_b32 v[72:73], v5 offset0:48 offset1:49
ds_read2_b32 v[74:75], v5 offset0:50 offset1:51
s_waitcnt lgkmcnt(6)
v_mfma_f32_16x16x32_bf16 v[52:55], v[132:135], v[148:151], v[52:55]
ds_read_b128 v[116:119], v12 offset:192
ds_read_b128 v[120:123], v12 offset:704
v_mfma_f32_16x16x32_bf16 v[56:59], v[132:135], v[152:155], v[56:59]
ds_read2_b32 v[100:101], v7 offset0:176 offset1:177
ds_read2_b32 v[102:103], v7 offset0:178 offset1:179
v_mfma_f32_16x16x32_bf16 v[56:59], v[136:139], v[148:151], v[56:59]
ds_read2_b32 v[104:105], v7 offset0:48 offset1:49
ds_read2_b32 v[106:107], v7 offset0:50 offset1:51
s_waitcnt lgkmcnt(6)
v_mfma_f32_16x16x32_bf16 v[20:23], v[68:71], v[84:87], v[20:23]
ds_read_b128 v[148:151], v13 offset:192
ds_read_b128 v[152:155], v13 offset:704
v_mfma_f32_16x16x32_bf16 v[24:27], v[68:71], v[88:91], v[24:27]
ds_read2_b32 v[132:133], v9 offset0:176 offset1:177
ds_read2_b32 v[134:135], v9 offset0:178 offset1:179
v_mfma_f32_16x16x32_bf16 v[24:27], v[72:75], v[84:87], v[24:27]
ds_read2_b32 v[136:137], v9 offset0:48 offset1:49
ds_read2_b32 v[138:139], v9 offset0:50 offset1:51
s_waitcnt lgkmcnt(6)
v_mfma_f32_16x16x32_bf16 v[36:39], v[100:103], v[116:119], v[36:39]
ds_read_b128 v[84:87], v11 offset:128
ds_read_b128 v[88:91], v11 offset:640
v_mfma_f32_16x16x32_bf16 v[40:43], v[100:103], v[120:123], v[40:43]
ds_read2_b32 v[68:69], v5 offset0:160 offset1:161
ds_read2_b32 v[70:71], v5 offset0:162 offset1:163
v_mfma_f32_16x16x32_bf16 v[40:43], v[104:107], v[116:119], v[40:43]
ds_read2_b32 v[72:73], v5 offset0:32 offset1:33
ds_read2_b32 v[74:75], v5 offset0:34 offset1:35
s_waitcnt lgkmcnt(6)
v_mfma_f32_16x16x32_bf16 v[52:55], v[132:135], v[148:151], v[52:55]
ds_read_b128 v[116:119], v12 offset:128
ds_read_b128 v[120:123], v12 offset:640
v_mfma_f32_16x16x32_bf16 v[56:59], v[132:135], v[152:155], v[56:59]
ds_read2_b32 v[100:101], v7 offset0:160 offset1:161
ds_read2_b32 v[102:103], v7 offset0:162 offset1:163
v_mfma_f32_16x16x32_bf16 v[56:59], v[136:139], v[148:151], v[56:59]
ds_read2_b32 v[104:105], v7 offset0:32 offset1:33
ds_read2_b32 v[106:107], v7 offset0:34 offset1:35
s_waitcnt lgkmcnt(6)
v_mfma_f32_16x16x32_bf16 v[20:23], v[68:71], v[84:87], v[20:23]
ds_read_b128 v[148:151], v13 offset:128
ds_read_b128 v[152:155], v13 offset:640
v_mfma_f32_16x16x32_bf16 v[24:27], v[68:71], v[88:91], v[24:27]
ds_read2_b32 v[132:133], v9 offset0:160 offset1:161
ds_read2_b32 v[134:135], v9 offset0:162 offset1:163
v_mfma_f32_16x16x32_bf16 v[24:27], v[72:75], v[84:87], v[24:27]
ds_read2_b32 v[136:137], v9 offset0:32 offset1:33
ds_read2_b32 v[138:139], v9 offset0:34 offset1:35
s_waitcnt lgkmcnt(6)
v_mfma_f32_16x16x32_bf16 v[36:39], v[100:103], v[116:119], v[36:39]
ds_read_b128 v[84:87], v11 offset:64
ds_read_b128 v[88:91], v11 offset:576
v_mfma_f32_16x16x32_bf16 v[40:43], v[100:103], v[120:123], v[40:43]
ds_read2_b32 v[68:69], v5 offset0:144 offset1:145
ds_read2_b32 v[70:71], v5 offset0:146 offset1:147
v_mfma_f32_16x16x32_bf16 v[40:43], v[104:107], v[116:119], v[40:43]
ds_read2_b32 v[72:73], v5 offset0:16 offset1:17
ds_read2_b32 v[74:75], v5 offset0:18 offset1:19
s_waitcnt lgkmcnt(6)
v_mfma_f32_16x16x32_bf16 v[52:55], v[132:135], v[148:151], v[52:55]
ds_read_b128 v[116:119], v12 offset:64
ds_read_b128 v[120:123], v12 offset:576
v_mfma_f32_16x16x32_bf16 v[56:59], v[132:135], v[152:155], v[56:59]
ds_read2_b32 v[100:101], v7 offset0:144 offset1:145
ds_read2_b32 v[102:103], v7 offset0:146 offset1:147
v_mfma_f32_16x16x32_bf16 v[56:59], v[136:139], v[148:151], v[56:59]
ds_read2_b32 v[104:105], v7 offset0:16 offset1:17
ds_read2_b32 v[106:107], v7 offset0:18 offset1:19
s_waitcnt lgkmcnt(6)
v_mfma_f32_16x16x32_bf16 v[20:23], v[68:71], v[84:87], v[20:23]
ds_read_b128 v[148:151], v13 offset:64
ds_read_b128 v[152:155], v13 offset:576
v_mfma_f32_16x16x32_bf16 v[24:27], v[68:71], v[88:91], v[24:27]
ds_read2_b32 v[132:133], v9 offset0:144 offset1:145
ds_read2_b32 v[134:135], v9 offset0:146 offset1:147
v_mfma_f32_16x16x32_bf16 v[24:27], v[72:75], v[84:87], v[24:27]
ds_read2_b32 v[136:137], v9 offset0:16 offset1:17
ds_read2_b32 v[138:139], v9 offset0:18 offset1:19
s_waitcnt lgkmcnt(6)
v_mfma_f32_16x16x32_bf16 v[36:39], v[100:103], v[116:119], v[36:39]
ds_read_b128 v[84:87], v11 offset:0
ds_read_b128 v[88:91], v11 offset:512
v_mfma_f32_16x16x32_bf16 v[40:43], v[100:103], v[120:123], v[40:43]
ds_read2_b32 v[68:69], v5 offset0:128 offset1:129
ds_read2_b32 v[70:71], v5 offset0:130 offset1:131
v_mfma_f32_16x16x32_bf16 v[40:43], v[104:107], v[116:119], v[40:43]
ds_read2_b32 v[72:73], v5 offset0:0 offset1:1
ds_read2_b32 v[74:75], v5 offset0:2 offset1:3
s_waitcnt lgkmcnt(6)
v_mfma_f32_16x16x32_bf16 v[52:55], v[132:135], v[148:151], v[52:55]
ds_read_b128 v[116:119], v12 offset:0
ds_read_b128 v[120:123], v12 offset:512
v_mfma_f32_16x16x32_bf16 v[56:59], v[132:135], v[152:155], v[56:59]
ds_read2_b32 v[100:101], v7 offset0:128 offset1:129
ds_read2_b32 v[102:103], v7 offset0:130 offset1:131
v_mfma_f32_16x16x32_bf16 v[56:59], v[136:139], v[148:151], v[56:59]
ds_read2_b32 v[104:105], v7 offset0:0 offset1:1
ds_read2_b32 v[106:107], v7 offset0:2 offset1:3
s_waitcnt lgkmcnt(6)
v_mfma_f32_16x16x32_bf16 v[20:23], v[68:71], v[84:87], v[20:23]
ds_read_b128 v[148:151], v13 offset:0
ds_read_b128 v[152:155], v13 offset:512
v_mfma_f32_16x16x32_bf16 v[24:27], v[68:71], v[88:91], v[24:27]
ds_read2_b32 v[132:133], v9 offset0:128 offset1:129
ds_read2_b32 v[134:135], v9 offset0:130 offset1:131
v_mfma_f32_16x16x32_bf16 v[24:27], v[72:75], v[84:87], v[24:27]
ds_read2_b32 v[136:137], v9 offset0:0 offset1:1
ds_read2_b32 v[138:139], v9 offset0:2 offset1:3
s_waitcnt lgkmcnt(6)
v_mfma_f32_16x16x32_bf16 v[36:39], v[100:103], v[116:119], v[36:39]
v_mfma_f32_16x16x32_bf16 v[40:43], v[100:103], v[120:123], v[40:43]
v_mfma_f32_16x16x32_bf16 v[40:43], v[104:107], v[116:119], v[40:43]
s_waitcnt lgkmcnt(0)
v_mfma_f32_16x16x32_bf16 v[52:55], v[132:135], v[148:151], v[52:55]
v_mfma_f32_16x16x32_bf16 v[56:59], v[132:135], v[152:155], v[56:59]
v_mfma_f32_16x16x32_bf16 v[56:59], v[136:139], v[148:151], v[56:59]
s_setprio 0
s_mul_i32 s40, s56, 72
s_mul_i32 s31, s57, 3
s_add_u32 s40, s40, s31
s_nop 7
s_nop 1
s_add_u32 s42, s40, 0
s_lshl_b32 s42, s42, 12
s_add_u32 s42, s42, 14680064
v_cvt_pk_bf16_f32 v68, v20, v21
v_cvt_pk_bf16_f32 v69, v22, v23
v_cvt_pk_bf16_f32 v70, v24, v25
v_cvt_pk_bf16_f32 v71, v26, v27
s_nop 1
v_permlane16_swap_b32 v68, v70
v_permlane16_swap_b32 v69, v71
s_cmp_eq_u32 s60, 0
s_cbranch_scc1 slow_100
buffer_store_dwordx4 v[68:71], v14, s[20:23], s42 offen offset:0
s_branch done_101
slow_100:
buffer_store_dwordx4 v[68:71], v14, s[20:23], s42 offen offset:0 sc1
done_101:
s_add_u32 s42, s40, 1
s_lshl_b32 s42, s42, 12
s_add_u32 s42, s42, 14680064
v_cvt_pk_bf16_f32 v76, v36, v37
v_cvt_pk_bf16_f32 v77, v38, v39
v_cvt_pk_bf16_f32 v78, v40, v41
v_cvt_pk_bf16_f32 v79, v42, v43
s_nop 1
v_permlane16_swap_b32 v76, v78
v_permlane16_swap_b32 v77, v79
s_cmp_eq_u32 s60, 0
s_cbranch_scc1 slow_102
buffer_store_dwordx4 v[76:79], v14, s[20:23], s42 offen offset:0
s_branch done_103
slow_102:
buffer_store_dwordx4 v[76:79], v14, s[20:23], s42 offen offset:0 sc1
done_103:
s_add_u32 s42, s40, 2
s_lshl_b32 s42, s42, 12
s_add_u32 s42, s42, 14680064
v_cvt_pk_bf16_f32 v84, v52, v53
v_cvt_pk_bf16_f32 v85, v54, v55
v_cvt_pk_bf16_f32 v86, v56, v57
v_cvt_pk_bf16_f32 v87, v58, v59
s_nop 1
v_permlane16_swap_b32 v84, v86
v_permlane16_swap_b32 v85, v87
s_cmp_eq_u32 s60, 0
s_cbranch_scc1 slow_104
buffer_store_dwordx4 v[84:87], v14, s[20:23], s42 offen offset:0
s_branch done_105
slow_104:
buffer_store_dwordx4 v[84:87], v14, s[20:23], s42 offen offset:0 sc1
done_105:
s_branch L_g1t
L_idle:
s_setprio 0
L_g1t:
s_barrier
s_mov_b32 s58, s59
v_lshrrev_b32 v68, 3, v1
s_lshl_b32 s31, s58, 3
v_add_u32 v68, s31, v68
v_and_b32 v70, 7, v1
v_lshlrev_b32 v69, 12, v68
v_lshl_add_u32 v69, v70, 4, v69
s_add_u32 s58, s59, 4
v_lshrrev_b32 v76, 3, v1
s_lshl_b32 s31, s58, 3
v_add_u32 v76, s31, v76
v_and_b32 v78, 7, v1
v_lshlrev_b32 v77, 12, v76
v_lshl_add_u32 v77, v78, 4, v77
s_mov_b32 s58, 8
v_lshrrev_b32 v84, 3, v1
s_lshl_b32 s31, s58, 3
v_add_u32 v84, s31, v84
v_and_b32 v86, 7, v1
v_lshlrev_b32 v85, 12, v84
v_lshl_add_u32 v85, v86, 4, v85
s_mul_i32 s46, s56, 294912
s_lshl_b32 s32, s57, 7
s_add_u32 s46, s46, s32
s_add_u32 s46, s46, 14680064
buffer_load_dwordx4 v[64:67], v69, s[20:23], s46 offen sc1
buffer_load_dwordx4 v[72:75], v77, s[20:23], s46 offen sc1
s_cmp_lg_u32 s59, 0
s_cbranch_scc1 bl_106
buffer_load_dwordx4 v[80:83], v85, s[20:23], s46 offen sc1
bl_106:
v_bfe_u32 v71, v68, 1, 1
v_bfe_u32 v12, v68, 3, 1
v_lshl_add_u32 v71, v12, 1, v71
v_lshlrev_b32 v71, 1, v71
v_xor_b32 v70, v70, v71
v_lshlrev_b32 v68, 7, v68
v_lshl_add_u32 v68, v70, 4, v68
v_add_u32 v68, 92880, v68
v_bfe_u32 v79, v76, 1, 1
v_bfe_u32 v12, v76, 3, 1
v_lshl_add_u32 v79, v12, 1, v79
v_lshlrev_b32 v79, 1, v79
v_xor_b32 v78, v78, v79
v_lshlrev_b32 v76, 7, v76
v_lshl_add_u32 v76, v78, 4, v76
v_add_u32 v76, 92880, v76
v_bfe_u32 v87, v84, 1, 1
v_bfe_u32 v12, v84, 3, 1
v_lshl_add_u32 v87, v12, 1, v87
v_lshlrev_b32 v87, 1, v87
v_xor_b32 v86, v86, v87
v_lshlrev_b32 v84, 7, v84
v_lshl_add_u32 v84, v86, 4, v84
v_add_u32 v84, 92880, v84
s_mul_i32 s44, s25, 147456
s_mul_i32 s32, s26, 144
s_add_u32 s44, s44, s32
s_mov_b32 s58, s24
s_lshl_b32 s31, s58, 6
v_add_u32 v118, s31, v1
v_mul_u32_u24 v116, 7282, v118
v_lshrrev_b32 v116, 16, v116
v_mul_u32_u24 v119, 9, v116
v_sub_u32 v117, v118, v119
v_lshlrev_b32 v118, 4, v118
v_add_u32 v118, 83664, v118
v_mul_u32_u24 v116, 2304, v116
v_lshl_add_u32 v116, v117, 4, v116
s_mov_b32 s58, 8
s_lshl_b32 s31, s58, 6
v_add_u32 v126, s31, v1
v_mul_u32_u24 v124, 7282, v126
v_lshrrev_b32 v124, 16, v124
v_mul_u32_u24 v127, 9, v124
v_sub_u32 v125, v126, v127
v_lshlrev_b32 v126, 4, v126
v_add_u32 v126, 83664, v126
v_mul_u32_u24 v124, 2304, v124
v_lshl_add_u32 v124, v125, 4, v124
v_and_b32 v132, 15, v1
v_lshrrev_b32 v133, 4, v1
v_lshrrev_b32 v134, 2, v132
s_lshr_b32 s31, s59, 2
s_lshl_b32 s31, s31, 5
s_and_b32 s32, s24, 3
v_lshl_add_u32 v134, v133, 3, v134
v_add_u32 v134, s31, v134
v_bfe_u32 v135, v132, 1, 1
s_lshl_b32 s58, s32, 1
v_add_u32 v135, s58, v135
v_bfe_u32 v128, v134, 1, 1
v_bfe_u32 v129, v134, 3, 1
v_lshl_add_u32 v128, v129, 1, v128
v_lshlrev_b32 v128, 1, v128
v_xor_b32 v135, v135, v128
v_lshlrev_b32 v134, 7, v134
v_lshl_add_u32 v134, v135, 4, v134
v_and_b32 v135, 1, v132
v_lshl_add_u32 v134, v135, 3, v134
v_add_u32 v134, 92880, v134
s_lshl_b32 s32, s32, 4
v_add_u32 v132, s32, v132
v_mul_u32_u24 v132, 2304, v132
v_lshl_add_u32 v132, v133, 4, v132
s_lshl_b32 s45, s31, 1
s_mul_i32 s32, s57, 147456
s_add_u32 s45, s45, s32
s_mul_i32 s32, s56, 144
s_add_u32 s45, s45, s32
s_add_u32 s45, s45, 1152
v_and_b32 v140, 15, v1
v_lshrrev_b32 v141, 4, v1
v_lshrrev_b32 v142, 2, v140
v_add_u32 v142, 64, v142
v_bfe_u32 v143, v140, 1, 1
v_lshl_add_u32 v143, v141, 1, v143
v_bfe_u32 v136, v142, 1, 1
v_bfe_u32 v137, v142, 3, 1
v_lshl_add_u32 v136, v137, 1, v136
v_lshlrev_b32 v136, 1, v136
v_xor_b32 v143, v143, v136
v_lshlrev_b32 v142, 7, v142
v_lshl_add_u32 v142, v143, 4, v142
v_and_b32 v143, 1, v140
v_lshl_add_u32 v142, v143, 3, v142
v_add_u32 v142, 92880, v142
v_lshl_add_u32 v140, v141, 4, v140
v_mul_u32_u24 v140, 2304, v140
s_mov_b32 s43, 128
s_mul_i32 s32, s57, 147456
s_add_u32 s43, s43, s32
s_mul_i32 s32, s56, 144
s_add_u32 s43, s43, s32
s_add_u32 s43, s43, 1152
s_barrier
bc_107:
s_waitcnt vmcnt(0)
v_max3_u32 v71, v64, v65, v66
v_max3_u32 v71, v71, v67, v72
v_max3_u32 v71, v71, v73, v74
v_max_u32 v71, v71, v75
s_cmp_lg_u32 s59, 0
s_cbranch_scc1 b2_109
v_max3_u32 v71, v71, v80, v81
v_max3_u32 v71, v71, v82, v83
b2_109:
v_cmp_eq_u32 vcc, -1, v71
s_cbranch_vccz bk_108
s_cmp_eq_u32 s61, 0
s_cbranch_scc1 bk_108
s_sub_u32 s61, s61, 1
buffer_load_dwordx4 v[64:67], v69, s[20:23], s46 offen sc1
buffer_load_dwordx4 v[72:75], v77, s[20:23], s46 offen sc1
s_cmp_lg_u32 s59, 0
s_cbranch_scc1 bl_110
buffer_load_dwordx4 v[80:83], v85, s[20:23], s46 offen sc1
bl_110:
s_branch bc_107
bk_108:
s_setprio 3
ds_write_b128 v68, v[64:67]
ds_write_b128 v76, v[72:75]
s_cmp_lg_u32 s59, 0
s_cbranch_scc1 bs_111
ds_write_b128 v84, v[80:83]
bs_111:
s_lshl_b32 s31, s59, 2
s_add_u32 s31, s31, 163824
v_mov_b32 v21, s31
s_waitcnt lgkmcnt(0)
v_mov_b32 v22, 3
s_mov_b64 exec, 1
ds_write_b32 v21, v22
s_mov_b64 exec, -1
s_mov_b64 s[6:7], exec
s_mov_b64 exec, 1
v_mov_b32 v20, 163824
s_mov_b32 s31, 65536
lw_112:
ds_read_b128 v[16:19], v20
s_sub_u32 s31, s31, 1
s_cbranch_scc1 lx_113
s_waitcnt lgkmcnt(0)
v_min3_u32 v16, v16, v17, v18
v_min_u32 v16, v16, v19
v_cmp_le_u32 vcc, 3, v16
s_cbranch_vccz lw_112
lx_113:
s_waitcnt lgkmcnt(0)
s_mov_b64 exec, s[6:7]
ds_read_b64_tr_b16 v[128:129], v134 offset:0
ds_read_b64_tr_b16 v[130:131], v134 offset:512
ds_read_b64_tr_b16 v[144:145], v134 offset:4096
ds_read_b64_tr_b16 v[146:147], v134 offset:4608
s_cmp_eq_u32 s59, 2
s_cbranch_scc1 e6_114
s_waitcnt lgkmcnt(2)
buffer_store_dwordx4 v[128:131], v132, s[48:51], s45 offen offset:0
s_waitcnt lgkmcnt(0)
buffer_store_dwordx4 v[144:147], v132, s[48:51], s45 offen offset:64
s_branch ee_115
e6_114:
ds_read_b64_tr_b16 v[136:137], v142 offset:0
ds_read_b64_tr_b16 v[138:139], v142 offset:512
s_waitcnt lgkmcnt(4)
buffer_store_dwordx4 v[128:131], v132, s[48:51], s45 offen offset:0
s_waitcnt lgkmcnt(2)
buffer_store_dwordx4 v[144:147], v132, s[48:51], s45 offen offset:64
s_waitcnt lgkmcnt(0)
buffer_store_dwordx4 v[136:139], v140, s[48:51], s43 offen offset:0
ee_115:
s_branch L_st
L_help:
s_cmp_lg_u32 s24, 10
s_cbranch_scc1 tc_116
s_mul_i32 s31, s25, 73728
s_mul_i32 s32, s26, 9216
s_add_u32 s31, s31, s32
v_lshlrev_b32 v8, 7, v1
s_mul_i32 s31, s2, 21
v_min_u32 v8, 20, v1
v_add_u32 v8, s31, v8
v_min_u32 v8, 5183, v8
v_mul_u32_u24 v9, 7282, v8
v_lshrrev_b32 v9, 16, v9
v_mul_u32_u24 v10, 9, v9
v_sub_u32 v10, v8, v10
v_mul_u32_u24 v9, 3456, v9
v_lshl_add_u32 v9, v10, 7, v9
s_mov_b32 exec_lo, 0x1fffff
s_mov_b32 exec_hi, 0
buffer_load_dword v167, v9, s[12:15], 0 offen offset:1152
s_mov_b64 exec, -1
tc_116:
s_load_dwordx4 s[8:11], s[0:1], 32
s_load_dwordx4 s[12:15], s[0:1], 48
s_load_dwordx4 s[16:19], s[0:1], 64
s_load_dwordx2 s[42:43], s[0:1], 80
s_waitcnt lgkmcnt(0)
s_sub_u32 s37, s24, 6
s_cmp_eq_u32 s24, 10
s_cbranch_scc1 fi_117
v_mov_b32 v2, 163744
v_mov_b32 v4, 0
v_mov_b32 v5, 0
v_mov_b32 v6, 0
v_mov_b32 v7, 0
ds_write_b128 v2, v[4:7] offset:0
ds_write_b128 v2, v[4:7] offset:16
ds_write_b128 v2, v[4:7] offset:32
ds_write_b128 v2, v[4:7] offset:48
ds_write_b128 v2, v[4:7] offset:64
ds_write_b128 v2, v[4:7] offset:80
s_waitcnt lgkmcnt(0)
fi_117:
s_cmp_lt_u32 s2, 192
s_cbranch_scc1 L_hut
s_setprio 1
s_lshr_b32 s38, s2, 3
s_add_u32 s38, s38, 40
s_and_b32 s39, s2, 7
s_mul_i32 s36, s39, 72
s_add_u32 s36, s36, s38
s_and_b32 s39, s37, 1
s_lshl_b32 s38, s36, 8
s_lshl_b32 s39, s39, 7
s_add_u32 s38, s38, s39
v_lshlrev_b32 v62, 1, v1
v_add_u32 v62, s38, v62
s_lshl_b32 s38, s36, 1
v_mov_b32 v64, s38
global_load_ushort v16, v62, s[10:11]
global_load_ushort v17, v62, s[12:13]
global_load_ushort v18, v62, s[14:15]
global_load_ushort v19, v62, s[16:17]
global_load_ushort v3, v64, s[42:43]
global_load_ushort v20, v64, s[18:19]
s_mul_i32 s38, s37, 4896
s_add_u32 s38, s38, 131328
s_mov_b32 m0, s38
v_and_b32 v54, 15, v1
v_lshrrev_b32 v56, 4, v1
v_lshl_add_u32 v60, v56, 4, s38
v_mul_u32_u24 v58, 288, v54
v_add_u32 v68, v58, v60
v_bfe_u32 v58, v54, 1, 1
v_add3_u32 v58, v58, v54, 0
v_lshrrev_b32 v58, 1, v58
v_mul_u32_u24 v58, 288, v58
v_add_u32 v69, v58, v60
v_bfe_u32 v58, v54, 2, 1
v_add3_u32 v58, v58, v54, 1
v_lshrrev_b32 v58, 2, v58
v_mul_u32_u24 v58, 288, v58
v_add_u32 v70, v58, v60
v_bfe_u32 v58, v54, 3, 1
v_add3_u32 v58, v58, v54, 3
v_lshrrev_b32 v58, 3, v58
v_mul_u32_u24 v58, 288, v58
v_add_u32 v71, v58, v60
v_lshlrev_b32 v58, 5, v54
v_lshl_add_u32 v58, v56, 3, v58
v_sub_u32 v2, 504, v58
s_cmp_lg_u32 s24, 10
s_cbranch_scc1 h11_118
h11_118:
v_mov_b32 v72, -1
v_mov_b32 v73, -1
v_mov_b32 v74, -1
v_mov_b32 v75, -1
v_lshlrev_b32 v76, 4, v1
s_mul_i32 s31, s25, 73728
s_add_u32 s31, s31, 0
s_and_b32 s32, s26, 1
s_lshl_b32 s27, s32, 15
s_lshl_b32 s28, s32, 9
s_lshr_b32 s32, s26, 1
s_lshl_b32 s33, s32, 13
s_add_u32 s27, s27, s33
s_add_u32 s27, s27, s31
s_lshl_b32 s33, s32, 11
s_add_u32 s28, s28, s33
s_add_u32 s28, s28, s31
v_lshrrev_b32 v78, 5, v1
v_and_b32 v77, 31, v1
v_lshlrev_b32 v77, 4, v77
v_lshl_add_u32 v77, v78, 10, v77
s_waitcnt vmcnt(0)
v_lshlrev_b32 v62, 16, v20
v_lshlrev_b32 v64, 16, v16
v_mul_f32 v62, 0x3fb8aa3b, v62
v_mul_f32 v64, 0x3fb8aa3b, v64
v_exp_f32 v62, v62
v_exp_f32 v64, v64
v_mov_b32 v66, 0x3f80
v_lshlrev_b32 v25, 16, v17
v_cvt_pk_bf16_f32 v62, v62, v62
v_cvt_pk_bf16_f32 v64, v64, v64
v_and_b32 v62, 0xffff0000, v62
v_lshlrev_b32 v26, 16, v18
v_mul_f32 v21, 0xbfb8aa3b, v62
v_and_b32 v64, 0xffff0000, v64
v_mul_f32 v22, 0x3e22f983, v62
v_lshlrev_b32 v27, 16, v19
v_add_f32 v23, v62, v62
v_mul_f32 v24, v64, v21
v_mul_f32 v25, v25, v22
v_mul_f32 v26, v26, v23
v_mul_f32 v27, v27, v23
ds_write_addtid_b32 v66
v_mul_f32 v36, 0x41800000, v24
v_mul_f32 v38, 0x43800000, v24
v_exp_f32 v28, v24
v_mul_f32 v62, 0x41800000, v25
v_mul_f32 v64, 0x43800000, v25
v_fract_f32 v54, v25
v_exp_f32 v36, v36
v_exp_f32 v38, v38
v_cos_f32 v55, v54
v_fract_f32 v62, v62
v_fract_f32 v64, v64
v_cos_f32 v63, v62
v_cos_f32 v65, v64
v_sin_f32 v54, v54
v_sin_f32 v62, v62
v_sin_f32 v64, v64
s_nop 0
s_nop 0
s_nop 0
v_mul_f32_e64 v29, v28, v54
v_mul_f32_e64 v37, -v36, v62
v_mul_f32_e64 v39, v38, v64
v_mul_f32 v28, v28, v55
v_mul_f32 v36, v36, v63
v_mul_f32 v38, v38, v65
v_mul_f32 v62, v37, v37
v_mul_f32 v64, v29, v29
v_mul_f32 v63, v37, v36
v_mul_f32 v65, v28, v29
v_fma_f32 v56, v36, v36, -v62
v_fma_f32 v30, v28, v28, -v64
v_fma_f32 v57, v36, v37, v63
v_add_f32 v31, v65, v65
v_cvt_pk_bf16_f32 v66, v36, v37
v_mul_f32 v64, v27, v39
ds_write_addtid_b32 v66 offset:288
v_mul_f32 v65, v27, v38
v_mul_f32 v62, v57, v37
v_mul_f32 v63, v57, v36
s_barrier
v_fma_f32 v40, v26, v38, -v64
v_fma_f32 v54, v56, v36, -v62
v_fma_f32 v41, v26, v39, v65
v_fma_f32 v55, v56, v37, v63
v_mul_f32 v64, v41, v31
v_cvt_pk_bf16_f32 v66, v56, v57
v_mul_f32 v65, v41, v30
ds_write_addtid_b32 v66 offset:576
v_fma_f32 v60, v40, v30, -v64
v_mul_f32 v62, v55, v37
v_mul_f32 v63, v55, v36
v_fma_f32 v61, v40, v31, v65
v_fma_f32 v56, v54, v36, -v62
v_cvt_pk_bf16_f32 v152, v40, v41
v_fma_f32 v57, v54, v37, v63
v_mul_f32 v64, v61, v31
v_cvt_pk_bf16_f32 v66, v54, v55
v_mul_f32 v65, v61, v30
ds_write_addtid_b32 v66 offset:864
v_fma_f32 v58, v60, v30, -v64
v_mul_f32 v62, v57, v37
v_fma_f32 v59, v60, v31, v65
v_mul_f32 v63, v57, v36
v_fma_f32 v54, v56, v36, -v62
v_cvt_pk_bf16_f32 v153, v60, v61
v_fma_f32 v55, v56, v37, v63
v_mul_f32 v64, v59, v31
v_cvt_pk_bf16_f32 v66, v56, v57
v_mul_f32 v65, v59, v30
ds_write_addtid_b32 v66 offset:1152
v_fma_f32 v60, v58, v30, -v64
v_mul_f32 v62, v55, v37
v_fma_f32 v61, v58, v31, v65
v_mul_f32 v63, v55, v36
v_fma_f32 v56, v54, v36, -v62
v_cvt_pk_bf16_f32 v154, v58, v59
v_fma_f32 v57, v54, v37, v63
v_mul_f32 v64, v61, v31
v_cvt_pk_bf16_f32 v66, v54, v55
v_mul_f32 v65, v61, v30
ds_write_addtid_b32 v66 offset:1440
v_fma_f32 v58, v60, v30, -v64
v_mul_f32 v62, v57, v37
v_fma_f32 v59, v60, v31, v65
v_mul_f32 v63, v57, v36
v_cvt_pk_bf16_f32 v155, v60, v61
v_fma_f32 v54, v56, v36, -v62
v_fma_f32 v55, v56, v37, v63
v_mul_f32 v64, v59, v31
v_cvt_pk_bf16_f32 v66, v56, v57
v_mul_f32 v65, v59, v30
ds_write_addtid_b32 v66 offset:1728
v_fma_f32 v60, v58, v30, -v64
v_mul_f32 v62, v55, v37
v_fma_f32 v61, v58, v31, v65
v_mul_f32 v63, v55, v36
v_cvt_pk_bf16_f32 v156, v58, v59
v_fma_f32 v56, v54, v36, -v62
v_mul_f32 v64, v61, v31
v_fma_f32 v57, v54, v37, v63
v_cvt_pk_bf16_f32 v66, v54, v55
s_barrier
v_mul_f32 v65, v61, v30
ds_write_addtid_b32 v66 offset:2016
v_fma_f32 v58, v60, v30, -v64
v_mul_f32 v62, v57, v37
v_fma_f32 v59, v60, v31, v65
v_mul_f32 v63, v57, v36
v_cvt_pk_bf16_f32 v157, v60, v61
v_fma_f32 v54, v56, v36, -v62
v_mul_f32 v64, v59, v31
v_fma_f32 v55, v56, v37, v63
v_cvt_pk_bf16_f32 v66, v56, v57
v_mul_f32 v65, v59, v30
ds_write_addtid_b32 v66 offset:2304
v_fma_f32 v60, v58, v30, -v64
v_mul_f32 v62, v55, v37
v_fma_f32 v61, v58, v31, v65
v_mul_f32 v63, v55, v36
v_cvt_pk_bf16_f32 v158, v58, v59
v_fma_f32 v56, v54, v36, -v62
v_mul_f32 v64, v61, v31
v_fma_f32 v57, v54, v37, v63
v_mul_f32 v65, v61, v30
v_cvt_pk_bf16_f32 v66, v54, v55
ds_write_addtid_b32 v66 offset:2592
v_fma_f32 v58, v60, v30, -v64
v_mul_f32 v62, v57, v37
v_fma_f32 v59, v60, v31, v65
v_mul_f32 v63, v57, v36
v_cvt_pk_bf16_f32 v159, v60, v61
v_fma_f32 v54, v56, v36, -v62
v_cvt_pk_bf16_f32 v160, v58, v59
v_fma_f32 v55, v56, v37, v63
v_mul_f32 v64, v41, v39
v_cvt_pk_bf16_f32 v66, v56, v57
v_mul_f32 v65, v41, v38
ds_write_addtid_b32 v66 offset:2880
v_mul_f32 v62, v55, v37
v_fma_f32 v42, v40, v38, -v64
v_mul_f32 v63, v55, v36
v_fma_f32 v43, v40, v39, v65
v_fma_f32 v56, v54, v36, -v62
v_mul_f32 v64, v43, v39
v_fma_f32 v57, v54, v37, v63
v_mul_f32 v65, v43, v38
v_cvt_pk_bf16_f32 v66, v54, v55
v_fma_f32 v44, v42, v38, -v64
ds_write_addtid_b32 v66 offset:3168
v_mul_f32 v62, v57, v37
v_fma_f32 v45, v42, v39, v65
v_mul_f32 v63, v57, v36
v_mul_f32 v64, v45, v39
v_fma_f32 v54, v56, v36, -v62
v_mul_f32 v65, v45, v38
v_fma_f32 v55, v56, v37, v63
v_fma_f32 v46, v44, v38, -v64
v_cvt_pk_bf16_f32 v66, v56, v57
v_fma_f32 v47, v44, v39, v65
ds_write_addtid_b32 v66 offset:3456
v_mul_f32 v64, v47, v39
v_mul_f32 v62, v55, v37
v_mul_f32 v63, v55, v36
s_barrier
v_mul_f32 v65, v47, v38
v_fma_f32 v56, v54, v36, -v62
v_fma_f32 v48, v46, v38, -v64
v_fma_f32 v57, v54, v37, v63
v_fma_f32 v49, v46, v39, v65
v_cvt_pk_bf16_f32 v66, v54, v55
v_mul_f32 v64, v49, v39
ds_write_addtid_b32 v66 offset:3744
v_mul_f32 v65, v49, v38
v_mul_f32 v62, v57, v37
v_mul_f32 v63, v57, v36
v_fma_f32 v50, v48, v38, -v64
v_fma_f32 v54, v56, v36, -v62
v_fma_f32 v51, v48, v39, v65
v_fma_f32 v55, v56, v37, v63
v_mul_f32 v64, v51, v39
v_cvt_pk_bf16_f32 v66, v56, v57
v_mul_f32 v65, v51, v38
ds_write_addtid_b32 v66 offset:4032
v_fma_f32 v52, v50, v38, -v64
v_cvt_pk_bf16_f32 v66, v54, v55
v_fma_f32 v53, v50, v39, v65
ds_write_addtid_b32 v66 offset:4320
ds_read_b128 v[120:123], v68 offset:0
ds_read_b128 v[124:127], v68 offset:64
ds_read_b128 v[128:131], v68 offset:128
ds_read_b128 v[132:135], v68 offset:192
ds_write_addtid_b32 v152 offset:0
ds_write_addtid_b32 v153 offset:288
ds_write_addtid_b32 v154 offset:576
ds_write_addtid_b32 v155 offset:864
ds_write_addtid_b32 v156 offset:1152
ds_write_addtid_b32 v157 offset:1440
ds_write_addtid_b32 v158 offset:1728
ds_write_addtid_b32 v159 offset:2016
ds_write_addtid_b32 v160 offset:2304
ds_read_b128 v[136:139], v69 offset:0
ds_read_b128 v[140:143], v69 offset:64
ds_read_b128 v[144:147], v69 offset:128
ds_read_b128 v[148:151], v69 offset:192
v_mul_f32 v62, v27, v29
v_mul_f32 v64, v31, v31
v_mul_f32 v63, v27, v28
v_mul_f32 v65, v30, v31
v_fma_f32 v56, v26, v28, -v62
v_fma_f32 v32, v30, v30, -v64
v_fma_f32 v57, v26, v29, v63
v_add_f32 v33, v65, v65
v_cvt_pk_bf16_f32 v66, v26, v27
v_mul_f32 v64, v33, v33
ds_write_addtid_b32 v66 offset:0
v_mul_f32 v62, v57, v29
v_mul_f32 v65, v32, v33
s_cmp_lg_u32 s24, 10
s_cbranch_scc1 hx_123
s_add_u32 s33, s27, 0
buffer_store_dwordx4 v[72:75], v76, s[20:23], s33 offen
s_add_u32 s33, s27, 1024
buffer_store_dwordx4 v[72:75], v76, s[20:23], s33 offen
s_add_u32 s33, s27, 2048
buffer_store_dwordx4 v[72:75], v76, s[20:23], s33 offen
hx_123:
s_barrier
v_mul_f32 v63, v57, v28
v_fma_f32 v34, v32, v32, -v64
v_fma_f32 v54, v56, v28, -v62
v_add_f32 v35, v65, v65
v_fma_f32 v55, v56, v29, v63
s_waitcnt lgkmcnt(1)
v_cvt_pk_bf16_f32 v66, v56, v57
v_mfma_f32_16x16x32_bf16 v[92:95], v[136:139], v[120:123], 0
ds_write_addtid_b32 v66 offset:288
v_mul_f32 v62, v55, v29
v_mfma_f32_16x16x32_bf16 v[92:95], v[140:143], v[124:127], v[92:95]
v_mul_f32 v63, v55, v28
v_mfma_f32_16x16x32_bf16 v[92:95], v[144:147], v[128:131], v[92:95]
v_fma_f32 v56, v54, v28, -v62
v_mfma_f32_16x16x32_bf16 v[92:95], v[148:151], v[132:135], v[92:95]
v_fma_f32 v57, v54, v29, v63
v_mul_f32 v64, v43, v33
v_cvt_pk_bf16_f32 v66, v54, v55
v_mul_f32 v65, v43, v32
ds_write_addtid_b32 v66 offset:576
v_mul_f32 v62, v57, v29
v_fma_f32 v60, v42, v32, -v64
v_mul_f32 v63, v57, v28
v_fma_f32 v61, v42, v33, v65
v_fma_f32 v54, v56, v28, -v62
v_cvt_pk_bf16_f32 v152, v42, v43
v_fma_f32 v55, v56, v29, v63
v_mul_f32 v64, v61, v33
v_cvt_pk_bf16_f32 v66, v56, v57
v_mul_f32 v65, v61, v32
ds_write_addtid_b32 v66 offset:864
v_fma_f32 v58, v60, v32, -v64
v_mul_f32 v62, v55, v29
v_mul_f32 v63, v55, v28
v_fma_f32 v59, v60, v33, v65
v_fma_f32 v56, v54, v28, -v62
v_cvt_pk_bf16_f32 v153, v60, v61
v_fma_f32 v57, v54, v29, v63
v_mul_f32 v64, v59, v33
v_cvt_pk_bf16_f32 v66, v54, v55
v_mul_f32 v65, v59, v32
ds_write_addtid_b32 v66 offset:1152
v_fma_f32 v60, v58, v32, -v64
v_mul_f32 v62, v57, v29
v_mul_f32 v63, v57, v28
s_cmp_lg_u32 s24, 10
s_cbranch_scc1 hx_124
s_add_u32 s33, s27, 3072
buffer_store_dwordx4 v[72:75], v76, s[20:23], s33 offen
s_add_u32 s33, s27, 4096
buffer_store_dwordx4 v[72:75], v76, s[20:23], s33 offen
s_add_u32 s33, s27, 5120
buffer_store_dwordx4 v[72:75], v76, s[20:23], s33 offen
hx_124:
s_barrier
v_fma_f32 v61, v58, v33, v65
v_fma_f32 v54, v56, v28, -v62
v_cvt_pk_bf16_f32 v154, v58, v59
v_fma_f32 v55, v56, v29, v63
v_mul_f32 v64, v61, v33
v_cvt_pk_bf16_f32 v66, v56, v57
v_mul_f32 v65, v61, v32
ds_write_addtid_b32 v66 offset:1440
v_fma_f32 v58, v60, v32, -v64
v_mul_f32 v62, v55, v29
v_mul_f32 v63, v55, v28
v_fma_f32 v59, v60, v33, v65
v_fma_f32 v56, v54, v28, -v62
v_cvt_pk_bf16_f32 v155, v60, v61
v_fma_f32 v57, v54, v29, v63
v_cvt_pk_bf16_f32 v156, v58, v59
v_cvt_pk_bf16_f32 v66, v54, v55
v_mul_f32 v64, v45, v33
ds_write_addtid_b32 v66 offset:1728
v_mul_f32 v65, v45, v32
v_mul_f32 v62, v57, v29
v_mul_f32 v63, v57, v28
v_fma_f32 v60, v44, v32, -v64
v_fma_f32 v54, v56, v28, -v62
v_fma_f32 v61, v44, v33, v65
v_fma_f32 v55, v56, v29, v63
v_cvt_pk_bf16_f32 v157, v44, v45
v_cvt_pk_bf16_f32 v66, v56, v57
v_mul_f32 v64, v61, v33
ds_write_addtid_b32 v66 offset:2016
v_mul_f32 v65, v61, v32
v_mul_f32 v62, v55, v29
v_mul_f32 v63, v55, v28
v_fma_f32 v58, v60, v32, -v64
v_fma_f32 v56, v54, v28, -v62
v_fma_f32 v59, v60, v33, v65
v_fma_f32 v57, v54, v29, v63
v_cvt_pk_bf16_f32 v158, v60, v61
v_cvt_pk_bf16_f32 v66, v54, v55
v_mul_f32 v64, v59, v33
ds_write_addtid_b32 v66 offset:2304
v_mul_f32 v65, v59, v32
v_mul_f32 v62, v57, v29
v_mul_f32 v63, v57, v28
v_fma_f32 v60, v58, v32, -v64
v_fma_f32 v54, v56, v28, -v62
v_fma_f32 v61, v58, v33, v65
v_fma_f32 v55, v56, v29, v63
v_cvt_pk_bf16_f32 v159, v58, v59
v_cvt_pk_bf16_f32 v66, v56, v57
v_mul_f32 v64, v61, v33
ds_write_addtid_b32 v66 offset:2592
v_mul_f32 v65, v61, v32
v_mul_f32 v62, v55, v29
v_mul_f32 v63, v55, v28
v_fma_f32 v58, v60, v32, -v64
v_fma_f32 v56, v54, v28, -v62
v_fma_f32 v59, v60, v33, v65
v_fma_f32 v57, v54, v29, v63
v_cvt_pk_bf16_f32 v160, v60, v61
v_cvt_pk_bf16_f32 v66, v54, v55
s_cmp_lg_u32 s24, 10
s_cbranch_scc1 hx_125
s_add_u32 s33, s27, 6144
buffer_store_dwordx4 v[72:75], v76, s[20:23], s33 offen
s_add_u32 s33, s27, 7168
buffer_store_dwordx4 v[72:75], v76, s[20:23], s33 offen
s_add_u32 s33, s28, 65536
buffer_store_dwordx4 v[72:75], v77, s[20:23], s33 offen
hx_125:
s_barrier
v_cvt_pk_bf16_f32 v161, v58, v59
ds_write_addtid_b32 v66 offset:2880
v_mul_f32 v64, v47, v35
v_mul_f32 v62, v57, v29
v_mul_f32 v63, v57, v28
v_mul_f32 v65, v47, v34
v_fma_f32 v54, v56, v28, -v62
v_fma_f32 v60, v46, v34, -v64
v_fma_f32 v55, v56, v29, v63
v_fma_f32 v61, v46, v35, v65
v_cvt_pk_bf16_f32 v66, v56, v57
v_cvt_pk_bf16_f32 v162, v46, v47
ds_write_addtid_b32 v66 offset:3168
v_mul_f32 v64, v61, v35
v_mul_f32 v62, v55, v29
v_mul_f32 v65, v61, v34
v_mul_f32 v63, v55, v28
v_fma_f32 v56, v54, v28, -v62
v_fma_f32 v58, v60, v34, -v64
v_fma_f32 v57, v54, v29, v63
v_fma_f32 v59, v60, v35, v65
v_cvt_pk_bf16_f32 v66, v54, v55
v_cvt_pk_bf16_f32 v163, v60, v61
ds_write_addtid_b32 v66 offset:3456
v_cvt_pk_bf16_f32 v164, v58, v59
v_mul_f32 v62, v57, v29
v_mul_f32 v64, v49, v35
v_mul_f32 v63, v57, v28
v_fma_f32 v54, v56, v28, -v62
v_mul_f32 v65, v49, v34
v_fma_f32 v55, v56, v29, v63
v_fma_f32 v60, v48, v34, -v64
v_cvt_pk_bf16_f32 v66, v56, v57
v_fma_f32 v61, v48, v35, v65
ds_write_addtid_b32 v66 offset:3744
v_cvt_pk_bf16_f32 v165, v48, v49
v_mul_f32 v62, v55, v29
v_mul_f32 v64, v61, v35
v_mul_f32 v63, v55, v28
v_fma_f32 v56, v54, v28, -v62
v_mul_f32 v65, v61, v34
v_fma_f32 v57, v54, v29, v63
v_fma_f32 v58, v60, v34, -v64
v_cvt_pk_bf16_f32 v66, v54, v55
v_fma_f32 v59, v60, v35, v65
ds_write_addtid_b32 v66 offset:4032
v_cvt_pk_bf16_f32 v166, v60, v61
v_cvt_pk_bf16_f32 v66, v56, v57
v_cvt_pk_bf16_f32 v167, v58, v59
ds_write_addtid_b32 v66 offset:4320
ds_read_b128 v[136:139], v68 offset:0
ds_read_b128 v[140:143], v68 offset:64
ds_read_b128 v[144:147], v68 offset:128
ds_read_b128 v[148:151], v68 offset:192
ds_write_addtid_b32 v152 offset:0
ds_write_addtid_b32 v153 offset:288
ds_write_addtid_b32 v154 offset:576
s_barrier
ds_write_addtid_b32 v155 offset:864
ds_write_addtid_b32 v156 offset:1152
ds_write_addtid_b32 v157 offset:1440
ds_write_addtid_b32 v158 offset:1728
ds_write_addtid_b32 v159 offset:2016
ds_write_addtid_b32 v160 offset:2304
ds_write_addtid_b32 v161 offset:2592
ds_write_addtid_b32 v162 offset:2880
ds_write_addtid_b32 v163 offset:3168
ds_write_addtid_b32 v164 offset:3456
ds_write_addtid_b32 v165 offset:3744
ds_write_addtid_b32 v166 offset:4032
ds_write_addtid_b32 v167 offset:4320
ds_read_b128 v[16:19], v70 offset:0
ds_read_b128 v[20:23], v70 offset:64
ds_read_b128 v[24:27], v70 offset:128
ds_read_b128 v[28:31], v70 offset:192
v_mul_f32 v62, v51, v35
v_mul_f32 v64, v53, v35
v_mul_f32 v63, v51, v34
v_mul_f32 v65, v53, v34
v_fma_f32 v56, v50, v34, -v62
v_fma_f32 v60, v52, v34, -v64
v_fma_f32 v57, v50, v35, v63
v_fma_f32 v61, v52, v35, v65
v_cvt_pk_bf16_f32 v152, v50, v51
v_cvt_pk_bf16_f32 v155, v52, v53
v_mul_f32 v62, v57, v35
s_waitcnt lgkmcnt(15)
v_mfma_f32_16x16x32_bf16 v[88:91], v[136:139], v[120:123], 0
v_mfma_f32_16x16x32_bf16 v[88:91], v[140:143], v[124:127], v[88:91]
v_mfma_f32_16x16x32_bf16 v[88:91], v[144:147], v[128:131], v[88:91]
v_mfma_f32_16x16x32_bf16 v[88:91], v[148:151], v[132:135], v[88:91]
ds_read_b128 v[136:139], v70 offset:1440
ds_read_b128 v[140:143], v70 offset:1504
ds_read_b128 v[144:147], v70 offset:1568
ds_read_b128 v[148:151], v70 offset:1632
s_barrier
v_mul_f32 v64, v61, v35
v_mul_f32 v63, v57, v34
v_mul_f32 v65, v61, v34
v_fma_f32 v54, v56, v34, -v62
v_fma_f32 v58, v60, v34, -v64
v_fma_f32 v55, v56, v35, v63
v_fma_f32 v59, v60, v35, v65
v_cvt_pk_bf16_f32 v153, v56, v57
v_cvt_pk_bf16_f32 v156, v60, v61
v_cvt_pk_bf16_f32 v154, v54, v55
v_cvt_pk_bf16_f32 v157, v58, v59
s_waitcnt lgkmcnt(4)
v_mfma_f32_16x16x32_bf16 v[96:99], v[16:19], v[120:123], 0
v_mfma_f32_16x16x32_bf16 v[96:99], v[20:23], v[124:127], v[96:99]
v_mfma_f32_16x16x32_bf16 v[96:99], v[24:27], v[128:131], v[96:99]
v_mfma_f32_16x16x32_bf16 v[96:99], v[28:31], v[132:135], v[96:99]
ds_read_b128 v[16:19], v71 offset:2880
ds_read_b128 v[20:23], v71 offset:2944
ds_read_b128 v[24:27], v71 offset:3008
ds_read_b128 v[28:31], v71 offset:3072
s_waitcnt lgkmcnt(4)
v_mfma_f32_16x16x32_bf16 v[100:103], v[136:139], v[120:123], 0
v_mfma_f32_16x16x32_bf16 v[100:103], v[140:143], v[124:127], v[100:103]
v_mfma_f32_16x16x32_bf16 v[100:103], v[144:147], v[128:131], v[100:103]
v_mfma_f32_16x16x32_bf16 v[100:103], v[148:151], v[132:135], v[100:103]
ds_read_b128 v[136:139], v71 offset:3744
ds_read_b128 v[140:143], v71 offset:3808
ds_read_b128 v[144:147], v71 offset:3872
s_barrier
ds_read_b128 v[148:151], v71 offset:3936
ds_write_addtid_b32 v152 offset:0
ds_write_addtid_b32 v153 offset:288
ds_write_addtid_b32 v154 offset:576
ds_write_addtid_b32 v155 offset:864
ds_write_addtid_b32 v156 offset:1152
ds_write_addtid_b32 v157 offset:1440
s_waitcnt lgkmcnt(10)
v_mfma_f32_16x16x32_bf16 v[104:107], v[16:19], v[120:123], 0
v_mfma_f32_16x16x32_bf16 v[104:107], v[20:23], v[124:127], v[104:107]
v_mfma_f32_16x16x32_bf16 v[104:107], v[24:27], v[128:131], v[104:107]
v_mfma_f32_16x16x32_bf16 v[104:107], v[28:31], v[132:135], v[104:107]
ds_read_b128 v[16:19], v71 offset:0
ds_read_b128 v[20:23], v71 offset:64
ds_read_b128 v[24:27], v71 offset:128
ds_read_b128 v[28:31], v71 offset:192
s_waitcnt lgkmcnt(10)
v_mfma_f32_16x16x32_bf16 v[108:111], v[136:139], v[120:123], 0
v_mfma_f32_16x16x32_bf16 v[108:111], v[140:143], v[124:127], v[108:111]
v_mfma_f32_16x16x32_bf16 v[108:111], v[144:147], v[128:131], v[108:111]
v_mfma_f32_16x16x32_bf16 v[108:111], v[148:151], v[132:135], v[108:111]
ds_read_b128 v[136:139], v71 offset:864
ds_read_b128 v[140:143], v71 offset:928
ds_read_b128 v[144:147], v71 offset:992
s_barrier
ds_read_b128 v[148:151], v71 offset:1056
s_waitcnt lgkmcnt(4)
v_mfma_f32_16x16x32_bf16 v[112:115], v[16:19], v[120:123], 0
v_mfma_f32_16x16x32_bf16 v[112:115], v[20:23], v[124:127], v[112:115]
v_mfma_f32_16x16x32_bf16 v[112:115], v[24:27], v[128:131], v[112:115]
v_mfma_f32_16x16x32_bf16 v[112:115], v[28:31], v[132:135], v[112:115]
s_waitcnt lgkmcnt(0)
v_mfma_f32_16x16x32_bf16 v[116:119], v[136:139], v[120:123], 0
v_mfma_f32_16x16x32_bf16 v[116:119], v[140:143], v[124:127], v[116:119]
v_mfma_f32_16x16x32_bf16 v[116:119], v[144:147], v[128:131], v[116:119]
v_mfma_f32_16x16x32_bf16 v[116:119], v[148:151], v[132:135], v[116:119]
s_nop 7
s_mul_i32 s38, s37, 4896
s_add_u32 s38, s38, 131328
v_lshl_add_u32 v62, v1, 4, s38
s_bitcmp1_b32 s37, 0
s_cbranch_scc1 kx1_119
ds_write_b128 v62, v[104:107] offset:0
ds_write_b128 v62, v[108:111] offset:1024
ds_write_b128 v62, v[112:115] offset:2048
ds_write_b128 v62, v[116:119] offset:3072
s_branch kxe_120
kx1_119:
ds_write_b128 v62, v[88:91] offset:0
ds_write_b128 v62, v[92:95] offset:1024
ds_write_b128 v62, v[96:99] offset:2048
ds_write_b128 v62, v[100:103] offset:3072
kxe_120:
s_waitcnt lgkmcnt(0)
s_barrier
s_xor_b32 s38, s37, 1
s_mul_i32 s38, s38, 4896
s_add_u32 s38, s38, 131328
v_lshl_add_u32 v62, v1, 4, s38
ds_read_b128 v[136:139], v62 offset:0
ds_read_b128 v[140:143], v62 offset:1024
ds_read_b128 v[144:147], v62 offset:2048
ds_read_b128 v[148:151], v62 offset:3072
s_mul_i32 s38, s36, 4112
s_add_u32 s38, s38, 11534336
v_lshlrev_b32 v3, 16, v3
v_cmp_eq_u32 vcc, 0, v1
v_and_b32 v64, 3, v1
v_mov_b32 v65, 0
v_lshlrev_b32 v64, 2, v64
s_add_u32 s39, s38, 4096
buffer_store_dword v65, v64, s[20:23], s39 offen
s_bitcmp1_b32 s37, 0
s_cselect_b64 vcc, 0, vcc
s_nop 1
v_cndmask_b32 v3, 0, v3, vcc
s_bitcmp1_b32 s37, 0
s_cbranch_scc0 kf1_121
v_mov_b32 v88, v104
v_mov_b32 v89, v105
v_mov_b32 v90, v106
v_mov_b32 v91, v107
v_mov_b32 v92, v108
v_mov_b32 v93, v109
v_mov_b32 v94, v110
v_mov_b32 v95, v111
v_mov_b32 v96, v112
v_mov_b32 v97, v113
v_mov_b32 v98, v114
v_mov_b32 v99, v115
v_mov_b32 v100, v116
v_mov_b32 v101, v117
v_mov_b32 v102, v118
v_mov_b32 v103, v119
s_sub_u32 s38, s38, 2048
kf1_121:
s_add_u32 s38, s38, 2048
s_waitcnt lgkmcnt(0)
v_add_f32 v88, v88, v3
v_add_f32 v88, v88, v136
v_add_f32 v89, v89, v137
v_add_f32 v90, v90, v138
v_add_f32 v91, v91, v139
v_add_f32 v92, v92, v140
v_add_f32 v93, v93, v141
v_add_f32 v94, v94, v142
v_add_f32 v95, v95, v143
v_add_f32 v96, v96, v144
v_add_f32 v97, v97, v145
v_add_f32 v98, v98, v146
v_add_f32 v99, v99, v147
v_add_f32 v100, v100, v148
v_add_f32 v101, v101, v149
v_add_f32 v102, v102, v150
v_add_f32 v103, v103, v151
v_cvt_pk_bf16_f32 v152, v91, v90
v_cvt_pk_bf16_f32 v153, v89, v88
buffer_store_dwordx2 v[152:153], v2, s[20:23], s38 offen offset:1536
v_cvt_pk_bf16_f32 v154, v95, v94
v_cvt_pk_bf16_f32 v155, v93, v92
buffer_store_dwordx2 v[154:155], v2, s[20:23], s38 offen offset:1024
v_cvt_pk_bf16_f32 v156, v99, v98
v_cvt_pk_bf16_f32 v157, v97, v96
buffer_store_dwordx2 v[156:157], v2, s[20:23], s38 offen offset:512
v_cvt_pk_bf16_f32 v158, v103, v102
v_cvt_pk_bf16_f32 v159, v101, v100
buffer_store_dwordx2 v[158:159], v2, s[20:23], s38 offen offset:0
s_barrier
s_branch L_hj
L_hut:
s_cmp_eq_u32 s24, 11
s_cbranch_scc1 L_hut2
s_lshr_b32 s46, s2, 3
s_add_u32 s46, s46, 0
s_mov_b32 s36, s8
s_and_b32 s37, s9, 0xffff
s_mov_b32 s38, 2359296
s_mov_b32 s39, 0x20000
s_mov_b32 s45, 150912
s_and_b32 s47, s2, 7
s_mul_i32 s40, s46, 73728
s_mul_i32 s41, s47, 144
s_add_u32 s40, s40, s41
s_barrier
s_nop 1
v_mov_b32 v72, -1
v_mov_b32 v73, -1
v_mov_b32 v74, -1
v_mov_b32 v75, -1
v_lshlrev_b32 v76, 4, v1
s_mul_i32 s31, s25, 73728
s_add_u32 s31, s31, 0
s_and_b32 s32, s26, 1
s_lshl_b32 s27, s32, 15
s_lshl_b32 s28, s32, 9
s_lshr_b32 s32, s26, 1
s_lshl_b32 s33, s32, 13
s_add_u32 s27, s27, s33
s_add_u32 s27, s27, s31
s_lshl_b32 s33, s32, 11
s_add_u32 s28, s28, s33
s_add_u32 s28, s28, s31
v_lshrrev_b32 v78, 5, v1
v_and_b32 v77, 31, v1
v_lshlrev_b32 v77, 4, v77
v_lshl_add_u32 v77, v78, 10, v77
s_add_u32 s33, s27, 0
buffer_store_dwordx4 v[72:75], v76, s[20:23], s33 offen
s_add_u32 s33, s27, 1024
buffer_store_dwordx4 v[72:75], v76, s[20:23], s33 offen
s_add_u32 s33, s27, 2048
buffer_store_dwordx4 v[72:75], v76, s[20:23], s33 offen
s_barrier
s_add_u32 s33, s27, 3072
buffer_store_dwordx4 v[72:75], v76, s[20:23], s33 offen
s_add_u32 s33, s27, 4096
buffer_store_dwordx4 v[72:75], v76, s[20:23], s33 offen
s_add_u32 s33, s27, 5120
buffer_store_dwordx4 v[72:75], v76, s[20:23], s33 offen
s_barrier
s_add_u32 s33, s27, 6144
buffer_store_dwordx4 v[72:75], v76, s[20:23], s33 offen
s_add_u32 s33, s27, 7168
buffer_store_dwordx4 v[72:75], v76, s[20:23], s33 offen
s_add_u32 s33, s28, 65536
buffer_store_dwordx4 v[72:75], v77, s[20:23], s33 offen
s_barrier
s_barrier
s_barrier
v_add_u32 v16, 0, v1
v_mul_u32_u24 v17, 7282, v16
v_lshrrev_b32 v17, 16, v17
v_mul_u32_u24 v18, 9, v17
v_sub_u32 v18, v16, v18
v_mul_u32_u24 v17, 1152, v17
s_add_u32 m0, s45, 0
v_lshl_add_u32 v16, v18, 4, v17
buffer_load_dwordx4 v16, s[36:39], s40 offen lds
v_add_u32 v19, 64, v1
v_mul_u32_u24 v20, 7282, v19
v_lshrrev_b32 v20, 16, v20
v_mul_u32_u24 v21, 9, v20
v_sub_u32 v21, v19, v21
v_mul_u32_u24 v20, 1152, v20
s_add_u32 m0, s45, 1024
v_lshl_add_u32 v19, v21, 4, v20
buffer_load_dwordx4 v19, s[36:39], s40 offen lds
v_add_u32 v16, 128, v1
v_mul_u32_u24 v17, 7282, v16
v_lshrrev_b32 v17, 16, v17
v_mul_u32_u24 v18, 9, v17
v_sub_u32 v18, v16, v18
v_mul_u32_u24 v17, 1152, v17
s_add_u32 m0, s45, 2048
v_lshl_add_u32 v16, v18, 4, v17
buffer_load_dwordx4 v16, s[36:39], s40 offen lds
v_add_u32 v19, 192, v1
v_mul_u32_u24 v20, 7282, v19
v_lshrrev_b32 v20, 16, v20
v_mul_u32_u24 v21, 9, v20
v_sub_u32 v21, v19, v21
v_mul_u32_u24 v20, 1152, v20
s_add_u32 m0, s45, 3072
v_lshl_add_u32 v19, v21, 4, v20
buffer_load_dwordx4 v19, s[36:39], s40 offen lds
v_add_u32 v16, 256, v1
v_mul_u32_u24 v17, 7282, v16
v_lshrrev_b32 v17, 16, v17
v_mul_u32_u24 v18, 9, v17
v_sub_u32 v18, v16, v18
v_mul_u32_u24 v17, 1152, v17
s_add_u32 m0, s45, 4096
v_lshl_add_u32 v16, v18, 4, v17
buffer_load_dwordx4 v16, s[36:39], s40 offen lds
s_barrier
v_add_u32 v19, 320, v1
v_mul_u32_u24 v20, 7282, v19
v_lshrrev_b32 v20, 16, v20
v_mul_u32_u24 v21, 9, v20
v_sub_u32 v21, v19, v21
v_mul_u32_u24 v20, 1152, v20
s_add_u32 m0, s45, 5120
v_lshl_add_u32 v19, v21, 4, v20
buffer_load_dwordx4 v19, s[36:39], s40 offen lds
v_add_u32 v16, 384, v1
v_mul_u32_u24 v17, 7282, v16
v_lshrrev_b32 v17, 16, v17
v_mul_u32_u24 v18, 9, v17
v_sub_u32 v18, v16, v18
v_mul_u32_u24 v17, 1152, v17
s_add_u32 m0, s45, 6144
v_lshl_add_u32 v16, v18, 4, v17
buffer_load_dwordx4 v16, s[36:39], s40 offen lds
v_add_u32 v19, 448, v1
v_mul_u32_u24 v20, 7282, v19
v_lshrrev_b32 v20, 16, v20
v_mul_u32_u24 v21, 9, v20
v_sub_u32 v21, v19, v21
v_mul_u32_u24 v20, 1152, v20
s_add_u32 m0, s45, 7168
v_lshl_add_u32 v19, v21, 4, v20
buffer_load_dwordx4 v19, s[36:39], s40 offen lds
v_add_u32 v16, 512, v1
v_mul_u32_u24 v17, 7282, v16
v_lshrrev_b32 v17, 16, v17
v_mul_u32_u24 v18, 9, v17
v_sub_u32 v18, v16, v18
v_mul_u32_u24 v17, 1152, v17
s_add_u32 m0, s45, 8192
v_lshl_add_u32 v16, v18, 4, v17
buffer_load_dwordx4 v16, s[36:39], s40 offen lds
v_and_b32 v22, 15, v1
v_lshrrev_b32 v23, 4, v1
v_lshrrev_b32 v24, 2, v22
v_lshl_add_u32 v24, v23, 3, v24
v_mul_u32_u24 v24, 144, v24
v_and_b32 v25, 3, v22
v_lshl_add_u32 v24, v25, 3, v24
v_add_u32 v24, s45, v24
v_lshlrev_b32 v25, 12, v22
v_lshl_add_u32 v25, v23, 4, v25
s_mul_i32 s41, s47, 294912
s_lshl_b32 s42, s46, 7
s_add_u32 s41, s41, s42
s_add_u32 s41, s41, 8388608
s_barrier
s_barrier
s_waitcnt vmcnt(0)
ds_read_b64_tr_b16 v[28:29], v24 offset:0
ds_read_b64_tr_b16 v[30:31], v24 offset:576
ds_read_b64_tr_b16 v[32:33], v24 offset:4608
ds_read_b64_tr_b16 v[34:35], v24 offset:5184
s_waitcnt lgkmcnt(2)
s_add_u32 s42, s41, 0
buffer_store_dwordx4 v[28:31], v25, s[20:23], s42 offen
s_waitcnt lgkmcnt(0)
s_add_u32 s42, s41, 64
buffer_store_dwordx4 v[32:35], v25, s[20:23], s42 offen
s_nop 1
ds_read_b64_tr_b16 v[36:37], v24 offset:32
ds_read_b64_tr_b16 v[38:39], v24 offset:608
ds_read_b64_tr_b16 v[40:41], v24 offset:4640
ds_read_b64_tr_b16 v[42:43], v24 offset:5216
s_waitcnt lgkmcnt(2)
s_add_u32 s42, s41, 65536
buffer_store_dwordx4 v[36:39], v25, s[20:23], s42 offen
s_waitcnt lgkmcnt(0)
s_barrier
s_add_u32 s42, s41, 65600
buffer_store_dwordx4 v[40:43], v25, s[20:23], s42 offen
s_nop 1
ds_read_b64_tr_b16 v[28:29], v24 offset:64
ds_read_b64_tr_b16 v[30:31], v24 offset:640
ds_read_b64_tr_b16 v[32:33], v24 offset:4672
ds_read_b64_tr_b16 v[34:35], v24 offset:5248
s_waitcnt lgkmcnt(2)
s_add_u32 s42, s41, 131072
buffer_store_dwordx4 v[28:31], v25, s[20:23], s42 offen
s_waitcnt lgkmcnt(0)
s_add_u32 s42, s41, 131136
buffer_store_dwordx4 v[32:35], v25, s[20:23], s42 offen
s_nop 1
ds_read_b64_tr_b16 v[36:37], v24 offset:96
ds_read_b64_tr_b16 v[38:39], v24 offset:672
ds_read_b64_tr_b16 v[40:41], v24 offset:4704
ds_read_b64_tr_b16 v[42:43], v24 offset:5280
s_waitcnt lgkmcnt(2)
s_add_u32 s42, s41, 196608
s_barrier
buffer_store_dwordx4 v[36:39], v25, s[20:23], s42 offen
s_waitcnt lgkmcnt(0)
s_add_u32 s42, s41, 196672
buffer_store_dwordx4 v[40:43], v25, s[20:23], s42 offen
s_nop 1
ds_read_b64_tr_b16 v[28:29], v24 offset:128
ds_read_b64_tr_b16 v[30:31], v24 offset:704
ds_read_b64_tr_b16 v[32:33], v24 offset:4736
ds_read_b64_tr_b16 v[34:35], v24 offset:5312
s_mov_b32 s42, 0x00ff00ff
s_mov_b32 s43, 0x00ff00ff
s_mov_b64 vcc, s[42:43]
s_waitcnt lgkmcnt(2)
s_add_u32 s42, s41, 262144
s_mov_b64 exec, vcc
buffer_store_dwordx4 v[28:31], v25, s[20:23], s42 offen
s_mov_b64 exec, -1
s_waitcnt lgkmcnt(0)
s_add_u32 s42, s41, 262208
s_mov_b64 exec, vcc
buffer_store_dwordx4 v[32:35], v25, s[20:23], s42 offen
s_mov_b64 exec, -1
s_nop 1
s_barrier
s_branch L_hj
L_hut2:
s_cmp_lt_u32 s2, 64
s_cbranch_scc1 L_hut3
s_lshr_b32 s46, s2, 3
s_sub_u32 s46, s46, 8
s_and_b32 s58, s46, 1
s_lshr_b32 s46, s46, 1
s_add_u32 s46, s46, 24
s_mov_b32 s36, s8
s_and_b32 s37, s9, 0xffff
s_mov_b32 s38, 2359296
s_mov_b32 s39, 0x20000
s_mov_b32 s45, 122112
s_and_b32 s47, s2, 7
s_mul_i32 s40, s46, 73728
s_mul_i32 s41, s47, 144
s_add_u32 s40, s40, s41
s_mul_i32 s41, s58, 36864
s_add_u32 s40, s40, s41
s_lshl_b32 s44, s58, 6
s_barrier
s_nop 1
v_mov_b32 v72, -1
v_mov_b32 v73, -1
v_mov_b32 v74, -1
v_mov_b32 v75, -1
v_lshlrev_b32 v76, 4, v1
s_mul_i32 s27, s56, 72
s_mul_i32 s32, s57, 3
s_add_u32 s27, s27, s32
s_lshl_b32 s27, s27, 12
s_add_u32 s27, s27, 14680064
s_add_u32 s33, s27, 0
buffer_store_dwordx4 v[72:75], v76, s[20:23], s33 offen
s_add_u32 s33, s27, 1024
buffer_store_dwordx4 v[72:75], v76, s[20:23], s33 offen
s_add_u32 s33, s27, 2048
buffer_store_dwordx4 v[72:75], v76, s[20:23], s33 offen
s_barrier
s_add_u32 s33, s27, 3072
buffer_store_dwordx4 v[72:75], v76, s[20:23], s33 offen
s_add_u32 s33, s27, 4096
buffer_store_dwordx4 v[72:75], v76, s[20:23], s33 offen
s_add_u32 s33, s27, 5120
buffer_store_dwordx4 v[72:75], v76, s[20:23], s33 offen
s_barrier
s_add_u32 s33, s27, 6144
buffer_store_dwordx4 v[72:75], v76, s[20:23], s33 offen
s_add_u32 s33, s27, 7168
buffer_store_dwordx4 v[72:75], v76, s[20:23], s33 offen
s_add_u32 s33, s27, 8192
buffer_store_dwordx4 v[72:75], v76, s[20:23], s33 offen
s_barrier
s_add_u32 s33, s27, 9216
buffer_store_dwordx4 v[72:75], v76, s[20:23], s33 offen
s_add_u32 s33, s27, 10240
buffer_store_dwordx4 v[72:75], v76, s[20:23], s33 offen
s_add_u32 s33, s27, 11264
buffer_store_dwordx4 v[72:75], v76, s[20:23], s33 offen
s_barrier
s_barrier
v_add_u32 v16, 0, v1
v_mul_u32_u24 v17, 7282, v16
v_lshrrev_b32 v17, 16, v17
v_mul_u32_u24 v18, 9, v17
v_sub_u32 v18, v16, v18
v_mul_u32_u24 v17, 1152, v17
s_add_u32 m0, s45, 0
v_lshl_add_u32 v16, v18, 4, v17
buffer_load_dwordx4 v16, s[36:39], s40 offen lds
v_add_u32 v19, 64, v1
v_mul_u32_u24 v20, 7282, v19
v_lshrrev_b32 v20, 16, v20
v_mul_u32_u24 v21, 9, v20
v_sub_u32 v21, v19, v21
v_mul_u32_u24 v20, 1152, v20
s_add_u32 m0, s45, 1024
v_lshl_add_u32 v19, v21, 4, v20
buffer_load_dwordx4 v19, s[36:39], s40 offen lds
v_add_u32 v16, 128, v1
v_mul_u32_u24 v17, 7282, v16
v_lshrrev_b32 v17, 16, v17
v_mul_u32_u24 v18, 9, v17
v_sub_u32 v18, v16, v18
v_mul_u32_u24 v17, 1152, v17
s_add_u32 m0, s45, 2048
v_lshl_add_u32 v16, v18, 4, v17
buffer_load_dwordx4 v16, s[36:39], s40 offen lds
s_barrier
v_add_u32 v19, 192, v1
v_mul_u32_u24 v20, 7282, v19
v_lshrrev_b32 v20, 16, v20
v_mul_u32_u24 v21, 9, v20
v_sub_u32 v21, v19, v21
v_mul_u32_u24 v20, 1152, v20
s_add_u32 m0, s45, 3072
v_lshl_add_u32 v19, v21, 4, v20
buffer_load_dwordx4 v19, s[36:39], s40 offen lds
v_add_u32 v16, 256, v1
v_mul_u32_u24 v17, 7282, v16
v_lshrrev_b32 v17, 16, v17
v_mul_u32_u24 v18, 9, v17
v_sub_u32 v18, v16, v18
v_mul_u32_u24 v17, 1152, v17
s_add_u32 m0, s45, 4096
v_lshl_add_u32 v16, v18, 4, v17
buffer_load_dwordx4 v16, s[36:39], s40 offen lds
v_and_b32 v22, 15, v1
v_lshrrev_b32 v23, 4, v1
v_lshrrev_b32 v24, 2, v22
v_lshl_add_u32 v24, v23, 3, v24
v_mul_u32_u24 v24, 144, v24
v_and_b32 v25, 3, v22
v_lshl_add_u32 v24, v25, 3, v24
v_add_u32 v24, s45, v24
v_lshlrev_b32 v25, 12, v22
v_lshl_add_u32 v25, v23, 4, v25
s_mul_i32 s41, s47, 294912
s_lshl_b32 s42, s46, 7
s_add_u32 s41, s41, s42
s_add_u32 s41, s41, 8388608
s_add_u32 s41, s41, s44
s_barrier
s_barrier
s_waitcnt vmcnt(0)
ds_read_b64_tr_b16 v[28:29], v24 offset:0
ds_read_b64_tr_b16 v[30:31], v24 offset:576
s_waitcnt lgkmcnt(0)
s_add_u32 s42, s41, 0
buffer_store_dwordx4 v[28:31], v25, s[20:23], s42 offen
s_nop 1
ds_read_b64_tr_b16 v[36:37], v24 offset:32
ds_read_b64_tr_b16 v[38:39], v24 offset:608
s_waitcnt lgkmcnt(0)
s_add_u32 s42, s41, 65536
s_barrier
buffer_store_dwordx4 v[36:39], v25, s[20:23], s42 offen
s_nop 1
ds_read_b64_tr_b16 v[28:29], v24 offset:64
ds_read_b64_tr_b16 v[30:31], v24 offset:640
s_waitcnt lgkmcnt(0)
s_add_u32 s42, s41, 131072
buffer_store_dwordx4 v[28:31], v25, s[20:23], s42 offen
s_nop 1
ds_read_b64_tr_b16 v[36:37], v24 offset:96
ds_read_b64_tr_b16 v[38:39], v24 offset:672
s_waitcnt lgkmcnt(0)
s_barrier
s_add_u32 s42, s41, 196608
buffer_store_dwordx4 v[36:39], v25, s[20:23], s42 offen
s_nop 1
ds_read_b64_tr_b16 v[28:29], v24 offset:128
ds_read_b64_tr_b16 v[30:31], v24 offset:704
s_mov_b32 s42, 0x00ff00ff
s_mov_b32 s43, 0x00ff00ff
s_mov_b64 vcc, s[42:43]
s_waitcnt lgkmcnt(0)
s_add_u32 s42, s41, 262144
s_mov_b64 exec, vcc
buffer_store_dwordx4 v[28:31], v25, s[20:23], s42 offen
s_mov_b64 exec, -1
s_nop 1
s_barrier
s_branch L_hj
L_hut3:
s_barrier
s_cmp_lg_u32 s57, 0
s_cbranch_scc1 mc_126
s_lshl_b32 s33, s56, 7
s_add_u32 s33, s33, 4194304
v_lshrrev_b32 v41, 5, v1
v_and_b32 v42, 31, v1
v_lshlrev_b32 v42, 2, v42
v_lshl_add_u32 v41, v41, 10, v42
v_mov_b32 v40, 0
buffer_store_dword v40, v41, s[20:23], s33 offen sc1
mc_126:
s_nop 1
v_mov_b32 v72, -1
v_mov_b32 v73, -1
v_mov_b32 v74, -1
v_mov_b32 v75, -1
v_lshlrev_b32 v76, 4, v1
s_mul_i32 s27, s56, 72
s_mul_i32 s32, s57, 3
s_add_u32 s27, s27, s32
s_lshl_b32 s27, s27, 12
s_add_u32 s27, s27, 14680064
s_add_u32 s33, s27, 0
buffer_store_dwordx4 v[72:75], v76, s[20:23], s33 offen
s_add_u32 s33, s27, 1024
buffer_store_dwordx4 v[72:75], v76, s[20:23], s33 offen
s_add_u32 s33, s27, 2048
buffer_store_dwordx4 v[72:75], v76, s[20:23], s33 offen
s_barrier
s_add_u32 s33, s27, 3072
buffer_store_dwordx4 v[72:75], v76, s[20:23], s33 offen
s_add_u32 s33, s27, 4096
buffer_store_dwordx4 v[72:75], v76, s[20:23], s33 offen
s_add_u32 s33, s27, 5120
buffer_store_dwordx4 v[72:75], v76, s[20:23], s33 offen
s_barrier
s_add_u32 s33, s27, 6144
buffer_store_dwordx4 v[72:75], v76, s[20:23], s33 offen
s_add_u32 s33, s27, 7168
buffer_store_dwordx4 v[72:75], v76, s[20:23], s33 offen
s_add_u32 s33, s27, 8192
buffer_store_dwordx4 v[72:75], v76, s[20:23], s33 offen
s_barrier
s_add_u32 s33, s27, 9216
buffer_store_dwordx4 v[72:75], v76, s[20:23], s33 offen
s_add_u32 s33, s27, 10240
buffer_store_dwordx4 v[72:75], v76, s[20:23], s33 offen
s_add_u32 s33, s27, 11264
buffer_store_dwordx4 v[72:75], v76, s[20:23], s33 offen
s_barrier
s_cmp_lg_u32 s57, 0
s_cbranch_scc1 md_127
s_waitcnt vmcnt(12)
v_mov_b32 v40, 1
s_lshl_b32 s31, s56, 2
v_mov_b32 v44, s31
s_mov_b64 exec, 1
buffer_store_dword v40, v44, s[52:55], 0 offen sc1
s_mov_b64 exec, -1
md_127:
s_barrier
s_barrier
s_barrier
s_barrier
s_barrier
s_barrier
s_barrier
L_hj:
s_setprio 0
v_and_b32 v3, 7, v1
v_lshlrev_b32 v3, 2, v3
s_cmp_eq_u32 s24, 10
s_cbranch_scc1 h11_128
buffer_load_dword v4, v3, s[52:55], 0 offen sc1
h11_128:
v_mov_b32 v72, -1
v_mov_b32 v73, -1
v_mov_b32 v74, -1
v_mov_b32 v75, -1
v_lshlrev_b32 v76, 4, v1
s_lshl_b32 s27, s26, 5
s_add_u32 s27, s27, s25
s_mul_i32 s27, s27, 7680
s_add_u32 s27, s27, 5242880
s_cmp_lg_u32 s24, 10
s_cbranch_scc1 h10_129
s_add_u32 s33, s27, 0
buffer_store_dwordx4 v[72:75], v76, s[20:23], s33 offen sc1
s_add_u32 s33, s27, 1024
buffer_store_dwordx4 v[72:75], v76, s[20:23], s33 offen sc1
s_add_u32 s33, s27, 2048
buffer_store_dwordx4 v[72:75], v76, s[20:23], s33 offen sc1
s_add_u32 s33, s27, 3072
buffer_store_dwordx4 v[72:75], v76, s[20:23], s33 offen sc1
s_lshl_b32 s32, s56, 4
v_add_u32 v77, s32, v1
v_cmp_gt_u32 vcc, 120, v77
v_lshlrev_b32 v77, 4, v77
s_mul_i32 s33, s57, 1920
s_add_u32 s33, s33, 7340032
s_and_b32 exec_lo, vcc_lo, 0xffff
s_mov_b32 exec_hi, 0
buffer_store_dwordx4 v[72:75], v77, s[20:23], s33 offen sc1
s_mov_b64 exec, -1
h10_129:
s_barrier
s_cmp_lg_u32 s24, 10
s_cbranch_scc1 h10_130
s_add_u32 s33, s27, 4096
buffer_store_dwordx4 v[72:75], v76, s[20:23], s33 offen sc1
s_add_u32 s33, s27, 5120
buffer_store_dwordx4 v[72:75], v76, s[20:23], s33 offen sc1
s_add_u32 s33, s27, 6144
buffer_store_dwordx4 v[72:75], v76, s[20:23], s33 offen sc1
s_mov_b32 exec_hi, 0
s_add_u32 s33, s27, 7168
buffer_store_dwordx4 v[72:75], v76, s[20:23], s33 offen sc1
s_mov_b64 exec, -1
h10_130:
s_barrier
s_barrier
s_waitcnt vmcnt(0)
s_barrier
s_cmp_eq_u32 s24, 10
s_cbranch_scc1 h11_131
dl_132:
s_waitcnt vmcnt(0)
v_cmp_eq_u32 vcc, 0, v4
s_cbranch_vccz dm_133
s_cmp_eq_u32 s61, 0
s_cbranch_scc1 dm_133
s_sub_u32 s61, s61, 1
buffer_load_dword v4, v3, s[52:55], 0 offen sc1
s_branch dl_132
dm_133:
s_getreg_b32 s46, hwreg(HW_REG_XCC_ID, 0, 4)
s_add_u32 s46, s46, 1
v_mov_b32 v4, s46
v_mov_b32 v5, s46
v_mov_b32 v6, s46
v_mov_b32 v7, s46
v_lshlrev_b32 v2, 4, v1
s_lshl_b32 s31, s56, 5
s_add_u32 s31, s31, s57
s_lshl_b32 s31, s31, 2
s_add_u32 s31, s31, 4194304
s_mov_b64 exec, 1
buffer_store_dword v4, v2, s[20:23], s31 offen sc1
s_mov_b64 exec, -1
h11_131:
s_barrier
s_barrier
s_barrier
v_and_b32 v3, 31, v1
v_lshrrev_b32 v5, 2, v3
v_lshlrev_b32 v5, 7, v5
v_and_b32 v6, 3, v3
v_lshl_add_u32 v5, v6, 2, v5
s_lshl_b32 s47, s26, 4
v_add_u32 v5, s47, v5
v_lshlrev_b32 v3, 2, v3
s_lshl_b32 s47, s56, 7
v_add_u32 v3, s47, v3
v_cmp_gt_u32 vcc, 32, v1
s_mov_b32 s47, 4194304
s_nop 0
v_cndmask_b32 v3, v5, v3, vcc
s_cmp_eq_u32 s24, 10
s_cbranch_scc1 h11_134
s_mov_b64 s[6:7], exec
s_mov_b64 exec, 1
v_mov_b32 v16, 163808
s_mov_b32 s31, 65536
lw_135:
ds_read_b128 v[8:11], v16
s_sub_u32 s31, s31, 1
s_cbranch_scc1 lx_136
s_waitcnt lgkmcnt(0)
v_min3_u32 v8, v8, v9, v10
v_min_u32 v8, v8, v11
v_cmp_le_u32 vcc, 20, v8
s_cbranch_vccz lw_135
lx_136:
s_waitcnt lgkmcnt(0)
s_mov_b64 exec, s[6:7]
h11_134:
s_cmp_eq_u32 s24, 10
s_cbranch_scc1 h11_137
buffer_load_dword v14, v3, s[20:23], s47 offen offset:0 sc1
h11_137:
s_cmp_eq_u32 s24, 10
s_cbranch_scc1 h11_138
s_waitcnt vmcnt(0)
s_branch d1_144
dc_139:
s_waitcnt vmcnt(0)
d1_144:
v_cmp_eq_u32 vcc, 0, v14
s_cbranch_vccz dk_140
s_cmp_eq_u32 s61, 0
s_cbranch_scc1 dk_140
s_sub_u32 s61, s61, 1
buffer_load_dword v14, v3, s[20:23], s47 offen offset:0 sc1
s_branch dc_139
dk_140:
v_mov_b32 v5, 163796
ds_write_b32 v5, v5
v_cmp_ne_u32 vcc, s46, v14
s_cmp_eq_u32 vcc_lo, 0
s_cselect_b32 s60, 1, 0
s_cmp_eq_u32 s60, 1
s_cbranch_scc1 df_143
buffer_wbl2 sc1
s_waitcnt vmcnt(0)
v_mov_b32 v4, 256
v_mov_b32 v2, 0
s_lshl_b32 s31, s56, 5
s_add_u32 s31, s31, s57
s_lshl_b32 s31, s31, 2
s_add_u32 s31, s31, 4194304
s_mov_b64 exec, 1
buffer_store_dword v4, v2, s[20:23], s31 offen offset:1024 sc1
s_mov_b64 exec, -1
s_mov_b64 exec, s[62:63]
buffer_load_dword v14, v3, s[20:23], s47 offen offset:1024 sc1
dw_141:
s_waitcnt vmcnt(0)
v_cmp_ne_u32 vcc, 256, v14
s_cbranch_vccz dx_142
s_cmp_eq_u32 s61, 0
s_cbranch_scc1 dx_142
s_sub_u32 s61, s61, 1
buffer_load_dword v14, v3, s[20:23], s47 offen offset:1024 sc1
s_branch dw_141
dx_142:
s_mov_b64 exec, -1
buffer_inv sc1
s_waitcnt vmcnt(0)
df_143:
s_add_u32 s31, s60, 1
v_mov_b32 v5, s31
v_mov_b32 v6, 163792
ds_write_b32 v6, v5
s_waitcnt lgkmcnt(0)
h11_138:
s_mul_i32 s47, s26, 82944
s_add_u32 s47, s47, 4259840
v_lshlrev_b32 v90, 4, v1
s_cmp_lg_u32 s24, 10
s_cbranch_scc1 p11_145
s_mov_b64 s[6:7], exec
s_mov_b64 exec, 1
v_mov_b32 v2, 163796
s_mov_b32 s31, 65536
lw_147:
ds_read_b32 v4, v2
s_sub_u32 s31, s31, 1
s_cbranch_scc1 lx_148
s_waitcnt lgkmcnt(0)
v_cmp_ne_u32 vcc, 0, v4
s_cbranch_vccz lw_147
lx_148:
s_waitcnt lgkmcnt(0)
s_mov_b64 exec, s[6:7]
s_mov_b64 s[6:7], exec
s_mov_b64 exec, 1
v_mov_b32 v2, 163808
s_mov_b32 s31, 65536
lw_149:
ds_read_b128 v[4:7], v2
s_sub_u32 s31, s31, 1
s_cbranch_scc1 lx_150
s_waitcnt lgkmcnt(0)
v_min3_u32 v4, v4, v5, v6
v_min_u32 v4, v4, v7
v_cmp_le_u32 vcc, 64, v4
s_cbranch_vccz lw_149
lx_150:
s_waitcnt lgkmcnt(0)
s_mov_b64 exec, s[6:7]
s_mov_b32 m0, 2048
s_add_u32 s33, s47, 2048
buffer_load_dwordx4 v90, s[20:23], s33 offen lds
s_mov_b32 m0, 6144
s_add_u32 s33, s47, 6144
buffer_load_dwordx4 v90, s[20:23], s33 offen lds
s_mov_b32 m0, 10240
s_add_u32 s33, s47, 10240
buffer_load_dwordx4 v90, s[20:23], s33 offen lds
s_mov_b32 m0, 14336
s_add_u32 s33, s47, 14336
buffer_load_dwordx4 v90, s[20:23], s33 offen lds
s_mov_b32 m0, 18432
s_add_u32 s33, s47, 18432
buffer_load_dwordx4 v90, s[20:23], s33 offen lds
s_mov_b32 m0, 22528
s_add_u32 s33, s47, 22528
buffer_load_dwordx4 v90, s[20:23], s33 offen lds
s_mov_b32 m0, 26624
s_add_u32 s33, s47, 26624
buffer_load_dwordx4 v90, s[20:23], s33 offen lds
s_mov_b32 m0, 30720
s_add_u32 s33, s47, 30720
buffer_load_dwordx4 v90, s[20:23], s33 offen lds
s_mov_b32 m0, 34816
s_add_u32 s33, s47, 34816
buffer_load_dwordx4 v90, s[20:23], s33 offen lds
s_mov_b32 m0, 38912
s_add_u32 s33, s47, 38912
buffer_load_dwordx4 v90, s[20:23], s33 offen lds
s_mov_b32 m0, 43008
s_add_u32 s33, s47, 43008
buffer_load_dwordx4 v90, s[20:23], s33 offen lds
s_mov_b32 m0, 47104
s_add_u32 s33, s47, 47104
buffer_load_dwordx4 v90, s[20:23], s33 offen lds
s_mov_b32 m0, 51200
s_add_u32 s33, s47, 51200
buffer_load_dwordx4 v90, s[20:23], s33 offen lds
s_mov_b32 m0, 55296
s_add_u32 s33, s47, 55296
buffer_load_dwordx4 v90, s[20:23], s33 offen lds
s_mov_b32 m0, 59392
s_add_u32 s33, s47, 59392
buffer_load_dwordx4 v90, s[20:23], s33 offen lds
s_mov_b32 m0, 63488
s_add_u32 s33, s47, 63488
buffer_load_dwordx4 v90, s[20:23], s33 offen lds
s_mov_b32 m0, 67584
s_add_u32 s33, s47, 67584
buffer_load_dwordx4 v90, s[20:23], s33 offen lds
s_mov_b32 m0, 71680
s_add_u32 s33, s47, 71680
buffer_load_dwordx4 v90, s[20:23], s33 offen lds
s_mov_b32 m0, 75776
s_add_u32 s33, s47, 75776
buffer_load_dwordx4 v90, s[20:23], s33 offen lds
s_mov_b32 m0, 79872
s_add_u32 s33, s47, 79872
buffer_load_dwordx4 v90, s[20:23], s33 offen lds
s_branch pj_146
p11_145:
s_mov_b64 s[6:7], exec
s_mov_b64 exec, 1
v_mov_b32 v2, 163808
s_mov_b32 s31, 65536
lw_151:
ds_read_b128 v[4:7], v2
s_sub_u32 s31, s31, 1
s_cbranch_scc1 lx_152
s_waitcnt lgkmcnt(0)
v_min3_u32 v4, v4, v5, v6
v_min_u32 v4, v4, v7
v_cmp_le_u32 vcc, 64, v4
s_cbranch_vccz lw_151
lx_152:
s_waitcnt lgkmcnt(0)
s_mov_b64 exec, s[6:7]
s_mov_b32 m0, 3072
s_add_u32 s33, s47, 3072
buffer_load_dwordx4 v90, s[20:23], s33 offen lds
s_mov_b32 m0, 7168
s_add_u32 s33, s47, 7168
buffer_load_dwordx4 v90, s[20:23], s33 offen lds
s_mov_b32 m0, 11264
s_add_u32 s33, s47, 11264
buffer_load_dwordx4 v90, s[20:23], s33 offen lds
s_mov_b32 m0, 15360
s_add_u32 s33, s47, 15360
buffer_load_dwordx4 v90, s[20:23], s33 offen lds
s_mov_b32 m0, 19456
s_add_u32 s33, s47, 19456
buffer_load_dwordx4 v90, s[20:23], s33 offen lds
s_mov_b32 m0, 23552
s_add_u32 s33, s47, 23552
buffer_load_dwordx4 v90, s[20:23], s33 offen lds
s_mov_b32 m0, 27648
s_add_u32 s33, s47, 27648
buffer_load_dwordx4 v90, s[20:23], s33 offen lds
s_mov_b32 m0, 31744
s_add_u32 s33, s47, 31744
buffer_load_dwordx4 v90, s[20:23], s33 offen lds
s_mov_b32 m0, 35840
s_add_u32 s33, s47, 35840
buffer_load_dwordx4 v90, s[20:23], s33 offen lds
s_mov_b32 m0, 39936
s_add_u32 s33, s47, 39936
buffer_load_dwordx4 v90, s[20:23], s33 offen lds
s_mov_b32 m0, 44032
s_add_u32 s33, s47, 44032
buffer_load_dwordx4 v90, s[20:23], s33 offen lds
s_mov_b32 m0, 48128
s_add_u32 s33, s47, 48128
buffer_load_dwordx4 v90, s[20:23], s33 offen lds
s_mov_b32 m0, 52224
s_add_u32 s33, s47, 52224
buffer_load_dwordx4 v90, s[20:23], s33 offen lds
s_mov_b32 m0, 56320
s_add_u32 s33, s47, 56320
buffer_load_dwordx4 v90, s[20:23], s33 offen lds
s_mov_b32 m0, 60416
s_add_u32 s33, s47, 60416
buffer_load_dwordx4 v90, s[20:23], s33 offen lds
s_mov_b32 m0, 64512
s_add_u32 s33, s47, 64512
buffer_load_dwordx4 v90, s[20:23], s33 offen lds
s_mov_b32 m0, 68608
s_add_u32 s33, s47, 68608
buffer_load_dwordx4 v90, s[20:23], s33 offen lds
s_mov_b32 m0, 72704
s_add_u32 s33, s47, 72704
buffer_load_dwordx4 v90, s[20:23], s33 offen lds
s_mov_b32 m0, 76800
s_add_u32 s33, s47, 76800
buffer_load_dwordx4 v90, s[20:23], s33 offen lds
s_mov_b32 m0, 80896
s_add_u32 s33, s47, 80896
buffer_load_dwordx4 v90, s[20:23], s33 offen lds
pj_146:
s_mov_b64 exec, -1
L_ox:
s_sub_u32 s59, s24, 8
s_mul_i32 s31, s25, 73728
s_add_u32 s31, s31, 0
s_lshl_b32 s40, s59, 13
s_add_u32 s40, s40, s31
s_mul_i32 s41, s59, 10240
s_add_u32 s41, s41, s31
s_add_u32 s41, s41, 32768
v_lshlrev_b32 v8, 4, v1
s_lshl_b32 s31, s59, 13
s_add_u32 s31, s31, 83664
v_add_u32 v10, s31, v8
s_mul_i32 s31, s59, 10240
s_add_u32 s31, s31, 116432
v_add_u32 v11, s31, v8
s_lshl_b32 s31, s59, 2
s_add_u32 s31, s31, 163760
v_mov_b32 v4, s31
v_mov_b32 v5, 1
s_waitcnt vmcnt(0)
s_mov_b64 exec, 1
ds_write_b32 v4, v5
s_mov_b64 exec, -1
s_mov_b64 s[6:7], exec
s_mov_b64 exec, 1
v_mov_b32 v6, 163792
s_mov_b32 s31, 65536
lw_153:
ds_read_b32 v4, v6
s_sub_u32 s31, s31, 1
s_cbranch_scc1 lx_154
s_waitcnt lgkmcnt(0)
v_cmp_ne_u32 vcc, 0, v4
s_cbranch_vccz lw_153
lx_154:
s_waitcnt lgkmcnt(0)
s_mov_b64 exec, s[6:7]
v_readfirstlane_b32 s60, v4
s_nop 0
s_sub_u32 s60, s60, 1
s_mov_b64 exec, 1
v_mov_b32 v2, 163776
s_mov_b32 s31, 65536
fw_155:
ds_read_b128 v[4:7], v2
s_sub_u32 s31, s31, 1
s_cbranch_scc1 fx_156
s_waitcnt lgkmcnt(0)
v_and_b32 v4, v4, v5
v_and_b32 v6, v6, v7
v_and_b32 v4, v4, v6
v_cmp_eq_u32 vcc, 1, v4
s_cbranch_vccz fw_155
fx_156:
s_waitcnt lgkmcnt(0)
s_mov_b64 exec, -1
s_setprio 3
s_add_u32 s33, s40, 0
buffer_load_dwordx4 v[16:19], v8, s[20:23], s33 offen sc1
s_add_u32 s33, s40, 1024
buffer_load_dwordx4 v[20:23], v8, s[20:23], s33 offen sc1
s_add_u32 s33, s40, 2048
buffer_load_dwordx4 v[24:27], v8, s[20:23], s33 offen sc1
s_add_u32 s33, s40, 3072
buffer_load_dwordx4 v[28:31], v8, s[20:23], s33 offen sc1
s_add_u32 s33, s40, 4096
buffer_load_dwordx4 v[32:35], v8, s[20:23], s33 offen sc1
s_add_u32 s33, s40, 5120
buffer_load_dwordx4 v[36:39], v8, s[20:23], s33 offen sc1
s_add_u32 s33, s40, 6144
buffer_load_dwordx4 v[40:43], v8, s[20:23], s33 offen sc1
s_add_u32 s33, s40, 7168
buffer_load_dwordx4 v[44:47], v8, s[20:23], s33 offen sc1
s_waitcnt vmcnt(0)
oc_158:
v_max3_u32 v9, v16, v17, v18
v_max3_u32 v9, v9, v19, v20
v_max3_u32 v9, v9, v21, v22
v_max3_u32 v9, v9, v23, v24
v_max3_u32 v9, v9, v25, v26
v_max3_u32 v9, v9, v27, v28
v_max3_u32 v9, v9, v29, v30
v_max3_u32 v9, v9, v31, v32
v_max3_u32 v9, v9, v33, v34
v_max3_u32 v9, v9, v35, v36
v_max3_u32 v9, v9, v37, v38
v_max3_u32 v9, v9, v39, v40
v_max3_u32 v9, v9, v41, v42
v_max3_u32 v9, v9, v43, v44
v_max3_u32 v9, v9, v45, v46
v_max_u32 v9, v9, v47
v_cmp_eq_u32 vcc, -1, v9
s_cbranch_vccz ok_159
s_cmp_eq_u32 s61, 0
s_cbranch_scc1 ok_159
s_sub_u32 s61, s61, 1
s_add_u32 s33, s40, 0
buffer_load_dwordx4 v[16:19], v8, s[20:23], s33 offen sc1
s_add_u32 s33, s40, 1024
buffer_load_dwordx4 v[20:23], v8, s[20:23], s33 offen sc1
s_add_u32 s33, s40, 2048
buffer_load_dwordx4 v[24:27], v8, s[20:23], s33 offen sc1
s_add_u32 s33, s40, 3072
buffer_load_dwordx4 v[28:31], v8, s[20:23], s33 offen sc1
s_add_u32 s33, s40, 4096
buffer_load_dwordx4 v[32:35], v8, s[20:23], s33 offen sc1
s_add_u32 s33, s40, 5120
buffer_load_dwordx4 v[36:39], v8, s[20:23], s33 offen sc1
s_add_u32 s33, s40, 6144
buffer_load_dwordx4 v[40:43], v8, s[20:23], s33 offen sc1
s_add_u32 s33, s40, 7168
buffer_load_dwordx4 v[44:47], v8, s[20:23], s33 offen sc1
s_waitcnt vmcnt(0)
s_branch oc_158
ok_159:
ds_write_b128 v10, v[16:19] offset:0
ds_write_b128 v10, v[20:23] offset:1024
ds_write_b128 v10, v[24:27] offset:2048
ds_write_b128 v10, v[28:31] offset:3072
ds_write_b128 v10, v[32:35] offset:4096
ds_write_b128 v10, v[36:39] offset:5120
ds_write_b128 v10, v[40:43] offset:6144
ds_write_b128 v10, v[44:47] offset:7168
s_add_u32 s33, s41, 0
buffer_load_dwordx4 v[48:51], v8, s[20:23], s33 offen sc1
s_add_u32 s33, s41, 1024
buffer_load_dwordx4 v[52:55], v8, s[20:23], s33 offen sc1
s_add_u32 s33, s41, 2048
buffer_load_dwordx4 v[56:59], v8, s[20:23], s33 offen sc1
s_add_u32 s33, s41, 3072
buffer_load_dwordx4 v[60:63], v8, s[20:23], s33 offen sc1
s_add_u32 s33, s41, 4096
buffer_load_dwordx4 v[64:67], v8, s[20:23], s33 offen sc1
s_add_u32 s33, s41, 5120
buffer_load_dwordx4 v[68:71], v8, s[20:23], s33 offen sc1
s_add_u32 s33, s41, 6144
buffer_load_dwordx4 v[72:75], v8, s[20:23], s33 offen sc1
s_add_u32 s33, s41, 7168
buffer_load_dwordx4 v[76:79], v8, s[20:23], s33 offen sc1
s_add_u32 s33, s41, 8192
buffer_load_dwordx4 v[80:83], v8, s[20:23], s33 offen sc1
s_add_u32 s33, s41, 9216
buffer_load_dwordx4 v[84:87], v8, s[20:23], s33 offen sc1
s_waitcnt lgkmcnt(0)
s_barrier
s_waitcnt vmcnt(0)
oc_161:
v_max3_u32 v9, v48, v49, v50
v_max3_u32 v9, v9, v51, v52
v_max3_u32 v9, v9, v53, v54
v_max3_u32 v9, v9, v55, v56
v_max3_u32 v9, v9, v57, v58
v_max3_u32 v9, v9, v59, v60
v_max3_u32 v9, v9, v61, v62
v_max3_u32 v9, v9, v63, v64
v_max3_u32 v9, v9, v65, v66
v_max3_u32 v9, v9, v67, v68
v_max3_u32 v9, v9, v69, v70
v_max3_u32 v9, v9, v71, v72
v_max3_u32 v9, v9, v73, v74
v_max3_u32 v9, v9, v75, v76
v_max3_u32 v9, v9, v77, v78
v_max3_u32 v9, v9, v79, v80
v_max3_u32 v9, v9, v81, v82
v_max3_u32 v9, v9, v83, v84
v_max3_u32 v9, v9, v85, v86
v_max_u32 v9, v9, v87
v_cmp_eq_u32 vcc, -1, v9
s_cbranch_vccz ok_162
s_cmp_eq_u32 s61, 0
s_cbranch_scc1 ok_162
s_sub_u32 s61, s61, 1
s_add_u32 s33, s41, 0
buffer_load_dwordx4 v[48:51], v8, s[20:23], s33 offen sc1
s_add_u32 s33, s41, 1024
buffer_load_dwordx4 v[52:55], v8, s[20:23], s33 offen sc1
s_add_u32 s33, s41, 2048
buffer_load_dwordx4 v[56:59], v8, s[20:23], s33 offen sc1
s_add_u32 s33, s41, 3072
buffer_load_dwordx4 v[60:63], v8, s[20:23], s33 offen sc1
s_add_u32 s33, s41, 4096
buffer_load_dwordx4 v[64:67], v8, s[20:23], s33 offen sc1
s_add_u32 s33, s41, 5120
buffer_load_dwordx4 v[68:71], v8, s[20:23], s33 offen sc1
s_add_u32 s33, s41, 6144
buffer_load_dwordx4 v[72:75], v8, s[20:23], s33 offen sc1
s_add_u32 s33, s41, 7168
buffer_load_dwordx4 v[76:79], v8, s[20:23], s33 offen sc1
s_add_u32 s33, s41, 8192
buffer_load_dwordx4 v[80:83], v8, s[20:23], s33 offen sc1
s_add_u32 s33, s41, 9216
buffer_load_dwordx4 v[84:87], v8, s[20:23], s33 offen sc1
s_waitcnt vmcnt(0)
s_branch oc_161
ok_162:
ds_write_b128 v11, v[48:51] offset:0
ds_write_b128 v11, v[52:55] offset:1024
ds_write_b128 v11, v[56:59] offset:2048
ds_write_b128 v11, v[60:63] offset:3072
ds_write_b128 v11, v[64:67] offset:4096
ds_write_b128 v11, v[68:71] offset:5120
ds_write_b128 v11, v[72:75] offset:6144
ds_write_b128 v11, v[76:79] offset:7168
ds_write_b128 v11, v[80:83] offset:8192
ds_write_b128 v11, v[84:87] offset:9216
s_waitcnt vmcnt(0) lgkmcnt(0)
s_setprio 0
s_barrier
s_barrier
s_branch L_end
L_loader:
s_sub_u32 s46, s24, 8
s_mul_i32 s44, s46, 1008
s_lshl_b32 s45, s46, 10
s_mul_i32 s31, s46, 7
v_mul_u32_u24 v6, 57, v1
v_lshrrev_b32 v6, 9, v6
v_mul_u32_u24 v17, 9, v6
v_sub_u32 v17, v1, v17
v_add_u32 v6, s31, v6
s_mul_i32 s33, s26, 144
v_mul_u32_u24 v16, 3456, v6
v_add_u32 v16, s33, v16
v_and_b32 v18, 1, v6
v_add3_u32 v18, v17, v18, 7
v_mul_u32_u24 v18, 7, v18
v_mul_u32_u24 v19, 57, v18
v_lshrrev_b32 v19, 9, v19
v_mul_u32_u24 v19, 9, v19
v_sub_u32 v18, v18, v19
v_lshl_add_u32 v2, v18, 4, v16
s_lshl_b32 s31, s46, 3
v_lshrrev_b32 v16, 3, v1
v_add_u32 v16, s31, v16
v_bfe_u32 v17, v16, 1, 3
v_and_b32 v18, 7, v1
v_mul_u32_u24 v16, 1152, v16
v_xor_b32 v19, v17, v18
v_lshl_add_u32 v3, v19, 4, v16
s_mul_i32 s32, s25, 73728
s_mov_b64 exec, -1
s_add_u32 m0, s45, 0
s_add_u32 s28, s32, 0
buffer_load_dwordx4 v3, s[8:11], s28 offen lds
s_add_u32 m0, s45, 2048
s_add_u32 s28, s32, 18432
buffer_load_dwordx4 v3, s[8:11], s28 offen lds
s_add_u32 m0, s45, 4096
s_add_u32 s28, s32, 36864
buffer_load_dwordx4 v3, s[8:11], s28 offen lds
s_add_u32 m0, s45, 6144
s_add_u32 s28, s32, 55296
buffer_load_dwordx4 v3, s[8:11], s28 offen lds
s_mov_b64 exec, s[34:35]
s_add_u32 m0, s44, 73728
s_mov_b32 s28, 1152
buffer_load_dwordx4 v2, s[12:15], s28 offen lds
s_add_u32 m0, s44, 75744
s_mov_b32 s28, 49536
buffer_load_dwordx4 v2, s[12:15], s28 offen lds
s_add_u32 m0, s44, 77760
s_mov_b32 s28, 97920
buffer_load_dwordx4 v2, s[12:15], s28 offen lds
s_add_u32 m0, s44, 79776
s_mov_b32 s28, 146304
buffer_load_dwordx4 v2, s[12:15], s28 offen lds
s_add_u32 m0, s44, 81792
s_mov_b32 s28, 194688
buffer_load_dwordx4 v2, s[12:15], s28 offen lds
s_mov_b64 exec, -1
s_add_u32 m0, s45, 8192
s_add_u32 s28, s32, 128
buffer_load_dwordx4 v3, s[8:11], s28 offen lds
s_add_u32 m0, s45, 10240
s_add_u32 s28, s32, 18560
buffer_load_dwordx4 v3, s[8:11], s28 offen lds
s_add_u32 m0, s45, 12288
s_add_u32 s28, s32, 36992
buffer_load_dwordx4 v3, s[8:11], s28 offen lds
s_add_u32 m0, s45, 14336
s_add_u32 s28, s32, 55424
buffer_load_dwordx4 v3, s[8:11], s28 offen lds
s_mov_b64 exec, s[34:35]
s_add_u32 m0, s44, 83808
s_mov_b32 s28, 243072
buffer_load_dwordx4 v2, s[12:15], s28 offen lds
s_add_u32 m0, s44, 85824
s_mov_b32 s28, 291456
buffer_load_dwordx4 v2, s[12:15], s28 offen lds
s_add_u32 m0, s44, 87840
s_mov_b32 s28, 339840
buffer_load_dwordx4 v2, s[12:15], s28 offen lds
s_add_u32 m0, s44, 89856
s_mov_b32 s28, 388224
buffer_load_dwordx4 v2, s[12:15], s28 offen lds
s_add_u32 m0, s44, 91872
s_mov_b32 s28, 436608
buffer_load_dwordx4 v2, s[12:15], s28 offen lds
s_load_dwordx2 s[16:17], s[0:1], 24
s_mov_b64 exec, -1
s_mul_i32 s40, s25, 81
s_add_u32 s41, s40, 81
s_lshr_b32 s40, s40, 2
s_lshr_b32 s41, s41, 2
s_lshl_b32 s40, s40, 3
s_lshl_b32 s41, s41, 3
s_mul_i32 s42, s46, 84
s_add_u32 s40, s40, s42
s_add_u32 s42, s40, 84
s_min_u32 s41, s41, s42
v_add_u32 v50, s40, v1
v_add_u32 v51, 64, v50
v_cmp_gt_u32 s[4:5], s41, v51
s_mul_i32 s42, s26, 144
s_mul_i32 s43, s26, 82944
s_add_u32 s43, s43, 4259840
v_min_u32 v53, 5183, v50
v_mul_u32_u24 v52, 7282, v53
v_lshrrev_b32 v52, 16, v52
v_mul_u32_u24 v54, 9, v52
v_sub_u32 v53, v53, v54
v_and_b32 v54, 1, v52
v_add3_u32 v53, v53, v54, 7
v_mul_u32_u24 v53, 7, v53
v_mul_u32_u24 v54, 57, v53
v_lshrrev_b32 v54, 9, v54
v_mul_u32_u24 v54, 9, v54
v_sub_u32 v53, v53, v54
v_mul_u32_u24 v54, 1152, v52
v_lshl_add_u32 v48, v53, 4, v54
v_lshlrev_b32 v50, 4, v50
v_min_u32 v53, 5183, v51
v_mul_u32_u24 v52, 7282, v53
v_lshrrev_b32 v52, 16, v52
v_mul_u32_u24 v54, 9, v52
v_sub_u32 v53, v53, v54
v_and_b32 v54, 1, v52
v_add3_u32 v53, v53, v54, 7
v_mul_u32_u24 v53, 7, v53
v_mul_u32_u24 v54, 57, v53
v_lshrrev_b32 v54, 9, v54
v_mul_u32_u24 v54, 9, v54
v_sub_u32 v53, v53, v54
v_mul_u32_u24 v54, 1152, v52
v_lshl_add_u32 v49, v53, 4, v54
v_lshlrev_b32 v51, 4, v51
s_waitcnt lgkmcnt(0)
s_and_b32 s17, s17, 0xffff
s_mov_b32 s18, 663552
s_mov_b32 s19, 0x20000
s_mov_b64 exec, -1
s_mul_i32 s31, s26, 56
s_mul_i32 s33, s46, 28
s_add_u32 s31, s31, s33
v_add_u32 v20, s31, v1
v_mul_u32_u24 v21, 9363, v20
v_lshrrev_b32 v21, 16, v21
v_mul_u32_u24 v22, 7, v21
v_sub_u32 v22, v20, v22
v_mul_u32_u24 v21, 1152, v21
v_lshl_add_u32 v22, v22, 7, v21
s_mul_i32 s31, s25, 73728
s_mov_b32 exec_lo, 0xfffffff
s_mov_b32 exec_hi, 0x0
buffer_load_dword v24, v22, s[8:11], s31 offen offset:256
s_waitcnt vmcnt(10)
s_barrier
s_mov_b64 exec, -1
s_add_u32 m0, s45, 16384
s_add_u32 s28, s32, 256
buffer_load_dwordx4 v3, s[8:11], s28 offen lds
s_add_u32 m0, s45, 18432
s_add_u32 s28, s32, 18688
buffer_load_dwordx4 v3, s[8:11], s28 offen lds
s_add_u32 m0, s45, 20480
s_add_u32 s28, s32, 37120
buffer_load_dwordx4 v3, s[8:11], s28 offen lds
s_add_u32 m0, s45, 22528
s_add_u32 s28, s32, 55552
buffer_load_dwordx4 v3, s[8:11], s28 offen lds
s_mov_b64 exec, s[34:35]
s_add_u32 m0, s44, 93888
s_mov_b32 s28, 484992
buffer_load_dwordx4 v2, s[12:15], s28 offen lds
s_add_u32 m0, s44, 95904
s_mov_b32 s28, 533376
buffer_load_dwordx4 v2, s[12:15], s28 offen lds
s_add_u32 m0, s44, 97920
s_mov_b32 s28, 581760
buffer_load_dwordx4 v2, s[12:15], s28 offen lds
s_add_u32 m0, s44, 99936
s_mov_b32 s28, 630144
buffer_load_dwordx4 v2, s[12:15], s28 offen lds
s_waitcnt vmcnt(9)
s_barrier
s_mov_b64 exec, -1
s_add_u32 m0, s45, 24576
s_add_u32 s28, s32, 384
buffer_load_dwordx4 v3, s[8:11], s28 offen lds
s_add_u32 m0, s45, 26624
s_add_u32 s28, s32, 18816
buffer_load_dwordx4 v3, s[8:11], s28 offen lds
s_add_u32 m0, s45, 28672
s_add_u32 s28, s32, 37248
buffer_load_dwordx4 v3, s[8:11], s28 offen lds
s_add_u32 m0, s45, 30720
s_add_u32 s28, s32, 55680
buffer_load_dwordx4 v3, s[8:11], s28 offen lds
s_mov_b64 exec, s[34:35]
s_add_u32 m0, s44, 101952
s_mov_b32 s28, 678528
buffer_load_dwordx4 v2, s[12:15], s28 offen lds
s_add_u32 m0, s44, 103968
s_mov_b32 s28, 726912
buffer_load_dwordx4 v2, s[12:15], s28 offen lds
s_add_u32 m0, s44, 105984
s_mov_b32 s28, 775296
buffer_load_dwordx4 v2, s[12:15], s28 offen lds
s_add_u32 m0, s44, 108000
s_mov_b32 s28, 823680
buffer_load_dwordx4 v2, s[12:15], s28 offen lds
s_add_u32 m0, s44, 110016
s_mov_b32 s28, 872064
buffer_load_dwordx4 v2, s[12:15], s28 offen lds
s_mov_b64 exec, -1
s_mul_i32 s31, s2, 41
s_mul_i32 s33, s46, 21
s_add_u32 s31, s31, s33
v_add_u32 v20, s31, v1
v_min_u32 v20, 10367, v20
v_mul_u32_u24 v21, 3641, v20
v_lshrrev_b32 v21, 16, v21
v_mul_u32_u24 v22, 18, v21
v_sub_u32 v22, v20, v22
v_mul_u32_u24 v21, 3456, v21
v_lshl_add_u32 v21, v22, 7, v21
v_add_u32 v23, 1152, v21
v_cmp_le_u32 vcc, 9, v22
s_nop 1
v_cndmask_b32 v22, v21, v23, vcc
s_mov_b32 exec_lo, 0x1fffff
s_mov_b32 exec_hi, 0x0
buffer_load_dword v24, v22, s[12:15], 0 offen
s_mov_b64 exec, -1
s_mul_i32 s31, s2, 21
s_mul_i32 s33, s46, 11
s_add_u32 s31, s31, s33
v_add_u32 v20, s31, v1
v_min_u32 v20, 5183, v20
v_lshlrev_b32 v22, 7, v20
s_mov_b32 exec_lo, 0x7ff
s_mov_b32 exec_hi, 0x0
buffer_load_dword v24, v22, s[16:19], 0 offen
s_waitcnt vmcnt(11)
s_barrier
s_mov_b64 exec, -1
s_add_u32 m0, s45, 32768
s_add_u32 s28, s32, 512
buffer_load_dwordx4 v3, s[8:11], s28 offen lds
s_add_u32 m0, s45, 34816
s_add_u32 s28, s32, 18944
buffer_load_dwordx4 v3, s[8:11], s28 offen lds
s_add_u32 m0, s45, 36864
s_add_u32 s28, s32, 37376
buffer_load_dwordx4 v3, s[8:11], s28 offen lds
s_add_u32 m0, s45, 38912
s_add_u32 s28, s32, 55808
buffer_load_dwordx4 v3, s[8:11], s28 offen lds
s_mov_b64 exec, s[34:35]
s_add_u32 m0, s44, 112032
s_mov_b32 s28, 920448
buffer_load_dwordx4 v2, s[12:15], s28 offen lds
s_add_u32 m0, s44, 114048
s_mov_b32 s28, 968832
buffer_load_dwordx4 v2, s[12:15], s28 offen lds
s_add_u32 m0, s44, 116064
s_mov_b32 s28, 1017216
buffer_load_dwordx4 v2, s[12:15], s28 offen lds
s_add_u32 m0, s44, 118080
s_mov_b32 s28, 1065600
buffer_load_dwordx4 v2, s[12:15], s28 offen lds
s_waitcnt vmcnt(10)
s_barrier
s_mov_b64 exec, -1
s_add_u32 m0, s45, 40960
s_add_u32 s28, s32, 640
buffer_load_dwordx4 v3, s[8:11], s28 offen lds
s_add_u32 m0, s45, 43008
s_add_u32 s28, s32, 19072
buffer_load_dwordx4 v3, s[8:11], s28 offen lds
s_add_u32 m0, s45, 45056
s_add_u32 s28, s32, 37504
buffer_load_dwordx4 v3, s[8:11], s28 offen lds
s_add_u32 m0, s45, 47104
s_add_u32 s28, s32, 55936
buffer_load_dwordx4 v3, s[8:11], s28 offen lds
s_mov_b64 exec, s[34:35]
s_add_u32 m0, s44, 120096
s_mov_b32 s28, 1113984
buffer_load_dwordx4 v2, s[12:15], s28 offen lds
s_add_u32 m0, s44, 73728
s_mov_b32 s28, 1162368
buffer_load_dwordx4 v2, s[12:15], s28 offen lds
s_add_u32 m0, s44, 75744
s_mov_b32 s28, 1210752
buffer_load_dwordx4 v2, s[12:15], s28 offen lds
s_add_u32 m0, s44, 77760
s_mov_b32 s28, 1259136
buffer_load_dwordx4 v2, s[12:15], s28 offen lds
s_add_u32 m0, s44, 79776
s_mov_b32 s28, 1307520
buffer_load_dwordx4 v2, s[12:15], s28 offen lds
s_mov_b64 exec, -1
s_add_u32 m0, s45, 49152
s_add_u32 s28, s32, 768
buffer_load_dwordx4 v3, s[8:11], s28 offen lds
s_add_u32 m0, s45, 51200
s_add_u32 s28, s32, 19200
buffer_load_dwordx4 v3, s[8:11], s28 offen lds
s_add_u32 m0, s45, 53248
s_add_u32 s28, s32, 37632
buffer_load_dwordx4 v3, s[8:11], s28 offen lds
s_add_u32 m0, s45, 55296
s_add_u32 s28, s32, 56064
buffer_load_dwordx4 v3, s[8:11], s28 offen lds
s_mov_b64 exec, s[34:35]
s_add_u32 m0, s44, 81792
s_mov_b32 s28, 1355904
buffer_load_dwordx4 v2, s[12:15], s28 offen lds
s_add_u32 m0, s44, 83808
s_mov_b32 s28, 1404288
buffer_load_dwordx4 v2, s[12:15], s28 offen lds
s_add_u32 m0, s44, 85824
s_mov_b32 s28, 1452672
buffer_load_dwordx4 v2, s[12:15], s28 offen lds
s_add_u32 m0, s44, 87840
s_mov_b32 s28, 1501056
buffer_load_dwordx4 v2, s[12:15], s28 offen lds
s_load_dwordx2 s[40:41], s[0:1], 32
s_mov_b64 exec, -1
s_mul_i32 s31, s2, 72
s_mul_i32 s33, s46, 36
s_add_u32 s31, s31, s33
v_add_u32 v20, s31, v1
v_min_u32 v20, 18431, v20
v_lshlrev_b32 v22, 7, v20
s_mov_b32 exec_lo, 0xffffffff
s_mov_b32 exec_hi, 0xf
s_waitcnt lgkmcnt(0)
global_load_dword v24, v22, s[40:41]
s_mov_b64 exec, -1
buffer_load_dwordx4 v[56:59], v48, s[16:19], s42 offen
s_mov_b64 exec, s[4:5]
buffer_load_dwordx4 v[60:63], v49, s[16:19], s42 offen
s_waitcnt vmcnt(20)
s_barrier
s_mov_b64 exec, -1
s_add_u32 m0, s45, 57344
s_add_u32 s28, s32, 896
buffer_load_dwordx4 v3, s[8:11], s28 offen lds
s_add_u32 m0, s45, 59392
s_add_u32 s28, s32, 19328
buffer_load_dwordx4 v3, s[8:11], s28 offen lds
s_add_u32 m0, s45, 61440
s_add_u32 s28, s32, 37760
buffer_load_dwordx4 v3, s[8:11], s28 offen lds
s_add_u32 m0, s45, 63488
s_add_u32 s28, s32, 56192
buffer_load_dwordx4 v3, s[8:11], s28 offen lds
s_mov_b64 exec, s[34:35]
s_add_u32 m0, s44, 89856
s_mov_b32 s28, 1549440
buffer_load_dwordx4 v2, s[12:15], s28 offen lds
s_add_u32 m0, s44, 91872
s_mov_b32 s28, 1597824
buffer_load_dwordx4 v2, s[12:15], s28 offen lds
s_add_u32 m0, s44, 93888
s_mov_b32 s28, 1646208
buffer_load_dwordx4 v2, s[12:15], s28 offen lds
s_add_u32 m0, s44, 95904
s_mov_b32 s28, 1694592
buffer_load_dwordx4 v2, s[12:15], s28 offen lds
s_add_u32 m0, s44, 97920
s_mov_b32 s28, 1742976
buffer_load_dwordx4 v2, s[12:15], s28 offen lds
s_mov_b64 exec, -1
s_add_u32 m0, s45, 65536
s_add_u32 s28, s32, 1024
buffer_load_dwordx4 v3, s[8:11], s28 offen lds
s_add_u32 m0, s45, 67584
s_add_u32 s28, s32, 19456
buffer_load_dwordx4 v3, s[8:11], s28 offen lds
s_add_u32 m0, s45, 69632
s_add_u32 s28, s32, 37888
buffer_load_dwordx4 v3, s[8:11], s28 offen lds
s_add_u32 m0, s45, 71680
s_add_u32 s28, s32, 56320
buffer_load_dwordx4 v3, s[8:11], s28 offen lds
s_mov_b64 exec, s[34:35]
s_add_u32 m0, s44, 99936
s_mov_b32 s28, 1791360
buffer_load_dwordx4 v2, s[12:15], s28 offen lds
s_add_u32 m0, s44, 101952
s_mov_b32 s28, 1839744
buffer_load_dwordx4 v2, s[12:15], s28 offen lds
s_add_u32 m0, s44, 103968
s_mov_b32 s28, 1888128
buffer_load_dwordx4 v2, s[12:15], s28 offen lds
s_add_u32 m0, s44, 105984
s_mov_b32 s28, 1936512
buffer_load_dwordx4 v2, s[12:15], s28 offen lds
s_waitcnt vmcnt(28)
s_barrier
v_cmp_le_u32 vcc, 2, v6
v_add_u32 v8, 1984896, v2
v_subrev_u32 v9, 4608, v2
s_add_u32 m0, s44, 108000
v_cndmask_b32 v8, v8, v9, vcc
s_mov_b32 s28, 0
buffer_load_dwordx4 v8, s[12:15], s28 offen lds
s_add_u32 m0, s44, 110016
s_mov_b32 s28, 43776
buffer_load_dwordx4 v2, s[12:15], s28 offen lds
s_add_u32 m0, s44, 112032
s_mov_b32 s28, 92160
buffer_load_dwordx4 v2, s[12:15], s28 offen lds
s_add_u32 m0, s44, 114048
s_mov_b32 s28, 140544
buffer_load_dwordx4 v2, s[12:15], s28 offen lds
s_waitcnt vmcnt(24)
s_barrier
s_add_u32 m0, s44, 116064
s_mov_b32 s28, 188928
buffer_load_dwordx4 v2, s[12:15], s28 offen lds
s_add_u32 m0, s44, 118080
s_mov_b32 s28, 237312
buffer_load_dwordx4 v2, s[12:15], s28 offen lds
s_add_u32 m0, s44, 120096
s_mov_b32 s28, 285696
buffer_load_dwordx4 v2, s[12:15], s28 offen lds
s_add_u32 m0, s44, 73728
s_mov_b32 s28, 334080
buffer_load_dwordx4 v2, s[12:15], s28 offen lds
s_add_u32 m0, s44, 75744
s_mov_b32 s28, 382464
buffer_load_dwordx4 v2, s[12:15], s28 offen lds
s_waitcnt vmcnt(17)
s_barrier
s_add_u32 m0, s44, 77760
s_mov_b32 s28, 430848
buffer_load_dwordx4 v2, s[12:15], s28 offen lds
s_add_u32 m0, s44, 79776
s_mov_b32 s28, 479232
buffer_load_dwordx4 v2, s[12:15], s28 offen lds
s_add_u32 m0, s44, 81792
s_mov_b32 s28, 527616
buffer_load_dwordx4 v2, s[12:15], s28 offen lds
s_add_u32 m0, s44, 83808
s_mov_b32 s28, 576000
buffer_load_dwordx4 v2, s[12:15], s28 offen lds
s_waitcnt vmcnt(30)
s_mov_b64 exec, -1
buffer_store_dwordx4 v[56:59], v50, s[20:23], s43 offen sc1
s_mov_b64 exec, s[4:5]
buffer_store_dwordx4 v[60:63], v51, s[20:23], s43 offen sc1
s_waitcnt vmcnt(14)
s_barrier
s_mov_b64 exec, s[34:35]
s_add_u32 m0, s44, 85824
s_mov_b32 s28, 624384
buffer_load_dwordx4 v2, s[12:15], s28 offen lds
s_add_u32 m0, s44, 87840
s_mov_b32 s28, 672768
buffer_load_dwordx4 v2, s[12:15], s28 offen lds
s_add_u32 m0, s44, 89856
s_mov_b32 s28, 721152
buffer_load_dwordx4 v2, s[12:15], s28 offen lds
s_add_u32 m0, s44, 91872
s_mov_b32 s28, 769536
buffer_load_dwordx4 v2, s[12:15], s28 offen lds
s_add_u32 m0, s44, 93888
s_mov_b32 s28, 817920
buffer_load_dwordx4 v2, s[12:15], s28 offen lds
s_waitcnt vmcnt(15)
s_barrier
s_add_u32 m0, s44, 95904
s_mov_b32 s28, 866304
buffer_load_dwordx4 v2, s[12:15], s28 offen lds
s_add_u32 m0, s44, 97920
s_mov_b32 s28, 914688
buffer_load_dwordx4 v2, s[12:15], s28 offen lds
s_add_u32 m0, s44, 99936
s_mov_b32 s28, 963072
buffer_load_dwordx4 v2, s[12:15], s28 offen lds
s_add_u32 m0, s44, 101952
s_mov_b32 s28, 1011456
buffer_load_dwordx4 v2, s[12:15], s28 offen lds
s_add_u32 m0, s44, 103968
s_mov_b32 s28, 1059840
buffer_load_dwordx4 v2, s[12:15], s28 offen lds
s_waitcnt vmcnt(15)
s_barrier
s_add_u32 m0, s44, 105984
s_mov_b32 s28, 1108224
buffer_load_dwordx4 v2, s[12:15], s28 offen lds
s_add_u32 m0, s44, 108000
s_mov_b32 s28, 1156608
buffer_load_dwordx4 v2, s[12:15], s28 offen lds
s_add_u32 m0, s44, 110016
s_mov_b32 s28, 1204992
buffer_load_dwordx4 v2, s[12:15], s28 offen lds
s_add_u32 m0, s44, 112032
s_mov_b32 s28, 1253376
buffer_load_dwordx4 v2, s[12:15], s28 offen lds
s_waitcnt vmcnt(13)
s_barrier
s_add_u32 m0, s44, 114048
s_mov_b32 s28, 1301760
buffer_load_dwordx4 v2, s[12:15], s28 offen lds
s_add_u32 m0, s44, 116064
s_mov_b32 s28, 1350144
buffer_load_dwordx4 v2, s[12:15], s28 offen lds
s_add_u32 m0, s44, 118080
s_mov_b32 s28, 1398528
buffer_load_dwordx4 v2, s[12:15], s28 offen lds
s_add_u32 m0, s44, 120096
s_mov_b32 s28, 1446912
buffer_load_dwordx4 v2, s[12:15], s28 offen lds
s_add_u32 m0, s44, 73728
s_mov_b32 s28, 1495296
buffer_load_dwordx4 v2, s[12:15], s28 offen lds
s_waitcnt vmcnt(13)
s_barrier
s_add_u32 m0, s44, 75744
s_mov_b32 s28, 1543680
buffer_load_dwordx4 v2, s[12:15], s28 offen lds
s_add_u32 m0, s44, 77760
s_mov_b32 s28, 1592064
buffer_load_dwordx4 v2, s[12:15], s28 offen lds
s_add_u32 m0, s44, 79776
s_mov_b32 s28, 1640448
buffer_load_dwordx4 v2, s[12:15], s28 offen lds
s_add_u32 m0, s44, 81792
s_mov_b32 s28, 1688832
buffer_load_dwordx4 v2, s[12:15], s28 offen lds
s_waitcnt vmcnt(13)
s_barrier
s_add_u32 m0, s44, 83808
s_mov_b32 s28, 1737216
buffer_load_dwordx4 v2, s[12:15], s28 offen lds
s_add_u32 m0, s44, 85824
s_mov_b32 s28, 1785600
buffer_load_dwordx4 v2, s[12:15], s28 offen lds
s_add_u32 m0, s44, 87840
s_mov_b32 s28, 1833984
buffer_load_dwordx4 v2, s[12:15], s28 offen lds
s_add_u32 m0, s44, 89856
s_mov_b32 s28, 1882368
buffer_load_dwordx4 v2, s[12:15], s28 offen lds
s_add_u32 m0, s44, 91872
s_mov_b32 s28, 1930752
buffer_load_dwordx4 v2, s[12:15], s28 offen lds
s_waitcnt vmcnt(13)
s_barrier
v_cmp_le_u32 vcc, 4, v6
v_add_u32 v8, 1979136, v2
v_subrev_u32 v9, 13824, v2
s_add_u32 m0, s44, 93888
v_cndmask_b32 v8, v8, v9, vcc
s_mov_b32 s28, 0
buffer_load_dwordx4 v8, s[12:15], s28 offen lds
s_add_u32 m0, s44, 95904
s_mov_b32 s28, 34560
buffer_load_dwordx4 v2, s[12:15], s28 offen lds
s_add_u32 m0, s44, 97920
s_mov_b32 s28, 82944
buffer_load_dwordx4 v2, s[12:15], s28 offen lds
s_add_u32 m0, s44, 99936
s_mov_b32 s28, 131328
buffer_load_dwordx4 v2, s[12:15], s28 offen lds
s_waitcnt vmcnt(32)
s_waitcnt vmcnt(12)
s_barrier
s_add_u32 m0, s44, 101952
s_mov_b32 s28, 179712
buffer_load_dwordx4 v2, s[12:15], s28 offen lds
s_add_u32 m0, s44, 103968
s_mov_b32 s28, 228096
buffer_load_dwordx4 v2, s[12:15], s28 offen lds
s_add_u32 m0, s44, 105984
s_mov_b32 s28, 276480
buffer_load_dwordx4 v2, s[12:15], s28 offen lds
s_add_u32 m0, s44, 108000
s_mov_b32 s28, 324864
buffer_load_dwordx4 v2, s[12:15], s28 offen lds
s_add_u32 m0, s44, 110016
s_mov_b32 s28, 373248
buffer_load_dwordx4 v2, s[12:15], s28 offen lds
s_waitcnt vmcnt(13)
s_barrier
s_add_u32 m0, s44, 112032
s_mov_b32 s28, 421632
buffer_load_dwordx4 v2, s[12:15], s28 offen lds
s_add_u32 m0, s44, 114048
s_mov_b32 s28, 470016
buffer_load_dwordx4 v2, s[12:15], s28 offen lds
s_add_u32 m0, s44, 116064
s_mov_b32 s28, 518400
buffer_load_dwordx4 v2, s[12:15], s28 offen lds
s_add_u32 m0, s44, 118080
s_mov_b32 s28, 566784
buffer_load_dwordx4 v2, s[12:15], s28 offen lds
s_add_u32 m0, s44, 120096
s_mov_b32 s28, 615168
buffer_load_dwordx4 v2, s[12:15], s28 offen lds
s_waitcnt vmcnt(13)
s_barrier
s_add_u32 m0, s44, 73728
s_mov_b32 s28, 663552
buffer_load_dwordx4 v2, s[12:15], s28 offen lds
s_add_u32 m0, s44, 75744
s_mov_b32 s28, 711936
buffer_load_dwordx4 v2, s[12:15], s28 offen lds
s_add_u32 m0, s44, 77760
s_mov_b32 s28, 760320
buffer_load_dwordx4 v2, s[12:15], s28 offen lds
s_add_u32 m0, s44, 79776
s_mov_b32 s28, 808704
buffer_load_dwordx4 v2, s[12:15], s28 offen lds
s_waitcnt vmcnt(13)
s_barrier
s_add_u32 m0, s44, 81792
s_mov_b32 s28, 857088
buffer_load_dwordx4 v2, s[12:15], s28 offen lds
s_add_u32 m0, s44, 83808
s_mov_b32 s28, 905472
buffer_load_dwordx4 v2, s[12:15], s28 offen lds
s_add_u32 m0, s44, 85824
s_mov_b32 s28, 953856
buffer_load_dwordx4 v2, s[12:15], s28 offen lds
s_add_u32 m0, s44, 87840
s_mov_b32 s28, 1002240
buffer_load_dwordx4 v2, s[12:15], s28 offen lds
s_add_u32 m0, s44, 89856
s_mov_b32 s28, 1050624
buffer_load_dwordx4 v2, s[12:15], s28 offen lds
s_setprio 3
s_lshl_b32 s31, s46, 2
s_add_u32 s31, s31, 163800
v_mov_b32 v26, s31
s_waitcnt vmcnt(13)
s_mov_b64 exec, 1
v_mov_b32 v27, 19
ds_write_b32 v26, v27
s_mov_b64 s[6:7], exec
s_mov_b64 exec, 1
v_mov_b32 v44, 163808
s_mov_b32 s31, 65536
lw_163:
ds_read_b128 v[40:43], v44
s_sub_u32 s31, s31, 1
s_cbranch_scc1 lx_164
s_waitcnt lgkmcnt(0)
v_min3_u32 v40, v40, v41, v42
v_min_u32 v40, v40, v43
v_cmp_le_u32 vcc, 18, v40
s_cbranch_vccz lw_163
lx_164:
s_waitcnt lgkmcnt(0)
s_mov_b64 exec, s[6:7]
s_mov_b64 exec, s[34:35]
s_add_u32 m0, s44, 91872
s_mov_b32 s28, 1099008
buffer_load_dwordx4 v2, s[12:15], s28 offen lds
s_add_u32 m0, s44, 93888
s_mov_b32 s28, 1147392
buffer_load_dwordx4 v2, s[12:15], s28 offen lds
s_add_u32 m0, s44, 95904
s_mov_b32 s28, 1195776
buffer_load_dwordx4 v2, s[12:15], s28 offen lds
s_add_u32 m0, s44, 97920
s_mov_b32 s28, 1244160
buffer_load_dwordx4 v2, s[12:15], s28 offen lds
s_waitcnt vmcnt(13)
s_mov_b64 exec, 1
v_mov_b32 v27, 20
ds_write_b32 v26, v27
s_mov_b64 s[6:7], exec
s_mov_b64 exec, 1
v_mov_b32 v44, 163808
s_mov_b32 s31, 65536
lw_165:
ds_read_b128 v[40:43], v44
s_sub_u32 s31, s31, 1
s_cbranch_scc1 lx_166
s_waitcnt lgkmcnt(0)
v_min3_u32 v40, v40, v41, v42
v_min_u32 v40, v40, v43
v_cmp_le_u32 vcc, 19, v40
s_cbranch_vccz lw_165
lx_166:
s_waitcnt lgkmcnt(0)
s_mov_b64 exec, s[6:7]
s_mov_b64 exec, s[34:35]
s_add_u32 m0, s44, 99936
s_mov_b32 s28, 1292544
buffer_load_dwordx4 v2, s[12:15], s28 offen lds
s_add_u32 m0, s44, 101952
s_mov_b32 s28, 1340928
buffer_load_dwordx4 v2, s[12:15], s28 offen lds
s_add_u32 m0, s44, 103968
s_mov_b32 s28, 1389312
buffer_load_dwordx4 v2, s[12:15], s28 offen lds
s_add_u32 m0, s44, 105984
s_mov_b32 s28, 1437696
buffer_load_dwordx4 v2, s[12:15], s28 offen lds
s_add_u32 m0, s44, 108000
s_mov_b32 s28, 1486080
buffer_load_dwordx4 v2, s[12:15], s28 offen lds
s_waitcnt vmcnt(13)
s_mov_b64 exec, 1
v_mov_b32 v27, 21
ds_write_b32 v26, v27
s_mov_b64 s[6:7], exec
s_mov_b64 exec, 1
v_mov_b32 v44, 163808
s_mov_b32 s31, 65536
lw_167:
ds_read_b128 v[40:43], v44
s_sub_u32 s31, s31, 1
s_cbranch_scc1 lx_168
s_waitcnt lgkmcnt(0)
v_min3_u32 v40, v40, v41, v42
v_min_u32 v40, v40, v43
v_cmp_le_u32 vcc, 20, v40
s_cbranch_vccz lw_167
lx_168:
s_waitcnt lgkmcnt(0)
s_mov_b64 exec, s[6:7]
s_mov_b64 exec, s[34:35]
s_add_u32 m0, s44, 110016
s_mov_b32 s28, 1534464
buffer_load_dwordx4 v2, s[12:15], s28 offen lds
s_add_u32 m0, s44, 112032
s_mov_b32 s28, 1582848
buffer_load_dwordx4 v2, s[12:15], s28 offen lds
s_add_u32 m0, s44, 114048
s_mov_b32 s28, 1631232
buffer_load_dwordx4 v2, s[12:15], s28 offen lds
s_add_u32 m0, s44, 116064
s_mov_b32 s28, 1679616
buffer_load_dwordx4 v2, s[12:15], s28 offen lds
s_waitcnt vmcnt(12)
s_mov_b64 exec, 1
v_mov_b32 v27, 22
ds_write_b32 v26, v27
s_mov_b64 s[6:7], exec
s_mov_b64 exec, 1
v_mov_b32 v44, 163808
s_mov_b32 s31, 65536
lw_169:
ds_read_b128 v[40:43], v44
s_sub_u32 s31, s31, 1
s_cbranch_scc1 lx_170
s_waitcnt lgkmcnt(0)
v_min3_u32 v40, v40, v41, v42
v_min_u32 v40, v40, v43
v_cmp_le_u32 vcc, 21, v40
s_cbranch_vccz lw_169
lx_170:
s_waitcnt lgkmcnt(0)
s_mov_b64 exec, s[6:7]
s_mov_b64 exec, s[34:35]
s_add_u32 m0, s44, 118080
s_mov_b32 s28, 1728000
buffer_load_dwordx4 v2, s[12:15], s28 offen lds
s_add_u32 m0, s44, 120096
s_mov_b32 s28, 1776384
buffer_load_dwordx4 v2, s[12:15], s28 offen lds
s_add_u32 m0, s44, 73728
s_mov_b32 s28, 1824768
buffer_load_dwordx4 v2, s[12:15], s28 offen lds
s_add_u32 m0, s44, 75744
s_mov_b32 s28, 1873152
buffer_load_dwordx4 v2, s[12:15], s28 offen lds
s_add_u32 m0, s44, 77760
s_mov_b32 s28, 1921536
buffer_load_dwordx4 v2, s[12:15], s28 offen lds
s_waitcnt vmcnt(13)
s_mov_b64 exec, 1
v_mov_b32 v27, 23
ds_write_b32 v26, v27
s_mov_b64 s[6:7], exec
s_mov_b64 exec, 1
v_mov_b32 v44, 163808
s_mov_b32 s31, 65536
lw_171:
ds_read_b128 v[40:43], v44
s_sub_u32 s31, s31, 1
s_cbranch_scc1 lx_172
s_waitcnt lgkmcnt(0)
v_min3_u32 v40, v40, v41, v42
v_min_u32 v40, v40, v43
v_cmp_le_u32 vcc, 22, v40
s_cbranch_vccz lw_171
lx_172:
s_waitcnt lgkmcnt(0)
s_mov_b64 exec, s[6:7]
s_mov_b64 exec, s[34:35]
s_add_u32 m0, s44, 79776
s_mov_b32 s28, 1969920
buffer_load_dwordx4 v2, s[12:15], s28 offen lds
s_waitcnt vmcnt(9)
s_mov_b64 exec, 1
v_mov_b32 v27, 24
ds_write_b32 v26, v27
s_waitcnt vmcnt(5)
s_mov_b64 exec, 1
v_mov_b32 v27, 25
ds_write_b32 v26, v27
s_waitcnt vmcnt(0)
s_mov_b64 exec, 1
v_mov_b32 v27, 26
ds_write_b32 v26, v27
s_setprio 0
s_mov_b64 exec, -1
s_mul_i32 s47, s26, 82944
s_add_u32 s47, s47, 4259840
v_lshlrev_b32 v90, 4, v1
s_mov_b64 s[6:7], exec
s_mov_b64 exec, 1
v_mov_b32 v44, 163796
s_mov_b32 s31, 65536
lw_173:
ds_read_b32 v40, v44
s_sub_u32 s31, s31, 1
s_cbranch_scc1 lx_174
s_waitcnt lgkmcnt(0)
v_cmp_ne_u32 vcc, 0, v40
s_cbranch_vccz lw_173
lx_174:
s_waitcnt lgkmcnt(0)
s_mov_b64 exec, s[6:7]
s_mov_b64 s[6:7], exec
s_mov_b64 exec, 1
v_mov_b32 v44, 163808
s_mov_b32 s31, 65536
lw_175:
ds_read_b128 v[40:43], v44
s_sub_u32 s31, s31, 1
s_cbranch_scc1 lx_176
s_waitcnt lgkmcnt(0)
v_min3_u32 v40, v40, v41, v42
v_min_u32 v40, v40, v43
v_cmp_le_u32 vcc, 64, v40
s_cbranch_vccz lw_175
lx_176:
s_waitcnt lgkmcnt(0)
s_mov_b64 exec, s[6:7]
s_cmp_lg_u32 s46, 0
s_cbranch_scc1 p9_177
s_mov_b32 m0, 0
s_add_u32 s33, s47, 0
buffer_load_dwordx4 v90, s[20:23], s33 offen lds
s_mov_b32 m0, 4096
s_add_u32 s33, s47, 4096
buffer_load_dwordx4 v90, s[20:23], s33 offen lds
s_mov_b32 m0, 8192
s_add_u32 s33, s47, 8192
buffer_load_dwordx4 v90, s[20:23], s33 offen lds
s_mov_b32 m0, 12288
s_add_u32 s33, s47, 12288
buffer_load_dwordx4 v90, s[20:23], s33 offen lds
s_mov_b32 m0, 16384
s_add_u32 s33, s47, 16384
buffer_load_dwordx4 v90, s[20:23], s33 offen lds
s_mov_b32 m0, 20480
s_add_u32 s33, s47, 20480
buffer_load_dwordx4 v90, s[20:23], s33 offen lds
s_mov_b32 m0, 24576
s_add_u32 s33, s47, 24576
buffer_load_dwordx4 v90, s[20:23], s33 offen lds
s_mov_b32 m0, 28672
s_add_u32 s33, s47, 28672
buffer_load_dwordx4 v90, s[20:23], s33 offen lds
s_mov_b32 m0, 32768
s_add_u32 s33, s47, 32768
buffer_load_dwordx4 v90, s[20:23], s33 offen lds
s_mov_b32 m0, 36864
s_add_u32 s33, s47, 36864
buffer_load_dwordx4 v90, s[20:23], s33 offen lds
s_mov_b32 m0, 40960
s_add_u32 s33, s47, 40960
buffer_load_dwordx4 v90, s[20:23], s33 offen lds
s_mov_b32 m0, 45056
s_add_u32 s33, s47, 45056
buffer_load_dwordx4 v90, s[20:23], s33 offen lds
s_mov_b32 m0, 49152
s_add_u32 s33, s47, 49152
buffer_load_dwordx4 v90, s[20:23], s33 offen lds
s_mov_b32 m0, 53248
s_add_u32 s33, s47, 53248
buffer_load_dwordx4 v90, s[20:23], s33 offen lds
s_mov_b32 m0, 57344
s_add_u32 s33, s47, 57344
buffer_load_dwordx4 v90, s[20:23], s33 offen lds
s_mov_b32 m0, 61440
s_add_u32 s33, s47, 61440
buffer_load_dwordx4 v90, s[20:23], s33 offen lds
s_mov_b32 m0, 65536
s_add_u32 s33, s47, 65536
buffer_load_dwordx4 v90, s[20:23], s33 offen lds
s_mov_b32 m0, 69632
s_add_u32 s33, s47, 69632
buffer_load_dwordx4 v90, s[20:23], s33 offen lds
s_mov_b32 m0, 73728
s_add_u32 s33, s47, 73728
buffer_load_dwordx4 v90, s[20:23], s33 offen lds
s_mov_b32 m0, 77824
s_add_u32 s33, s47, 77824
buffer_load_dwordx4 v90, s[20:23], s33 offen lds
s_mov_b32 m0, 81920
s_add_u32 s33, s47, 81920
buffer_load_dwordx4 v90, s[20:23], s33 offen lds
s_branch pk_178
p9_177:
s_mov_b32 m0, 1024
s_add_u32 s33, s47, 1024
buffer_load_dwordx4 v90, s[20:23], s33 offen lds
s_mov_b32 m0, 5120
s_add_u32 s33, s47, 5120
buffer_load_dwordx4 v90, s[20:23], s33 offen lds
s_mov_b32 m0, 9216
s_add_u32 s33, s47, 9216
buffer_load_dwordx4 v90, s[20:23], s33 offen lds
s_mov_b32 m0, 13312
s_add_u32 s33, s47, 13312
buffer_load_dwordx4 v90, s[20:23], s33 offen lds
s_mov_b32 m0, 17408
s_add_u32 s33, s47, 17408
buffer_load_dwordx4 v90, s[20:23], s33 offen lds
s_mov_b32 m0, 21504
s_add_u32 s33, s47, 21504
buffer_load_dwordx4 v90, s[20:23], s33 offen lds
s_mov_b32 m0, 25600
s_add_u32 s33, s47, 25600
buffer_load_dwordx4 v90, s[20:23], s33 offen lds
s_mov_b32 m0, 29696
s_add_u32 s33, s47, 29696
buffer_load_dwordx4 v90, s[20:23], s33 offen lds
s_mov_b32 m0, 33792
s_add_u32 s33, s47, 33792
buffer_load_dwordx4 v90, s[20:23], s33 offen lds
s_mov_b32 m0, 37888
s_add_u32 s33, s47, 37888
buffer_load_dwordx4 v90, s[20:23], s33 offen lds
s_mov_b32 m0, 41984
s_add_u32 s33, s47, 41984
buffer_load_dwordx4 v90, s[20:23], s33 offen lds
s_mov_b32 m0, 46080
s_add_u32 s33, s47, 46080
buffer_load_dwordx4 v90, s[20:23], s33 offen lds
s_mov_b32 m0, 50176
s_add_u32 s33, s47, 50176
buffer_load_dwordx4 v90, s[20:23], s33 offen lds
s_mov_b32 m0, 54272
s_add_u32 s33, s47, 54272
buffer_load_dwordx4 v90, s[20:23], s33 offen lds
s_mov_b32 m0, 58368
s_add_u32 s33, s47, 58368
buffer_load_dwordx4 v90, s[20:23], s33 offen lds
s_mov_b32 m0, 62464
s_add_u32 s33, s47, 62464
buffer_load_dwordx4 v90, s[20:23], s33 offen lds
s_mov_b32 m0, 66560
s_add_u32 s33, s47, 66560
buffer_load_dwordx4 v90, s[20:23], s33 offen lds
s_mov_b32 m0, 70656
s_add_u32 s33, s47, 70656
buffer_load_dwordx4 v90, s[20:23], s33 offen lds
s_mov_b32 m0, 74752
s_add_u32 s33, s47, 74752
buffer_load_dwordx4 v90, s[20:23], s33 offen lds
s_mov_b32 m0, 78848
s_add_u32 s33, s47, 78848
buffer_load_dwordx4 v90, s[20:23], s33 offen lds
pk_178:
s_mov_b64 exec, -1
s_branch L_ox
L_end:
s_endpgm
.section .rodata,"a"
.p2align 6
.amdhsa_kernel concat_heads__linear_kernel_hedgehog__ssm_conv_s4d__prompt_kernel
  .amdhsa_next_free_vgpr 168
  .amdhsa_next_free_sgpr 102
  .amdhsa_accum_offset 168
  .amdhsa_group_segment_fixed_size 0
  .amdhsa_kernarg_size 112
  .amdhsa_user_sgpr_count 2
  .amdhsa_user_sgpr_kernarg_segment_ptr 1
  .amdhsa_system_sgpr_workgroup_id_x 1
  .amdhsa_float_denorm_mode_32 3
.end_amdhsa_kernel
```
